```python
import torch

def _softmax(x, axis=-1):
    return torch.softmax(x, dim=axis)
def _gelu(x):
    return torch.nn.functional.gelu(x, approximate="tanh")
def _silu(x):
    return torch.nn.functional.silu(x)
def _sigmoid(x):
    return torch.sigmoid(x)
def _layernorm(x, axis=-1, eps=1e-5):
    m = x.mean(dim=axis, keepdim=True)
    v = x.var(dim=axis, keepdim=True, unbiased=False)
    return (x - m) / torch.sqrt(v + eps)
def _scatter_add(tgt, idx, src, axis=0):
    return tgt.clone().index_add_(axis, idx, src)
def _segment_sum(src, seg, n):
    out = torch.zeros((n,) + src.shape[1:], dtype=src.dtype)
    return out.index_add_(0, seg, src)
def _pad(x, pw):
    flat = tuple(v for pair in reversed(pw) for v in pair)
    return torch.nn.functional.pad(x, flat)

kernel_name = 'interleave_layers__mha_block_cached__dense_activation_silu__decode'

def setup_inputs():

    _w = (lambda a: (lambda t: t.to(torch.bfloat16) if t.is_floating_point() else t)(torch.as_tensor(a)))
    def _A_setup():
        B, Sq, D = 1, 1, 640
        H, Sk, Dh = 32, 32768, 192
        return {
            "x": _w((lambda *s: torch.randn(*s, dtype=torch.bfloat16) * 0.1)(B, Sq, D)),
            "k_cache": _w((lambda *s: torch.randn(*s, dtype=torch.bfloat16) * 1.6)(B, H, Sk, Dh)),
            "v_cache": _w((lambda *s: torch.randn(*s, dtype=torch.bfloat16) * 1.6)(B, H, Sk, Dh)),
            "wq": _w((lambda *s: torch.randn(*s, dtype=torch.bfloat16) * 1.6)(D, H * Dh) * (D ** -0.5)),
            "wo": _w((lambda *s: torch.randn(*s, dtype=torch.bfloat16) * 1.6)(H * Dh, D) * ((H * Dh) ** -0.5)),
        }
    _A_in = _A_setup()

    def _B_setup():
        B, S, D, F = 1, 1, 640, 1536
        return {
            "x": _w((lambda *s: torch.randn(*s, dtype=torch.bfloat16) * 0.1)(B, S, D)),
            "w1": _w((lambda *s: torch.randn(*s, dtype=torch.bfloat16) * 0.8)(D, F) * (D ** -0.5)),
            "w2": _w((lambda *s: torch.randn(*s, dtype=torch.bfloat16) * 0.8)(F, D) * (F ** -0.5)),
        }
    _B_in = _B_setup()

    return {
        "A_x": _A_in["x"],
        "A_k_cache": _A_in["k_cache"],
        "A_v_cache": _A_in["v_cache"],
        "A_wq": _A_in["wq"],
        "A_wo": _A_in["wo"],
        "B_x": _B_in["x"],
        "B_w1": _B_in["w1"],
        "B_w2": _B_in["w2"],
    }

def reference(A_x, A_k_cache, A_v_cache, A_wq, A_wo, B_x, B_w1, B_w2):
    def _A_ref(x, k_cache, v_cache, wq, wo):
        B, Sq, D = x.shape
        H, Dh = 32, 192
        q = (lambda x, *d: x.permute(*d))((x @ wq).reshape(B, Sq, H, Dh), 0, 2, 1, 3)
        scores = torch.einsum("bhqd,bhkd->bhqk", q, k_cache) * (Dh ** -0.5)
        p = _softmax(scores, axis=-1)
        o = torch.einsum("bhqk,bhkd->bhqd", p, v_cache)
        return (lambda x, *d: x.permute(*d))(o, 0, 2, 1, 3).reshape(B, Sq, H * Dh) @ wo

    def _B_ref(x, w1, w2):
        h = torch.einsum("bsd,df->bsf", x, w1)
        h = _silu(h)
        out = torch.einsum("bsf,fd->bsd", h, w2)
        return out

    x = A_x
    x = x + _A_ref(_layernorm(x, axis=-1), A_k_cache, A_v_cache, A_wq, A_wo)
    x = x + _B_ref(_layernorm(x, axis=-1), B_w1, B_w2)
    x = x + _A_ref(_layernorm(x, axis=-1), A_k_cache, A_v_cache, A_wq, A_wo)
    x = x + _B_ref(_layernorm(x, axis=-1), B_w1, B_w2)
    return x
```

```asm
; @launch grid=(256,1,1) block=(256,1,1) lds=161536
.amdgcn_target "amdgcn-amd-amdhsa--gfx950"
.text
.globl interleave_layers__mha_block_cached__dense_activation_silu__decode_kernel
.p2align 8
.type interleave_layers__mha_block_cached__dense_activation_silu__decode_kernel,@function
interleave_layers__mha_block_cached__dense_activation_silu__decode_kernel:
  s_cmp_ge_u32 s2, 256
  s_cbranch_scc1 L_end
  s_load_dwordx2 s[4:5], s[0:1], 8
  s_load_dwordx2 s[8:9], s[0:1], 16
  s_load_dwordx2 s[32:33], s[0:1], 0
  s_load_dwordx2 s[12:13], s[0:1], 24
  s_load_dwordx2 s[16:17], s[0:1], 32
  s_load_dwordx2 s[20:21], s[0:1], 48
  s_load_dwordx2 s[24:25], s[0:1], 56
  s_load_dwordx2 s[36:37], s[0:1], 64
  s_load_dwordx2 s[40:41], s[0:1], 72
  s_load_dwordx2 s[28:29], s[0:1], 80
  v_lshrrev_b32 v2, 6, v0
  v_and_b32 v1, 63, v0
  v_readfirstlane_b32 s3, v2
  s_mov_b32 s6, 402653184
  s_mov_b32 s7, 0x20000
  s_mov_b32 s10, 402653184
  s_mov_b32 s11, 0x20000
  s_mov_b32 s34, 1280
  s_mov_b32 s35, 0x20000
  s_mov_b32 s14, 7864320
  s_mov_b32 s15, 0x20000
  s_mov_b32 s18, 7864320
  s_mov_b32 s19, 0x20000
  s_mov_b32 s22, 1966080
  s_mov_b32 s23, 0x20000
  s_mov_b32 s26, 1966080
  s_mov_b32 s27, 0x20000
  s_mov_b32 s38, 1280
  s_mov_b32 s39, 0x20000
  s_mov_b32 s42, 256
  s_mov_b32 s43, 0x20000
  s_mov_b32 s30, 6291456
  s_mov_b32 s31, 0x20000
  s_lshr_b32 s72, s2, 3
  s_bfe_u32 s77, s2, 0x10001
  s_and_b32 s78, s2, 1
  s_lshl_b32 s78, s78, 1
  s_or_b32 s77, s77, s78
  s_bfe_u32 s80, s2, 0x10002
  s_mul_i32 s79, s72, 171
  s_lshr_b32 s79, s79, 9
  s_mul_i32 s79, s79, 3
  s_sub_u32 s81, s72, s79
  s_xor_b32 s71, s81, 1
  s_cmp_eq_u32 s81, 2
  s_cselect_b32 s81, 2, s71
  s_add_u32 s79, s79, s81
  s_add_u32 s63, s79, 64
  s_and_b32 s81, s3, 1
  s_lshl1_add_u32 s82, s72, s81
  s_cmp_ge_u32 s3, 2
  s_cselect_b32 s82, s63, s82
  s_lshl_b32 s79, s82, 1
  s_and_b32 s81, s77, 1
  s_add_u32 s79, s79, s81
  s_lshl_b32 s58, s79, 21
  s_lshl_b32 s81, s2, 2
  s_add_u32 s81, s81, s3
  s_mul_i32 s81, s81, 0x2f1300
  s_and_b32 s81, s81, 0x1f5700
  s_add_u32 s58, s58, s81
  s_add_u32 s59, s58, 0x8000
  s_lshr_b32 s61, s77, 1
  s_waitcnt lgkmcnt(0)
  s_mov_b64 exec, 1
  s_cmp_eq_u32 s61, 1
  s_cbranch_scc1 L_warmV
  buffer_load_dword v88, off, s[4:7], s59 nt
  s_branch L_warmD
L_warmV:
  buffer_load_dword v88, off, s[8:11], s59 nt
L_warmD:
  s_mov_b64 exec, -1
  s_and_b32 s73, s77, 1
  s_lshl_b32 s78, s80, 1
  s_or_b32 s73, s73, s78
  s_and_b32 s78, s77, 2
  s_lshl_b32 s78, s78, 1
  s_or_b32 s73, s73, s78
  s_and_b32 s77, s73, 3
  s_lshl_b32 s77, s77, 1
  s_lshr_b32 s78, s73, 2
  s_add_u32 s89, s77, s78
  s_mul_i32 s96, s82, 171
  s_lshr_b32 s96, s96, 9
  s_mul_i32 s97, s96, 3
  s_sub_u32 s97, s82, s97
  s_lshl_b32 s77, s72, 5
  s_add_u32 s77, s77, 1
  s_mul_i32 s77, s77, 0xaaab
  s_lshr_b32 s77, s77, 17
  s_lshl_b32 s94, s72, 5
  s_add_u32 s94, s94, 17
  s_mul_i32 s94, s94, 0xaaab
  s_lshr_b32 s94, s94, 17
  s_lshl_b32 s95, s72, 5
  s_add_u32 s95, s95, 33
  s_mul_i32 s95, s95, 0xaaab
  s_lshr_b32 s95, s95, 17
  s_lshl_b32 s78, s63, 4
  s_add_u32 s78, s78, 1
  s_mul_i32 s78, s78, 0xaaab
  s_lshr_b32 s78, s78, 17
  s_sub_u32 s94, s94, s77
  s_sub_u32 s95, s95, s77
  s_sub_u32 s78, s78, s95
  s_mul_i32 s91, s77, 786432
  s_mul_i32 s92, s78, 786432
  s_cmp_eq_u32 s95, 10
  s_cselect_b32 s93, s92, s91
  s_bitcmp1_b32 s72, 0
  s_cselect_b32 s100, 5, 0
  s_xor_b32 s100, s100, s73
  s_add_u32 s77, s3, 8
  s_cmp_lt_u32 s3, 2
  s_cselect_b32 s84, s77, s3
  s_cselect_b32 s83, -1, 0
  s_andn2_b32 s90, 0x80000000, s83
  s_lshr_b32 s77, s2, 3
  s_add_u32 s77, s77, s2
  s_mul_i32 s77, s77, 5
  s_and_b32 s77, s77, 31
  s_mov_b32 s68, s77
  s_mul_i32 s70, s3, 36864
  s_mov_b32 s85, 0x3fb8aa3b
  s_mov_b32 s74, 1
  s_mov_b32 s75, -1
  s_mov_b32 s76, 0
  s_mov_b32 s88, 0
  s_lshl_b32 s77, s2, 13
  s_lshl_b32 s78, s3, 11
  s_add_u32 s77, s77, s78
  s_add_u32 s87, s77, 3145728
  s_sub_u32 s77, s2, 160
  s_cmp_lt_u32 s77, 64
  s_cbranch_scc1 L_clr
  v_and_b32 v46, 7, v1
  v_bfe_u32 v47, v1, 3, 2
  v_lshlrev_b32 v46, 3, v46
  v_lshl_add_u32 v46, v47, 1, v46
  v_lshrrev_b32 v47, 5, v1
  v_add_u32 v46, v46, v47
  v_lshlrev_b32 v46, 1, v46
  s_add_u32 s77, s3, 0
  s_mul_i32 s77, s77, 128
  buffer_load_ushort v84, v46, s[32:35], s77 offen
  s_add_u32 s77, s3, 4
  s_mul_i32 s77, s77, 128
  buffer_load_ushort v85, v46, s[32:35], s77 offen
  s_mul_i32 s77, s84, 128
  buffer_load_ushort v86, v46, s[32:35], s77 offen
  v_lshrrev_b32 v44, 3, v1
  v_mul_u32_u24 v44, 98304, v44
  v_and_b32 v45, 7, v1
  v_lshl_add_u32 v44, v45, 4, v44
  s_cmp_ge_u32 s2, 224
  s_cselect_b32 s78, 64, 0
  s_sub_u32 s78, s2, s78
  s_and_b32 s77, s78, 1
  s_lshl1_add_u32 s77, s3, s77
  s_mulk_i32 s77, 12288
  s_lshr_b32 s78, s78, 1
  s_lshl_b32 s78, s78, 7
  s_add_u32 s77, s77, s78
  buffer_load_dwordx4 v[48:51], v44, s[12:15], s77 offen
  s_add_u32 s77, s77, 786432
  buffer_load_dwordx4 v[52:55], v44, s[12:15], s77 offen
  s_add_u32 s77, s77, 786432
  buffer_load_dwordx4 v[56:59], v44, s[12:15], s77 offen
  s_add_u32 s77, s77, 786432
  buffer_load_dwordx4 v[60:63], v44, s[12:15], s77 offen
  s_add_u32 s77, s77, 786432
  buffer_load_dwordx4 v[64:67], v44, s[12:15], s77 offen
  s_add_u32 s77, s77, 786432
  buffer_load_dwordx4 v[68:71], v44, s[12:15], s77 offen
  s_add_u32 s77, s77, 786432
  buffer_load_dwordx4 v[12:15], v44, s[12:15], s77 offen
  s_add_u32 s77, s77, 786432
  buffer_load_dwordx4 v[80:83], v44, s[12:15], s77 offen
  s_add_u32 s77, s77, 786432
  buffer_load_dwordx4 v[32:35], v44, s[12:15], s77 offen
  s_add_u32 s77, s77, 786432
  buffer_load_dwordx4 v[36:39], v44, s[12:15], s77 offen
  s_branch L_nowq0
L_clr:
  v_mov_b32 v16, -1
  v_mov_b32 v17, -1
  v_mov_b32 v18, -1
  v_mov_b32 v19, -1
  v_lshlrev_b32 v44, 4, v1
  s_sub_u32 s64, s2, 160
  s_lshl2_add_u32 s64, s64, s3
  s_mul_i32 s65, s64, 10752
  s_cmp_ge_u32 s2, 168
  s_cbranch_scc1 L_clr1
  v_mov_b32 v84, 0
  v_mov_b32 v85, 0
  v_mov_b32 v86, 0
  v_mov_b32 v87, 0
  s_mul_i32 s66, s64, 3072
  s_add_u32 s66, s66, 2883584
  buffer_store_dwordx4 v[84:87], v44, s[28:31], s66 offen offset:0 sc1
  buffer_store_dwordx4 v[84:87], v44, s[28:31], s66 offen offset:1024 sc1
  buffer_store_dwordx4 v[84:87], v44, s[28:31], s66 offen offset:2048 sc1
L_clr1:
  buffer_store_dwordx4 v[16:19], v44, s[28:31], s65 offen offset:0 sc1 nt
  buffer_store_dwordx4 v[16:19], v44, s[28:31], s65 offen offset:1024 sc1 nt
  buffer_store_dwordx4 v[16:19], v44, s[28:31], s65 offen offset:2048 sc1 nt
  buffer_store_dwordx4 v[16:19], v44, s[28:31], s65 offen offset:3072 sc1 nt
  s_add_u32 s65, s65, 4096
  buffer_store_dwordx4 v[16:19], v44, s[28:31], s65 offen offset:0 sc1 nt
  buffer_store_dwordx4 v[16:19], v44, s[28:31], s65 offen offset:1024 sc1 nt
  buffer_store_dwordx4 v[16:19], v44, s[28:31], s65 offen offset:2048 sc1 nt
  buffer_store_dwordx4 v[16:19], v44, s[28:31], s65 offen offset:3072 sc1 nt
  s_add_u32 s65, s65, 4096
  buffer_store_dwordx4 v[16:19], v44, s[28:31], s65 offen offset:0 sc1 nt
  buffer_store_dwordx4 v[16:19], v44, s[28:31], s65 offen offset:1024 sc1 nt
  s_mov_b32 exec_hi, 0
  buffer_store_dwordx4 v[16:19], v44, s[28:31], s65 offen offset:2048 sc1 nt
  s_mov_b64 exec, -1
  s_cmp_ge_u32 s2, 168
  s_cbranch_scc1 L_nowq0
  s_waitcnt vmcnt(11)
  s_barrier
  s_cmp_lg_u32 s3, 0
  s_cbranch_scc1 L_nowq0
  s_mov_b64 exec, 1
  buffer_store_dword v16, off, s[40:43], s64 offset:128 sc1
  s_mov_b64 exec, -1
L_nowq0:
  s_lshl_b32 s77, s3, 3
  v_bfe_u32 v44, v1, 1, 3
  v_add_u32 v44, s77, v44
  v_mul_u32_u24 v44, 384, v44
  v_and_b32 v45, 1, v1
  v_lshl_add_u32 v44, v45, 6, v44
  v_lshrrev_b32 v45, 4, v1
  v_lshl_add_u32 v2, v45, 4, v44
  v_lshrrev_b32 v44, 3, v1
  v_add_u32 v44, s77, v44
  v_mul_u32_u24 v44, 384, v44
  v_and_b32 v45, 7, v1
  v_lshl_add_u32 v3, v45, 4, v44
  s_movk_i32 s78, 8448
  v_mov_b32 v45, 32640
  v_mov_b32 v46, 4294963072
  v_mov_b32 v47, 57216
  v_cmp_le_u32 vcc, 4224, v2
  v_cmp_le_u32 s[54:55], s78, v2
  s_nop 0
  v_cndmask_b32 v44, v45, v46, vcc
  v_cndmask_b32 v44, v44, v47, s[54:55]
  v_add_u32 v2, v2, v44
  v_cmp_le_u32 vcc, 4224, v3
  v_cmp_le_u32 s[54:55], s78, v3
  s_nop 0
  v_cndmask_b32 v44, v45, v46, vcc
  v_cndmask_b32 v44, v44, v47, s[54:55]
  v_add_u32 v3, v3, v44
  s_mov_b32 s48, 0x84108
  s_mov_b32 s49, 0x0
  v_add_u32 v44, 0, v1
  v_mov_b32 v45, s91
  v_mul_u32_u24 v44, 98304, v44
  v_add_u32 v44, v44, v45
  v_add_u32 v44, 49152, v44
  v_lshrrev_b32 v45, 7, v44
  v_xor_b32 v44, v44, v45
  v_bfe_u32 v45, v44, 20, 1
  v_bfe_u32 v44, v44, 19, 1
  v_lshl_or_b32 v44, v44, 2, v45
  v_and_b32 v45, 1, v1
  v_mul_u32_u24 v45, 5, v45
  v_xor_b32 v44, v44, v45
  v_xor_b32 v44, s100, v44
  s_mov_b32 s54, 0x90140
  s_mov_b32 s55, 0x0
  v_cndmask_b32 v45, 0, 1, s[54:55]
  v_xor_b32 v44, v44, v45
  v_cndmask_b32 v45, 0, 2, s[48:49]
  v_xor_b32 v45, v45, v44
  v_mul_u32_u24 v45, 48, v45
  v_and_b32 v0, 0x70, v45
  v_and_b32 v44, 1, v1
  v_lshlrev_b32 v44, 4, v44
  v_mov_b32 v45, 0xffff
  v_lshlrev_b32 v45, v44, v45
  v_bfe_u32 v46, v1, 1, 2
  v_cmp_eq_u32 vcc, 0, v46
  s_nop 1
  v_cndmask_b32 v8, 0, v45, vcc
  v_cmp_eq_u32 vcc, 1, v46
  s_nop 1
  v_cndmask_b32 v9, 0, v45, vcc
  v_cmp_eq_u32 vcc, 2, v46
  s_nop 1
  v_cndmask_b32 v10, 0, v45, vcc
  v_cmp_eq_u32 vcc, 3, v46
  s_nop 1
  v_cndmask_b32 v11, 0, v45, vcc
  v_lshlrev_b32 v6, 4, v1
  v_add_u32 v6, s70, v6
  s_mov_b32 s82, s58
  s_mov_b32 s58, s82
  s_mov_b32 s0, 0xffff
  s_mov_b32 s1, 0xffff
  s_xor_b32 s59, s58, 8192
  s_waitcnt vmcnt(0)
  s_mov_b64 exec, 1
  s_cmp_eq_u32 s61, 1
  s_cbranch_scc1 L_prV
  s_memtime s[54:55]
  s_waitcnt lgkmcnt(0)
  buffer_load_dword v88, off, s[4:7], s58 offset:0 nt
  s_waitcnt vmcnt(0)
  s_memtime s[56:57]
  s_waitcnt lgkmcnt(0)
  buffer_load_dword v88, off, s[4:7], s59 offset:0 nt
  s_waitcnt vmcnt(0)
  s_memtime s[48:49]
  s_waitcnt lgkmcnt(0)
  s_sub_u32 s77, s56, s54
  s_sub_u32 s78, s48, s56
  s_min_u32 s0, s0, s77
  s_min_u32 s1, s1, s78
  s_branch L_prD
L_prV:
  s_memtime s[54:55]
  s_waitcnt lgkmcnt(0)
  buffer_load_dword v88, off, s[8:11], s58 offset:0 nt
  s_waitcnt vmcnt(0)
  s_memtime s[56:57]
  s_waitcnt lgkmcnt(0)
  buffer_load_dword v88, off, s[8:11], s59 offset:0 nt
  s_waitcnt vmcnt(0)
  s_memtime s[48:49]
  s_waitcnt lgkmcnt(0)
  s_sub_u32 s77, s56, s54
  s_sub_u32 s78, s48, s56
  s_min_u32 s0, s0, s77
  s_min_u32 s1, s1, s78
L_prD:
  s_mov_b64 exec, -1
  s_bitcmp1_b32 s2, 2
  s_cselect_b32 s77, s1, s0
  s_cselect_b32 s1, s0, s1
  s_mov_b32 s0, s77
  v_cvt_f32_u32 v46, s0
  v_cvt_f32_u32 v47, s1
  s_lshl_b32 s77, s3, 3
  s_add_u32 s77, s77, 159744
  v_mov_b32 v44, s77
  ds_write_b64 v44, v[46:47]
  s_waitcnt lgkmcnt(0)
  s_barrier
  s_cmp_eq_u32 s3, 3
  s_cselect_b32 s78, 0, 0x80000000
  v_and_b32 v46, 7, v1
  v_lshl_or_b32 v41, v46, 2, s78
  buffer_load_dword v40, v41, s[40:43], 0 offen offset:128 sc1
  v_readlane_b32 s64, v0, 0
  s_add_u32 s58, s91, 0
  s_bfe_u32 s65, s64, 0x30004
  s_mulk_i32 s65, 12288
  v_add_u32 v44, s65, v3
  v_add_u32 v45, 4294868992, v44
  v_min_u32 v4, v44, v45
  s_add_u32 m0, s70, 0
  s_nop 0
  buffer_load_dwordx4 v4, s[8:11], s58 offen offset:0 nt lds
  s_add_u32 m0, s70, 896
  s_nop 0
  buffer_load_dwordx4 v4, s[8:11], s58 offen offset:128 nt lds
  s_add_u32 m0, s70, 1792
  s_nop 0
  buffer_load_dwordx4 v4, s[8:11], s58 offen offset:256 nt lds
  v_readlane_b32 s64, v0, 3
  s_add_u32 s58, s91, 294912
  s_bfe_u32 s65, s64, 0x30004
  s_mulk_i32 s65, 12288
  v_add_u32 v44, s65, v3
  v_add_u32 v45, 4294868992, v44
  v_min_u32 v4, v44, v45
  s_add_u32 m0, s70, 3072
  s_nop 0
  buffer_load_dwordx4 v4, s[8:11], s58 offen offset:0 nt lds
  s_add_u32 m0, s70, 3968
  s_nop 0
  buffer_load_dwordx4 v4, s[8:11], s58 offen offset:128 nt lds
  s_add_u32 m0, s70, 4864
  s_nop 0
  buffer_load_dwordx4 v4, s[8:11], s58 offen offset:256 nt lds
  v_readlane_b32 s64, v0, 6
  s_add_u32 s58, s91, 589824
  s_bfe_u32 s65, s64, 0x30004
  s_mulk_i32 s65, 12288
  v_add_u32 v44, s65, v3
  v_add_u32 v45, 4294868992, v44
  v_min_u32 v4, v44, v45
  s_add_u32 m0, s70, 6144
  s_nop 0
  buffer_load_dwordx4 v4, s[8:11], s58 offen offset:0 nt lds
  s_add_u32 m0, s70, 7040
  s_nop 0
  buffer_load_dwordx4 v4, s[8:11], s58 offen offset:128 nt lds
  s_add_u32 m0, s70, 7936
  s_nop 0
  buffer_load_dwordx4 v4, s[8:11], s58 offen offset:256 nt lds
  v_readlane_b32 s64, v0, 8
  s_add_u32 s58, s91, 786432
  s_bfe_u32 s65, s64, 0x30004
  s_mulk_i32 s65, 12288
  v_add_u32 v44, s65, v3
  v_add_u32 v45, 4294868992, v44
  v_min_u32 v4, v44, v45
  s_add_u32 m0, s70, 9216
  s_nop 0
  buffer_load_dwordx4 v4, s[8:11], s58 offen offset:0 nt lds
  s_add_u32 m0, s70, 10112
  s_nop 0
  buffer_load_dwordx4 v4, s[8:11], s58 offen offset:128 nt lds
  s_add_u32 m0, s70, 11008
  s_nop 0
  buffer_load_dwordx4 v4, s[8:11], s58 offen offset:256 nt lds
  s_cmp_lg_u32 s3, 3
  s_cbranch_scc1 L_nop
  v_add_u32 v46, 159744, v41
  ds_read_b32 v47, v46
  v_lshlrev_b32 v46, 2, v1
  s_lshl3_add_u32 s77, s72, s73
  s_lshl_b32 s77, s77, 7
  s_add_u32 s77, s77, 2949120
  s_waitcnt vmcnt(12)
  v_cmp_eq_u32 vcc, 0, v40
  s_cbranch_vccnz L_go_spin
L_go_ok:
  s_mov_b32 exec_hi, 0
  s_waitcnt lgkmcnt(0)
  buffer_store_dword v47, v46, s[28:31], s77 offen sc1
  s_sub_u32 s77, s2, 160
  s_cmp_lt_u32 s77, 64
  s_cselect_b64 exec, 1, 0
  s_cbranch_execz L_nosig
  v_mov_b32 v40, 1
  buffer_atomic_add v40, off, s[40:43], 0 sc1
L_nosig:
  s_mov_b64 exec, -1
L_nop:
  v_lshlrev_b32 v84, 16, v84
  v_lshlrev_b32 v85, 16, v85
  v_lshlrev_b32 v86, 16, v86
  s_lshl_b32 s78, s3, 10
  s_add_u32 s78, s78, 151552
  v_lshl_add_u32 v46, v1, 4, s78
L_pass:
  s_sub_u32 s77, s2, 160
  s_cmp_lt_u32 s77, 64
  s_cbranch_scc1 L_qpub_done
  ds_write_b128 v46, v[84:87]
  v_lshlrev_b32 v44, 4, v1
  v_add_u32 v44, 151552, v44
  s_and_b32 s78, s2, 1
  s_lshl2_add_u32 s78, s78, s3
  s_lshl_b32 s78, s78, 7
  s_add_u32 s78, s78, 151552
  v_lshrrev_b32 v46, 3, v1
  v_lshl_add_u32 v46, v46, 4, s78
  v_and_b32 v47, 1, v1
  v_lshl_add_u32 v47, v47, 10, v46
  v_and_b32 v45, 2, v1
  v_lshl_add_u32 v46, v45, 10, v47
  v_and_b32 v45, 4, v1
  v_add_u32 v46, v46, v45
  s_waitcnt lgkmcnt(0)
  s_barrier
  ds_read_b128 v[20:23], v44
  ds_read_b128 v[24:27], v44 offset:1024
  ds_read_b64 v[28:29], v44 offset:2048
  ds_read_b64 v[30:31], v44 offset:3072
  ds_read_b32 v88, v46
  ds_read_b32 v89, v47 offset:8
  s_cmp_lg_u32 s76, 1
  s_cbranch_scc1 L_noek
  buffer_load_dwordx4 v[72:75], v4, s[4:7], s58 offen offset:0 nt
  buffer_load_dwordx4 v[76:79], v4, s[4:7], s58 offen offset:128 nt
  buffer_load_dwordx4 v[40:43], v4, s[4:7], s58 offen offset:256 nt
L_noek:
  s_waitcnt lgkmcnt(2)
  v_readfirstlane_b32 s54, v20
  s_nop 1
  v_pk_add_f32 v[20:21], v[20:21], s[54:55] op_sel_hi:[1,0] neg_lo:[0,1] neg_hi:[0,1]
  v_pk_add_f32 v[24:25], v[24:25], s[54:55] op_sel_hi:[1,0] neg_lo:[0,1] neg_hi:[0,1]
  v_pk_add_f32 v[28:29], v[28:29], s[54:55] op_sel_hi:[1,0] neg_lo:[0,1] neg_hi:[0,1]
  v_pk_add_f32 v[30:31], v[30:31], s[54:55] op_sel_hi:[1,0] neg_lo:[0,1] neg_hi:[0,1]
  v_subrev_f32 v22, s54, v22
  v_subrev_f32 v23, s54, v26
  v_pk_mul_f32 v[46:47], v[20:21], v[20:21]
  v_pk_add_f32 v[44:45], v[20:21], v[24:25]
  v_pk_fma_f32 v[46:47], v[24:25], v[24:25], v[46:47]
  v_pk_add_f32 v[44:45], v[44:45], v[28:29]
  v_pk_fma_f32 v[46:47], v[28:29], v[28:29], v[46:47]
  v_pk_add_f32 v[44:45], v[44:45], v[30:31]
  v_pk_fma_f32 v[46:47], v[30:31], v[30:31], v[46:47]
  v_pk_add_f32 v[44:45], v[44:45], v[22:23]
  v_pk_fma_f32 v[46:47], v[22:23], v[22:23], v[46:47]
  v_add_f32 v44, v44, v45
  v_add_f32 v45, v46, v47
  s_nop 1
  v_add_f32_dpp v44, v44, v44 quad_perm:[1,0,3,2] row_mask:0xf bank_mask:0xf
  v_add_f32_dpp v45, v45, v45 quad_perm:[1,0,3,2] row_mask:0xf bank_mask:0xf
  s_nop 0
  v_add_f32_dpp v44, v44, v44 quad_perm:[2,3,0,1] row_mask:0xf bank_mask:0xf
  v_add_f32_dpp v45, v45, v45 quad_perm:[2,3,0,1] row_mask:0xf bank_mask:0xf
  s_nop 0
  v_add_f32_dpp v44, v44, v44 row_half_mirror row_mask:0xf bank_mask:0xf
  v_add_f32_dpp v45, v45, v45 row_half_mirror row_mask:0xf bank_mask:0xf
  s_nop 0
  v_add_f32_dpp v44, v44, v44 row_mirror row_mask:0xf bank_mask:0xf
  v_add_f32_dpp v45, v45, v45 row_mirror row_mask:0xf bank_mask:0xf
  s_nop 0
  v_mov_b32 v46, v44
  v_mov_b32 v47, v45
  s_nop 1
  v_permlane16_swap_b32 v44, v46
  v_permlane16_swap_b32 v45, v47
  v_add_f32 v44, v44, v46
  v_add_f32 v45, v45, v47
  v_mov_b32 v46, v44
  v_mov_b32 v47, v45
  s_nop 1
  v_permlane32_swap_b32 v44, v46
  v_permlane32_swap_b32 v45, v47
  v_add_f32 v44, v44, v46
  v_add_f32 v45, v45, v47
  v_mul_f32 v44, 0x3acccccd, v44
  v_mul_f32 v45, 0x3acccccd, v45
  v_fma_f32 v45, -v44, v44, v45
  v_add_f32 v44, s54, v44
  v_max_f32 v45, 0, v45
  v_cvt_pk_bf16_f32 v45, 0, v45
  v_cvt_pk_bf16_f32 v44, 0, v44
  v_add_f32 v45, 0x3727c5ac, v45
  v_cvt_pk_bf16_f32 v45, 0, v45
  v_sqrt_f32 v45, v45
  s_waitcnt lgkmcnt(0)
  v_sub_f32 v88, v88, v44
  v_sub_f32 v89, v89, v44
  v_cvt_pk_bf16_f32 v45, 0, v45
  v_rcp_f32 v46, v45
  v_cvt_pk_bf16_f32 v88, 0, v88
  v_cvt_pk_bf16_f32 v89, 0, v89
  v_mul_f32 v20, v88, v46
  v_mul_f32 v21, v89, v46
  v_fma_f32 v24, -v20, v45, v88
  v_fma_f32 v25, -v21, v45, v89
  v_fma_f32 v20, v24, v46, v20
  v_fma_f32 v21, v25, v46, v21
  v_cvt_pk_bf16_f32 v88, v20, v20
  v_cvt_pk_bf16_f32 v89, v21, v21
  s_nop 0
  v_mov_b32_dpp v44, v88 row_newbcast:0 row_mask:0xf bank_mask:0x3
  v_mov_b32_dpp v44, v88 row_newbcast:8 row_mask:0xf bank_mask:0xc
  v_and_b32 v16, v8, v44
  v_and_b32 v17, v9, v44
  v_and_b32 v18, v10, v44
  v_and_b32 v19, v11, v44
  v_mov_b32_dpp v44, v88 row_newbcast:1 row_mask:0xf bank_mask:0x3
  v_mov_b32_dpp v44, v88 row_newbcast:9 row_mask:0xf bank_mask:0xc
  v_mfma_f32_16x16x32_bf16 v[20:23], v[16:19], v[48:51], 0
  v_and_b32 v84, v8, v44
  v_and_b32 v85, v9, v44
  v_and_b32 v86, v10, v44
  v_and_b32 v87, v11, v44
  v_mov_b32_dpp v44, v88 row_newbcast:2 row_mask:0xf bank_mask:0x3
  v_mov_b32_dpp v44, v88 row_newbcast:10 row_mask:0xf bank_mask:0xc
  v_mfma_f32_16x16x32_bf16 v[20:23], v[84:87], v[52:55], v[20:23]
  v_and_b32 v16, v8, v44
  v_and_b32 v17, v9, v44
  v_and_b32 v18, v10, v44
  v_and_b32 v19, v11, v44
  v_mov_b32_dpp v44, v88 row_newbcast:3 row_mask:0xf bank_mask:0x3
  v_mov_b32_dpp v44, v88 row_newbcast:11 row_mask:0xf bank_mask:0xc
  v_mfma_f32_16x16x32_bf16 v[20:23], v[16:19], v[56:59], v[20:23]
  v_and_b32 v84, v8, v44
  v_and_b32 v85, v9, v44
  v_and_b32 v86, v10, v44
  v_and_b32 v87, v11, v44
  v_mov_b32_dpp v44, v88 row_newbcast:4 row_mask:0xf bank_mask:0x3
  v_mov_b32_dpp v44, v88 row_newbcast:12 row_mask:0xf bank_mask:0xc
  v_mfma_f32_16x16x32_bf16 v[20:23], v[84:87], v[60:63], v[20:23]
  v_and_b32 v16, v8, v44
  v_and_b32 v17, v9, v44
  v_and_b32 v18, v10, v44
  v_and_b32 v19, v11, v44
  v_mov_b32_dpp v44, v88 row_newbcast:5 row_mask:0xf bank_mask:0x3
  v_mov_b32_dpp v44, v88 row_newbcast:13 row_mask:0xf bank_mask:0xc
  v_mfma_f32_16x16x32_bf16 v[20:23], v[16:19], v[64:67], v[20:23]
  v_and_b32 v84, v8, v44
  v_and_b32 v85, v9, v44
  v_and_b32 v86, v10, v44
  v_and_b32 v87, v11, v44
  v_mov_b32_dpp v44, v88 row_newbcast:6 row_mask:0xf bank_mask:0x3
  v_mov_b32_dpp v44, v88 row_newbcast:14 row_mask:0xf bank_mask:0xc
  v_mfma_f32_16x16x32_bf16 v[20:23], v[84:87], v[68:71], v[20:23]
  v_and_b32 v16, v8, v44
  v_and_b32 v17, v9, v44
  v_and_b32 v18, v10, v44
  v_and_b32 v19, v11, v44
  v_mov_b32_dpp v44, v88 row_newbcast:7 row_mask:0xf bank_mask:0x3
  v_mov_b32_dpp v44, v88 row_newbcast:15 row_mask:0xf bank_mask:0xc
  v_mfma_f32_16x16x32_bf16 v[20:23], v[16:19], v[12:15], v[20:23]
  v_and_b32 v84, v8, v44
  v_and_b32 v85, v9, v44
  v_and_b32 v86, v10, v44
  v_and_b32 v87, v11, v44
  v_mov_b32_dpp v44, v89 row_newbcast:0 row_mask:0xf bank_mask:0x3
  v_mov_b32_dpp v44, v89 row_newbcast:8 row_mask:0xf bank_mask:0xc
  v_mfma_f32_16x16x32_bf16 v[20:23], v[84:87], v[80:83], v[20:23]
  v_and_b32 v16, v8, v44
  v_and_b32 v17, v9, v44
  v_and_b32 v18, v10, v44
  v_and_b32 v19, v11, v44
  v_mov_b32_dpp v44, v89 row_newbcast:1 row_mask:0xf bank_mask:0x3
  v_mov_b32_dpp v44, v89 row_newbcast:9 row_mask:0xf bank_mask:0xc
  v_mfma_f32_16x16x32_bf16 v[20:23], v[16:19], v[32:35], v[20:23]
  v_and_b32 v84, v8, v44
  v_and_b32 v85, v9, v44
  v_and_b32 v86, v10, v44
  v_and_b32 v87, v11, v44
  s_nop 1
  v_mfma_f32_16x16x32_bf16 v[20:23], v[84:87], v[36:39], v[20:23]
  s_lshl_b32 s77, s3, 2
  s_add_u32 s77, s77, 155648
  v_lshl_add_u32 v45, v1, 4, s77
  v_and_b32 v46, 7, v1
  v_bfe_u32 v47, v1, 3, 2
  v_lshlrev_b32 v46, 3, v46
  v_lshl_add_u32 v46, v47, 1, v46
  v_lshrrev_b32 v47, 5, v1
  v_add_u32 v46, v46, v47
  v_permlane32_swap_b32 v20, v21
  v_permlane32_swap_b32 v22, v23
  v_lshlrev_b32 v46, 2, v46
  s_nop 0
  v_add_f32_dpp v44, v21, v20 row_ror:8 row_mask:0xf bank_mask:0x3
  v_add_f32_dpp v44, v22, v23 row_ror:8 row_mask:0xf bank_mask:0xc
  ds_write_b32 v45, v44
  s_cmp_ge_u32 s2, 224
  s_cselect_b32 s78, 64, 0
  s_sub_u32 s78, s2, s78
  s_lshr_b32 s79, s78, 1
  s_mul_i32 s77, s79, 171
  s_lshr_b32 s77, s77, 9
  s_mulk_i32 s77, 5
  s_add_u32 s77, s77, s79
  s_and_b32 s78, s78, 1
  s_lshl2_add_u32 s77, s78, s77
  s_lshl_b32 s77, s77, 8
  s_add_u32 s77, s77, 2883584
  s_cmp_eq_u32 s76, 2
  s_waitcnt lgkmcnt(0)
  s_barrier
  s_cbranch_scc1 L_x2
  s_cmp_lg_u32 s3, 3
  s_cbranch_scc1 L_qpub_done
  v_add_u32 v45, -12, v45
  ds_read_b128 v[84:87], v45
  s_waitcnt lgkmcnt(0)
  v_add_f32 v84, v84, v85
  v_add_f32 v86, v86, v87
  v_add_f32 v84, v84, v86
  v_and_or_b32 v84, v84, -2, s74
  buffer_store_dword v84, v46, s[28:31], s77 offen sc1
L_qpub_done:
  s_cmp_lg_u32 s76, 0
  s_cbranch_scc1 L_q_pass1
  s_barrier
  v_readlane_b32 s64, v0, 11
  s_add_u32 s58, s91, 1081344
  s_bfe_u32 s65, s64, 0x30004
  s_mulk_i32 s65, 12288
  v_add_u32 v44, s65, v3
  v_add_u32 v45, 4294868992, v44
  v_min_u32 v4, v44, v45
  s_add_u32 m0, s70, 12288
  s_waitcnt vmcnt(5)
  s_barrier
  s_nop 0
  buffer_load_dwordx4 v4, s[8:11], s58 offen offset:0 nt lds
  s_add_u32 m0, s70, 13184
  s_waitcnt vmcnt(5)
  s_nop 0
  buffer_load_dwordx4 v4, s[8:11], s58 offen offset:128 nt lds
  s_add_u32 m0, s70, 14080
  s_waitcnt vmcnt(5)
  s_nop 0
  buffer_load_dwordx4 v4, s[8:11], s58 offen offset:256 nt lds
  v_readlane_b32 s64, v0, 14
  s_add_u32 s58, s91, 1376256
  s_bfe_u32 s65, s64, 0x30004
  s_mulk_i32 s65, 12288
  v_add_u32 v44, s65, v3
  v_add_u32 v45, 4294868992, v44
  v_min_u32 v4, v44, v45
  s_add_u32 m0, s70, 15360
  s_waitcnt vmcnt(5)
  s_barrier
  s_nop 0
  buffer_load_dwordx4 v4, s[8:11], s58 offen offset:0 nt lds
  s_add_u32 m0, s70, 16256
  s_waitcnt vmcnt(5)
  s_nop 0
  buffer_load_dwordx4 v4, s[8:11], s58 offen offset:128 nt lds
  s_add_u32 m0, s70, 17152
  s_waitcnt vmcnt(5)
  s_nop 0
  buffer_load_dwordx4 v4, s[8:11], s58 offen offset:256 nt lds
  v_lshrrev_b32 v46, 3, v1
  v_lshlrev_b32 v46, 7, v46
  v_and_b32 v47, 7, v1
  v_lshl_add_u32 v46, v47, 2, v46
  s_lshl_b32 s71, s72, 10
  s_add_u32 s71, s71, 2949120
  buffer_load_dword v14, v46, s[28:31], s71 offen sc1
  v_readlane_b32 s64, v0, 16
  s_add_u32 s58, s91, 1572864
  s_bfe_u32 s65, s64, 0x30004
  s_mulk_i32 s65, 12288
  v_add_u32 v44, s65, v3
  v_add_u32 v45, 4294868992, v44
  v_min_u32 v4, v44, v45
  s_add_u32 m0, s70, 18432
  s_waitcnt vmcnt(5)
  s_barrier
  s_nop 0
  buffer_load_dwordx4 v4, s[8:11], s58 offen offset:0 nt lds
  s_add_u32 m0, s70, 19328
  s_waitcnt vmcnt(5)
  s_nop 0
  buffer_load_dwordx4 v4, s[8:11], s58 offen offset:128 nt lds
  s_add_u32 m0, s70, 20224
  s_waitcnt vmcnt(5)
  s_nop 0
  buffer_load_dwordx4 v4, s[8:11], s58 offen offset:256 nt lds
  v_readlane_b32 s64, v0, 19
  s_add_u32 s58, s91, 1867776
  s_bfe_u32 s65, s64, 0x30004
  s_mulk_i32 s65, 12288
  v_add_u32 v44, s65, v3
  v_add_u32 v45, 4294868992, v44
  v_min_u32 v4, v44, v45
  s_add_u32 m0, s70, 21504
  s_waitcnt vmcnt(5)
  s_barrier
  s_nop 0
  buffer_load_dwordx4 v4, s[8:11], s58 offen offset:0 nt lds
  s_add_u32 m0, s70, 22400
  s_waitcnt vmcnt(5)
  s_nop 0
  buffer_load_dwordx4 v4, s[8:11], s58 offen offset:128 nt lds
  s_add_u32 m0, s70, 23296
  s_waitcnt vmcnt(5)
  s_nop 0
  buffer_load_dwordx4 v4, s[8:11], s58 offen offset:256 nt lds
  v_cmp_eq_u32 vcc, 0, v14
  s_cbranch_vccnz L_pw_spin
L_pw_ok:
  v_mov_b32 v44, v14
  s_nop 1
  v_permlane16_swap_b32 v14, v44
  v_min_f32 v44, v14, v44
  s_nop 1
  v_min_f32_dpp v44, v44, v44 quad_perm:[2,3,0,1] row_mask:0xf bank_mask:0xa
  s_nop 1
  v_mov_b32_dpp v45, v44 row_ror:8 row_mask:0xf bank_mask:0xf
  v_min_f32_dpp v46, v44, v44 quad_perm:[1,0,3,2] row_mask:0xf bank_mask:0xf
  s_nop 0
  v_min_f32_dpp v45, v45, v44 quad_perm:[1,0,3,2] row_mask:0xf bank_mask:0xf
  s_nop 1
  v_min_f32_dpp v45, v45, v45 quad_perm:[2,3,0,1] row_mask:0xf bank_mask:0xf
  s_nop 1
  v_min_f32_dpp v47, v45, v45 quad_perm:[1,0,3,2] row_mask:0xf bank_mask:0xf
  s_nop 1
  v_min_f32_dpp v47, v47, v47 row_half_mirror row_mask:0xf bank_mask:0xf
  v_mul_f32 v47, 0x3f95c28f, v47
  v_cmp_lt_f32 vcc, v46, v47
  s_nop 1
  v_cndmask_b32 v44, v45, v44, vcc
  s_nop 1
  v_mov_b32_dpp v45, v44 quad_perm:[1,0,3,2] row_mask:0xf bank_mask:0xf
  v_cmp_lt_f32 s[54:55], v45, v44
  s_lshl_b32 s78, s95, 3
  s_lshl_b32 s79, s72, 23
  s_sub_u32 s79, s91, s79
  s_sub_u32 s77, s63, 2
  s_lshl_b32 s77, s77, 22
  s_sub_u32 s77, s92, s77
  v_add_u32 v44, 0, v1
  v_mov_b32 v45, s79
  v_mov_b32 v46, s77
  v_cmp_le_u32 vcc, s78, v44
  v_mul_u32_u24 v44, 98304, v44
  s_nop 0
  v_cndmask_b32 v45, v45, v46, vcc
  v_cndmask_b32 v46, 0, 4, vcc
  v_cndmask_b32 v47, 3, 5, vcc
  v_add_u32 v44, v44, v45
  v_add_u32 v44, 49152, v44
  v_ashrrev_i32 v44, 21, v44
  v_med3_i32 v45, v44, v46, v47
  v_xor_b32 v44, v44, v45
  v_and_b32 v44, 1, v44
  v_and_b32 v47, 1, v45
  v_and_b32 v45, 6, v45
  v_lshl_add_u32 v47, v47, 3, v45
  v_bfe_u32 v45, s54, v47, 1
  v_cmp_ne_u32 s[44:45], v45, v44
  v_bfe_u32 v45, s55, v47, 1
  v_cmp_ne_u32 s[48:49], v45, v44
  v_add_u32 v44, 64, v1
  v_mov_b32 v45, s79
  v_mov_b32 v46, s77
  v_cmp_le_u32 vcc, s78, v44
  v_mul_u32_u24 v44, 98304, v44
  s_nop 0
  v_cndmask_b32 v45, v45, v46, vcc
  v_cndmask_b32 v46, 0, 4, vcc
  v_cndmask_b32 v47, 3, 5, vcc
  v_add_u32 v44, v44, v45
  v_add_u32 v44, 49152, v44
  v_ashrrev_i32 v44, 21, v44
  v_med3_i32 v45, v44, v46, v47
  v_xor_b32 v44, v44, v45
  v_and_b32 v44, 1, v44
  v_and_b32 v47, 1, v45
  v_and_b32 v45, 6, v45
  v_lshl_add_u32 v47, v47, 3, v45
  v_bfe_u32 v45, s54, v47, 1
  v_cmp_ne_u32 s[46:47], v45, v44
  v_bfe_u32 v45, s55, v47, 1
  v_cmp_ne_u32 s[50:51], v45, v44
  s_nop 1
  s_xor_b32 s66, s44, 0x84108
  s_and_b32 s66, s66, 0x94949
  s_xor_b32 s67, s45, 0x0
  s_and_b32 s67, s67, 0x0
  s_andn2_b32 s48, s48, 0x94949
  s_or_b32 s48, s48, 0x84108
  s_andn2_b32 s44, s44, 0x94949
  s_or_b32 s44, s44, 0x84108
  s_cmp_eq_u64 s[44:45], s[48:49]
  s_cselect_b32 s98, 0x80000000, 0
  s_cmp_eq_u64 s[46:47], s[50:51]
  s_cselect_b32 s99, 0x80000000, 0
  v_add_u32 v44, 0, v1
  v_mov_b32 v45, s91
  v_mul_u32_u24 v44, 98304, v44
  v_add_u32 v44, v44, v45
  v_add_u32 v44, 49152, v44
  v_lshrrev_b32 v45, 7, v44
  v_xor_b32 v44, v44, v45
  v_bfe_u32 v45, v44, 20, 1
  v_bfe_u32 v44, v44, 19, 1
  v_lshl_or_b32 v44, v44, 2, v45
  v_and_b32 v45, 1, v1
  v_mul_u32_u24 v45, 5, v45
  v_xor_b32 v44, v44, v45
  v_xor_b32 v44, s100, v44
  s_mov_b32 s54, 0x90140
  s_mov_b32 s55, 0x0
  v_cndmask_b32 v45, 0, 1, s[54:55]
  v_xor_b32 v44, v44, v45
  v_cndmask_b32 v45, 0, 2, s[48:49]
  v_xor_b32 v45, v45, v44
  v_mul_u32_u24 v45, 48, v45
  v_cndmask_b32 v46, 0, 2, s[44:45]
  v_xor_b32 v46, v46, v44
  v_mul_u32_u24 v46, 3, v46
  v_and_b32 v46, 7, v46
  v_and_b32 v45, 0x70, v45
  v_or_b32 v45, v45, v46
  v_mov_b32 v46, 0xf333cccc
  s_mov_b32 exec_lo, 0
  v_mov_b32 v46, 0xcc30cc30
  s_mov_b32 exec_lo, -1
  v_add_u32 v47, s68, v1
  v_bfe_u32 v46, v46, v47, 1
  v_cndmask_b32 v46, v46, 1, s[66:67]
  v_lshl_or_b32 v45, v46, 3, v45
  s_mov_b32 s54, 0xb6b6b6b6
  s_mov_b32 s55, 0xb6b6b6b6
  v_mbcnt_lo_u32_b32 v46, s54, 0
  v_mbcnt_hi_u32_b32 v46, s55, v46
  v_add_u32 v46, s68, v46
  s_mov_b32 s69, 0xa94a5294
  v_bfe_u32 v46, s69, v46, 1
  v_lshl_or_b32 v0, v46, 7, v45
  v_add_u32 v44, 64, v1
  v_mov_b32 v45, s91
  s_lshl_b32 s78, s95, 3
  v_cmp_le_u32 vcc, s78, v44
  v_mov_b32 v46, s92
  s_nop 0
  v_cndmask_b32 v45, v45, v46, vcc
  v_mul_u32_u24 v44, 98304, v44
  v_add_u32 v44, v44, v45
  v_add_u32 v44, 49152, v44
  v_lshrrev_b32 v45, 7, v44
  v_xor_b32 v44, v44, v45
  v_bfe_u32 v45, v44, 20, 1
  v_bfe_u32 v44, v44, 19, 1
  v_lshl_or_b32 v44, v44, 2, v45
  v_and_b32 v45, 1, v1
  v_mul_u32_u24 v45, 5, v45
  v_xor_b32 v44, v44, v45
  v_xor_b32 v44, s100, v44
  v_cndmask_b32 v45, 0, 2, s[50:51]
  v_xor_b32 v45, v45, v44
  v_mul_u32_u24 v45, 48, v45
  v_cndmask_b32 v46, 0, 2, s[46:47]
  v_xor_b32 v46, v46, v44
  v_mul_u32_u24 v46, 3, v46
  v_and_b32 v46, 7, v46
  v_and_b32 v45, 0x70, v45
  v_or_b32 v45, v45, v46
  v_mov_b32 v46, 0xcc30cc30
  s_mov_b32 exec_lo, 0
  v_mov_b32 v46, 0xcc30cc30
  s_mov_b32 exec_lo, -1
  v_add_u32 v47, s68, v1
  v_bfe_u32 v46, v46, v47, 1
  v_lshl_or_b32 v45, v46, 3, v45
  s_mov_b32 s54, 0xb6b6b6b6
  s_mov_b32 s55, 0xf6b6b6b6
  v_mbcnt_lo_u32_b32 v46, s54, 40
  v_mbcnt_hi_u32_b32 v46, s55, v46
  v_add_u32 v46, s68, v46
  s_mov_b32 s69, 0xa94a5294
  v_bfe_u32 v46, s69, v46, 1
  v_lshl_or_b32 v45, v46, 7, v45
  v_lshl_or_b32 v0, v45, 8, v0
  s_nop 0
  v_readlane_b32 s64, v0, 22
  s_add_u32 s58, s91, 2162688
  s_bfe_u32 s65, s64, 0x30004
  s_mulk_i32 s65, 12288
  v_add_u32 v44, s65, v3
  v_add_u32 v45, 4294868992, v44
  v_min_u32 v4, v44, v45
  s_add_u32 m0, s70, 24576
  s_waitcnt vmcnt(5)
  s_barrier
  s_nop 0
  buffer_load_dwordx4 v4, s[8:11], s58 offen offset:0 nt lds
  s_add_u32 m0, s70, 25472
  s_nop 0
  buffer_load_dwordx4 v4, s[8:11], s58 offen offset:128 nt lds
  s_add_u32 m0, s70, 26368
  s_waitcnt vmcnt(6)
  s_nop 0
  buffer_load_dwordx4 v4, s[8:11], s58 offen offset:256 nt lds
  v_readlane_b32 s64, v0, 24
  s_add_u32 s58, s91, 2359296
  s_bfe_u32 s65, s64, 0x30004
  s_mulk_i32 s65, 12288
  v_add_u32 v44, s65, v3
  v_add_u32 v45, 4294868992, v44
  v_min_u32 v4, v44, v45
  s_add_u32 m0, s70, 27648
  s_waitcnt vmcnt(5)
  s_barrier
  s_nop 0
  buffer_load_dwordx4 v4, s[8:11], s58 offen offset:0 nt lds
  s_add_u32 m0, s70, 28544
  s_nop 0
  buffer_load_dwordx4 v4, s[8:11], s58 offen offset:128 nt lds
  s_add_u32 m0, s70, 29440
  s_waitcnt vmcnt(6)
  s_nop 0
  buffer_load_dwordx4 v4, s[8:11], s58 offen offset:256 nt lds
  v_readlane_b32 s64, v0, 27
  s_add_u32 s58, s91, 2654208
  s_bfe_u32 s65, s64, 0x30004
  s_mulk_i32 s65, 12288
  v_add_u32 v44, s65, v3
  v_add_u32 v45, 4294868992, v44
  v_min_u32 v4, v44, v45
  s_add_u32 m0, s70, 30720
  s_waitcnt vmcnt(5)
  s_barrier
  s_nop 0
  buffer_load_dwordx4 v4, s[8:11], s58 offen offset:0 nt lds
  s_add_u32 m0, s70, 31616
  s_nop 0
  buffer_load_dwordx4 v4, s[8:11], s58 offen offset:128 nt lds
  s_add_u32 m0, s70, 32512
  s_waitcnt vmcnt(6)
  s_nop 0
  buffer_load_dwordx4 v4, s[8:11], s58 offen offset:256 nt lds
  v_readlane_b32 s64, v0, 30
  s_add_u32 s58, s91, 2949120
  s_bfe_u32 s65, s64, 0x30004
  s_mulk_i32 s65, 12288
  v_add_u32 v44, s65, v3
  v_add_u32 v45, 4294868992, v44
  v_min_u32 v4, v44, v45
  s_add_u32 m0, s70, 33792
  s_waitcnt vmcnt(5)
  s_barrier
  s_nop 0
  buffer_load_dwordx4 v4, s[8:11], s58 offen offset:0 nt lds
  s_add_u32 m0, s70, 34688
  s_nop 0
  buffer_load_dwordx4 v4, s[8:11], s58 offen offset:128 nt lds
  s_add_u32 m0, s70, 35584
  s_waitcnt vmcnt(6)
  s_nop 0
  buffer_load_dwordx4 v4, s[8:11], s58 offen offset:256 nt lds
  v_readlane_b32 s64, v0, 32
  s_add_u32 s58, s91, 3145728
  s_bfe_u32 s65, s64, 0x30004
  s_mulk_i32 s65, 12288
  v_add_u32 v44, s65, v3
  v_add_u32 v45, 4294868992, v44
  v_min_u32 v4, v44, v45
  s_waitcnt vmcnt(5)
  s_barrier
  buffer_load_dwordx4 a[0:3], v4, s[8:11], s58 offen offset:0 nt
  buffer_load_dwordx4 a[4:7], v4, s[8:11], s58 offen offset:128 nt
  s_waitcnt vmcnt(6)
  buffer_load_dwordx4 a[8:11], v4, s[8:11], s58 offen offset:256 nt
  v_readlane_b32 s64, v0, 35
  s_add_u32 s58, s91, 3440640
  s_bfe_u32 s65, s64, 0x30004
  s_mulk_i32 s65, 12288
  v_add_u32 v44, s65, v3
  v_add_u32 v45, 4294868992, v44
  v_min_u32 v4, v44, v45
  s_waitcnt vmcnt(5)
  s_barrier
  buffer_load_dwordx4 a[12:15], v4, s[8:11], s58 offen offset:0 nt
  buffer_load_dwordx4 a[16:19], v4, s[8:11], s58 offen offset:128 nt
  s_waitcnt vmcnt(6)
  buffer_load_dwordx4 a[20:23], v4, s[8:11], s58 offen offset:256 nt
  v_readlane_b32 s64, v0, 38
  s_add_u32 s58, s91, 3735552
  s_bfe_u32 s65, s64, 0x30004
  s_mulk_i32 s65, 12288
  v_add_u32 v44, s65, v3
  v_add_u32 v45, 4294868992, v44
  v_min_u32 v4, v44, v45
  s_waitcnt vmcnt(5)
  s_barrier
  buffer_load_dwordx4 a[24:27], v4, s[8:11], s58 offen offset:0 nt
  buffer_load_dwordx4 a[28:31], v4, s[8:11], s58 offen offset:128 nt
  s_waitcnt vmcnt(6)
  buffer_load_dwordx4 a[32:35], v4, s[8:11], s58 offen offset:256 nt
  v_readlane_b32 s64, v0, 40
  s_add_u32 s58, s91, 3932160
  s_bfe_u32 s65, s64, 0x30004
  s_mulk_i32 s65, 12288
  v_add_u32 v44, s65, v3
  v_add_u32 v45, 4294868992, v44
  v_min_u32 v4, v44, v45
  s_waitcnt vmcnt(5)
  s_barrier
  buffer_load_dwordx4 a[36:39], v4, s[8:11], s58 offen offset:0 nt
  buffer_load_dwordx4 a[40:43], v4, s[8:11], s58 offen offset:128 nt
  s_waitcnt vmcnt(6)
  buffer_load_dwordx4 a[44:47], v4, s[8:11], s58 offen offset:256 nt
  v_readlane_b32 s64, v0, 43
  s_add_u32 s58, s91, 4227072
  s_bfe_u32 s65, s64, 0x30004
  s_mulk_i32 s65, 12288
  v_add_u32 v44, s65, v3
  v_add_u32 v45, 4294868992, v44
  v_min_u32 v4, v44, v45
  s_waitcnt vmcnt(5)
  s_barrier
  buffer_load_dwordx4 a[48:51], v4, s[8:11], s58 offen offset:0 nt
  buffer_load_dwordx4 a[52:55], v4, s[8:11], s58 offen offset:128 nt
  s_waitcnt vmcnt(6)
  buffer_load_dwordx4 a[56:59], v4, s[8:11], s58 offen offset:256 nt
  v_readlane_b32 s64, v0, 46
  s_add_u32 s58, s91, 4521984
  s_bfe_u32 s65, s64, 0x30004
  s_mulk_i32 s65, 12288
  v_add_u32 v44, s65, v3
  v_add_u32 v45, 4294868992, v44
  v_min_u32 v4, v44, v45
  s_waitcnt vmcnt(5)
  s_barrier
  buffer_load_dwordx4 a[60:63], v4, s[8:11], s58 offen offset:0 nt
  buffer_load_dwordx4 a[64:67], v4, s[8:11], s58 offen offset:128 nt
  s_waitcnt vmcnt(6)
  buffer_load_dwordx4 a[68:71], v4, s[8:11], s58 offen offset:256 nt
  v_readlane_b32 s64, v0, 48
  s_add_u32 s58, s91, 4718592
  s_bfe_u32 s65, s64, 0x30004
  s_mulk_i32 s65, 12288
  v_add_u32 v44, s65, v3
  v_add_u32 v45, 4294868992, v44
  v_min_u32 v4, v44, v45
  s_waitcnt vmcnt(5)
  s_barrier
  buffer_load_dwordx4 a[72:75], v4, s[8:11], s58 offen offset:0 nt
  buffer_load_dwordx4 a[76:79], v4, s[8:11], s58 offen offset:128 nt
  s_waitcnt vmcnt(6)
  buffer_load_dwordx4 a[80:83], v4, s[8:11], s58 offen offset:256 nt
  v_readlane_b32 s64, v0, 51
  s_add_u32 s58, s91, 5013504
  s_bfe_u32 s65, s64, 0x30004
  s_mulk_i32 s65, 12288
  v_add_u32 v44, s65, v3
  v_add_u32 v45, 4294868992, v44
  v_min_u32 v4, v44, v45
  s_waitcnt vmcnt(5)
  s_barrier
  buffer_load_dwordx4 a[84:87], v4, s[8:11], s58 offen offset:0 nt
  buffer_load_dwordx4 a[88:91], v4, s[8:11], s58 offen offset:128 nt
  s_waitcnt vmcnt(6)
  buffer_load_dwordx4 a[92:95], v4, s[8:11], s58 offen offset:256 nt
  v_readlane_b32 s64, v0, 54
  s_add_u32 s58, s91, 5308416
  s_bfe_u32 s65, s64, 0x30004
  s_mulk_i32 s65, 12288
  v_add_u32 v44, s65, v3
  v_add_u32 v45, 4294868992, v44
  v_min_u32 v4, v44, v45
  s_waitcnt vmcnt(5)
  s_barrier
  buffer_load_dwordx4 a[96:99], v4, s[8:11], s58 offen offset:0 nt
  buffer_load_dwordx4 a[100:103], v4, s[8:11], s58 offen offset:128 nt
  s_waitcnt vmcnt(6)
  buffer_load_dwordx4 a[104:107], v4, s[8:11], s58 offen offset:256 nt
  v_readlane_b32 s64, v0, 56
  s_add_u32 s58, s91, 5505024
  s_bfe_u32 s65, s64, 0x30004
  s_mulk_i32 s65, 12288
  v_add_u32 v44, s65, v3
  v_add_u32 v45, 4294868992, v44
  v_min_u32 v4, v44, v45
  s_waitcnt vmcnt(5)
  s_barrier
  buffer_load_dwordx4 a[108:111], v4, s[8:11], s58 offen offset:0 nt
  buffer_load_dwordx4 a[112:115], v4, s[8:11], s58 offen offset:128 nt
  s_waitcnt vmcnt(6)
  buffer_load_dwordx4 a[116:119], v4, s[8:11], s58 offen offset:256 nt
  v_readlane_b32 s64, v0, 59
  s_add_u32 s58, s91, 5799936
  s_bfe_u32 s65, s64, 0x30004
  s_mulk_i32 s65, 12288
  v_add_u32 v44, s65, v3
  v_add_u32 v45, 4294868992, v44
  v_min_u32 v4, v44, v45
  s_waitcnt vmcnt(5)
  s_barrier
  buffer_load_dwordx4 a[120:123], v4, s[8:11], s58 offen offset:0 nt
  buffer_load_dwordx4 a[124:127], v4, s[8:11], s58 offen offset:128 nt
  s_waitcnt vmcnt(6)
  buffer_load_dwordx4 a[128:131], v4, s[8:11], s58 offen offset:256 nt
  v_readlane_b32 s64, v0, 62
  s_add_u32 s58, s91, 6094848
  s_bfe_u32 s65, s64, 0x30004
  s_mulk_i32 s65, 12288
  v_add_u32 v44, s65, v3
  v_add_u32 v45, 4294868992, v44
  v_min_u32 v4, v44, v45
  s_waitcnt vmcnt(5)
  s_barrier
  buffer_load_dwordx4 a[132:135], v4, s[8:11], s58 offen offset:0 nt
  buffer_load_dwordx4 a[136:139], v4, s[8:11], s58 offen offset:128 nt
  s_waitcnt vmcnt(6)
  buffer_load_dwordx4 a[140:143], v4, s[8:11], s58 offen offset:256 nt
  v_min_u32 v46, 47, v1
  v_lshlrev_b32 v46, 4, v46
  s_lshl_b32 s80, s96, 11
  s_add_u32 s80, s80, 2883584
  buffer_load_dword v14, off, s[40:43], 0 sc1
  buffer_load_dwordx4 v[84:87], v46, s[28:31], s80 offen offset:0 sc1
  buffer_load_dwordx4 v[88:91], v46, s[28:31], s80 offen offset:1024 sc1
  v_readlane_b32 s64, v0, 0
  s_add_u32 s58, s91, 6291456
  s_bfe_u32 s65, s64, 0x3000c
  s_mulk_i32 s65, 12288
  v_add_u32 v44, s65, v3
  v_add_u32 v45, 4294868992, v44
  v_min_u32 v4, v44, v45
  s_waitcnt vmcnt(5)
  s_barrier
  buffer_load_dwordx4 a[144:147], v4, s[8:11], s58 offen offset:0 nt
  s_waitcnt vmcnt(5)
  buffer_load_dwordx4 a[148:151], v4, s[8:11], s58 offen offset:128 nt
  s_waitcnt vmcnt(5)
  buffer_load_dwordx4 a[152:155], v4, s[8:11], s58 offen offset:256 nt
  v_readlane_b32 s64, v0, 3
  s_add_u32 s58, s91, 6586368
  s_bfe_u32 s65, s64, 0x3000c
  s_mulk_i32 s65, 12288
  v_add_u32 v44, s65, v3
  v_add_u32 v45, 4294868992, v44
  v_min_u32 v4, v44, v45
  s_waitcnt vmcnt(5)
  s_barrier
  buffer_load_dwordx4 a[156:159], v4, s[8:11], s58 offen offset:0 nt
  s_waitcnt vmcnt(5)
  buffer_load_dwordx4 a[160:163], v4, s[8:11], s58 offen offset:128 nt
  s_waitcnt vmcnt(5)
  buffer_load_dwordx4 a[164:167], v4, s[8:11], s58 offen offset:256 nt
  v_readfirstlane_b32 s77, v14
  s_cmp_lt_u32 s77, 64
  s_cbranch_scc1 L_all_spin
L_all_ok:
  v_bitop3_b32 v45, v84, v85, s75 bitop3:0x7e
  v_bitop3_b32 v45, v45, v86, s75 bitop3:0xf6
  v_bitop3_b32 v45, v45, v87, s75 bitop3:0xf6
  v_bitop3_b32 v45, v45, v88, s75 bitop3:0xf6
  v_bitop3_b32 v45, v45, v89, s75 bitop3:0xf6
  v_bitop3_b32 v45, v45, v90, s75 bitop3:0xf6
  v_bitop3_b32 v45, v45, v91, s75 bitop3:0xf6
  v_and_b32 v45, 1, v45
  v_cmp_ne_u32 vcc, 0, v45
  s_cbranch_vccz L_q0ok
  s_mov_b32 s86, 200000
L_poll_1:
  buffer_load_dwordx4 v[84:87], v46, s[28:31], s80 offen offset:0 sc1
  buffer_load_dwordx4 v[88:91], v46, s[28:31], s80 offen offset:1024 sc1
  s_waitcnt vmcnt(0)
  v_bitop3_b32 v45, v84, v85, s75 bitop3:0x7e
  v_bitop3_b32 v45, v45, v86, s75 bitop3:0xf6
  v_bitop3_b32 v45, v45, v87, s75 bitop3:0xf6
  v_bitop3_b32 v45, v45, v88, s75 bitop3:0xf6
  v_bitop3_b32 v45, v45, v89, s75 bitop3:0xf6
  v_bitop3_b32 v45, v45, v90, s75 bitop3:0xf6
  v_bitop3_b32 v45, v45, v91, s75 bitop3:0xf6
  v_and_b32 v45, 1, v45
  v_cmp_ne_u32 vcc, 0, v45
  s_cbranch_vccz L_pollx_2
  s_mov_b64 exec, vcc
  s_sub_u32 s86, s86, 1
  s_cmp_lg_u32 s86, 0
  s_cbranch_scc1 L_poll_1
L_pollx_2:
  s_mov_b64 exec, -1
L_q0ok:
  s_mul_i32 s77, s3, 384
  s_add_u32 s77, s77, 160000
  v_add_f32 v84, v84, v88
  v_add_f32 v85, v85, v89
  v_add_f32 v86, v86, v90
  v_add_f32 v87, v87, v91
  v_lshrrev_b32 v46, 1, v46
  v_cvt_pk_bf16_f32 v84, v84, v85
  v_cvt_pk_bf16_f32 v85, v86, v87
  v_add_u32 v46, s77, v46
  ds_write_b64 v46, v[84:85]
  v_bfe_u32 v45, v1, 3, 1
  v_lshlrev_b32 v45, 6, v45
  v_lshrrev_b32 v46, 4, v1
  v_lshl_add_u32 v45, v46, 4, v45
  v_add_u32 v45, 160000, v45
  s_waitcnt lgkmcnt(0)
  s_barrier
  ds_read_b128 v[80:83], v45 offset:0
  ds_read_b128 v[84:87], v45 offset:128
  ds_read_b128 v[88:91], v45 offset:256
  s_waitcnt lgkmcnt(0)
  v_readlane_b32 s64, v0, 6
  s_add_u32 s58, s91, 6881280
  s_bfe_u32 s65, s64, 0x3000c
  s_mulk_i32 s65, 12288
  v_add_u32 v44, s65, v3
  v_add_u32 v45, 4294868992, v44
  v_min_u32 v4, v44, v45
  s_waitcnt vmcnt(5)
  s_barrier
  buffer_load_dwordx4 a[168:171], v4, s[8:11], s58 offen offset:0 nt
  buffer_load_dwordx4 a[172:175], v4, s[8:11], s58 offen offset:128 nt
  s_waitcnt vmcnt(6)
  buffer_load_dwordx4 a[176:179], v4, s[8:11], s58 offen offset:256 nt
  v_readlane_b32 s64, v0, 8
  s_add_u32 s58, s91, 7077888
  s_bfe_u32 s65, s64, 0x3000c
  s_mulk_i32 s65, 12288
  v_add_u32 v44, s65, v3
  v_add_u32 v45, 4294868992, v44
  v_min_u32 v4, v44, v45
  s_waitcnt vmcnt(5)
  s_barrier
  buffer_load_dwordx4 a[180:183], v4, s[8:11], s58 offen offset:0 nt
  buffer_load_dwordx4 a[184:187], v4, s[8:11], s58 offen offset:128 nt
  s_waitcnt vmcnt(6)
  buffer_load_dwordx4 a[188:191], v4, s[8:11], s58 offen offset:256 nt
  v_readlane_b32 s64, v0, 11
  s_add_u32 s58, s91, 7372800
  s_bfe_u32 s65, s64, 0x3000c
  s_mulk_i32 s65, 12288
  v_add_u32 v44, s65, v3
  v_add_u32 v45, 4294868992, v44
  v_min_u32 v4, v44, v45
  s_waitcnt vmcnt(5)
  s_barrier
  buffer_load_dwordx4 a[192:195], v4, s[8:11], s58 offen offset:0 nt
  buffer_load_dwordx4 a[196:199], v4, s[8:11], s58 offen offset:128 nt
  s_waitcnt vmcnt(6)
  buffer_load_dwordx4 a[200:203], v4, s[8:11], s58 offen offset:256 nt
  v_readlane_b32 s64, v0, 14
  s_add_u32 s58, s91, 7667712
  s_bfe_u32 s65, s64, 0x3000c
  s_mulk_i32 s65, 12288
  v_add_u32 v44, s65, v3
  v_add_u32 v45, 4294868992, v44
  v_min_u32 v4, v44, v45
  s_waitcnt vmcnt(5)
  s_barrier
  buffer_load_dwordx4 a[204:207], v4, s[8:11], s58 offen offset:0 nt
  buffer_load_dwordx4 a[208:211], v4, s[8:11], s58 offen offset:128 nt
  s_waitcnt vmcnt(6)
  buffer_load_dwordx4 a[212:215], v4, s[8:11], s58 offen offset:256 nt
  v_readlane_b32 s64, v0, 16
  s_add_u32 s58, s93, 7864320
  s_bfe_u32 s65, s64, 0x3000c
  s_mulk_i32 s65, 12288
  v_add_u32 v44, s65, v3
  v_add_u32 v45, 4294868992, v44
  v_min_u32 v4, v44, v45
  s_waitcnt vmcnt(5)
  s_barrier
  buffer_load_dwordx4 a[216:219], v4, s[8:11], s58 offen offset:0 nt
  buffer_load_dwordx4 a[220:223], v4, s[8:11], s58 offen offset:128 nt
  s_waitcnt vmcnt(6)
  buffer_load_dwordx4 a[224:227], v4, s[8:11], s58 offen offset:256 nt
  v_readlane_b32 s64, v0, 19
  s_add_u32 s58, s93, 8159232
  s_bfe_u32 s65, s64, 0x3000c
  s_mulk_i32 s65, 12288
  v_add_u32 v44, s65, v3
  v_add_u32 v45, 4294868992, v44
  v_min_u32 v4, v44, v45
  s_waitcnt vmcnt(5)
  s_barrier
  buffer_load_dwordx4 a[228:231], v4, s[8:11], s58 offen offset:0 nt
  buffer_load_dwordx4 a[232:235], v4, s[8:11], s58 offen offset:128 nt
  s_waitcnt vmcnt(6)
  buffer_load_dwordx4 a[236:239], v4, s[8:11], s58 offen offset:256 nt
  v_readlane_b32 s64, v0, 22
  s_add_u32 s58, s93, 8454144
  s_bfe_u32 s65, s64, 0x3000c
  s_mulk_i32 s65, 12288
  v_add_u32 v44, s65, v3
  v_add_u32 v45, 4294868992, v44
  v_min_u32 v4, v44, v45
  s_waitcnt vmcnt(5)
  s_barrier
  buffer_load_dwordx4 a[240:243], v4, s[8:11], s58 offen offset:0 nt
  buffer_load_dwordx4 a[244:247], v4, s[8:11], s58 offen offset:128 nt
  s_waitcnt vmcnt(6)
  buffer_load_dwordx4 a[248:251], v4, s[8:11], s58 offen offset:256 nt
  v_readlane_b32 s64, v0, 24
  s_add_u32 s58, s92, 8650752
  s_bfe_u32 s65, s64, 0x3000c
  s_mulk_i32 s65, 12288
  v_add_u32 v44, s65, v3
  v_add_u32 v45, 4294868992, v44
  v_min_u32 v4, v44, v45
  s_waitcnt vmcnt(5)
  s_barrier
  buffer_load_dwordx4 a[252:255], v4, s[8:11], s58 offen offset:0 nt
  buffer_load_dwordx4 v[92:95], v4, s[8:11], s58 offen offset:128 nt
  s_waitcnt vmcnt(6)
  buffer_load_dwordx4 v[96:99], v4, s[8:11], s58 offen offset:256 nt
  v_readlane_b32 s64, v0, 27
  s_add_u32 s58, s92, 8945664
  s_bfe_u32 s65, s64, 0x3000c
  s_mulk_i32 s65, 12288
  v_add_u32 v44, s65, v3
  v_add_u32 v45, 4294868992, v44
  v_min_u32 v4, v44, v45
  s_waitcnt vmcnt(5)
  s_barrier
  buffer_load_dwordx4 v[100:103], v4, s[8:11], s58 offen offset:0 nt
  buffer_load_dwordx4 v[104:107], v4, s[8:11], s58 offen offset:128 nt
  s_waitcnt vmcnt(6)
  buffer_load_dwordx4 v[108:111], v4, s[8:11], s58 offen offset:256 nt
  v_readlane_b32 s64, v0, 30
  s_add_u32 s58, s92, 9240576
  s_bfe_u32 s65, s64, 0x3000c
  s_mulk_i32 s65, 12288
  v_add_u32 v44, s65, v3
  v_add_u32 v45, 4294868992, v44
  v_min_u32 v4, v44, v45
  s_waitcnt vmcnt(5)
  s_barrier
  buffer_load_dwordx4 v[112:115], v4, s[8:11], s58 offen offset:0 nt
  buffer_load_dwordx4 v[116:119], v4, s[8:11], s58 offen offset:128 nt
  s_waitcnt vmcnt(6)
  buffer_load_dwordx4 v[120:123], v4, s[8:11], s58 offen offset:256 nt
  v_readlane_b32 s64, v0, 32
  s_add_u32 s58, s92, 9437184
  s_bfe_u32 s65, s64, 0x3000c
  s_mulk_i32 s65, 12288
  v_add_u32 v44, s65, v3
  v_add_u32 v45, 4294868992, v44
  v_min_u32 v4, v44, v45
  s_waitcnt vmcnt(5)
  s_barrier
  buffer_load_dwordx4 v[124:127], v4, s[8:11], s58 offen offset:0 nt
  buffer_load_dwordx4 v[128:131], v4, s[8:11], s58 offen offset:128 nt
  s_waitcnt vmcnt(6)
  buffer_load_dwordx4 v[132:135], v4, s[8:11], s58 offen offset:256 nt
  v_readlane_b32 s64, v0, 35
  s_add_u32 s58, s92, 9732096
  s_bfe_u32 s65, s64, 0x3000c
  s_mulk_i32 s65, 12288
  v_add_u32 v44, s65, v3
  v_add_u32 v45, 4294868992, v44
  v_min_u32 v4, v44, v45
  s_waitcnt vmcnt(5)
  s_barrier
  buffer_load_dwordx4 v[136:139], v4, s[8:11], s58 offen offset:0 nt
  buffer_load_dwordx4 v[140:143], v4, s[8:11], s58 offen offset:128 nt
  s_waitcnt vmcnt(6)
  buffer_load_dwordx4 v[144:147], v4, s[8:11], s58 offen offset:256 nt
  v_readlane_b32 s64, v0, 38
  s_add_u32 s58, s92, 10027008
  s_bfe_u32 s65, s64, 0x3000c
  s_mulk_i32 s65, 12288
  v_add_u32 v44, s65, v3
  v_add_u32 v45, 4294868992, v44
  v_min_u32 v4, v44, v45
  s_waitcnt vmcnt(5)
  s_barrier
  buffer_load_dwordx4 v[148:151], v4, s[8:11], s58 offen offset:0 nt
  buffer_load_dwordx4 v[152:155], v4, s[8:11], s58 offen offset:128 nt
  s_waitcnt vmcnt(6)
  buffer_load_dwordx4 v[156:159], v4, s[8:11], s58 offen offset:256 nt
  v_readlane_b32 s64, v0, 40
  s_add_u32 s58, s92, 10223616
  s_bfe_u32 s65, s64, 0x3000c
  s_mulk_i32 s65, 12288
  v_add_u32 v44, s65, v3
  v_add_u32 v45, 4294868992, v44
  v_min_u32 v4, v44, v45
  s_waitcnt vmcnt(5)
  s_barrier
  buffer_load_dwordx4 v[160:163], v4, s[8:11], s58 offen offset:0 nt
  buffer_load_dwordx4 v[164:167], v4, s[8:11], s58 offen offset:128 nt
  s_waitcnt vmcnt(6)
  buffer_load_dwordx4 v[168:171], v4, s[8:11], s58 offen offset:256 nt
  v_readlane_b32 s64, v0, 43
  s_add_u32 s58, s92, 10518528
  s_bfe_u32 s65, s64, 0x3000c
  s_mulk_i32 s65, 12288
  v_add_u32 v44, s65, v3
  v_add_u32 v45, 4294868992, v44
  v_min_u32 v4, v44, v45
  s_waitcnt vmcnt(5)
  s_barrier
  buffer_load_dwordx4 v[172:175], v4, s[8:11], s58 offen offset:0 nt
  buffer_load_dwordx4 v[176:179], v4, s[8:11], s58 offen offset:128 nt
  s_waitcnt vmcnt(6)
  buffer_load_dwordx4 v[180:183], v4, s[8:11], s58 offen offset:256 nt
  v_readlane_b32 s64, v0, 46
  s_add_u32 s58, s92, 10813440
  s_bfe_u32 s65, s64, 0x3000c
  s_mulk_i32 s65, 12288
  v_add_u32 v44, s65, v3
  v_add_u32 v45, 4294868992, v44
  v_min_u32 v4, v44, v45
  s_waitcnt vmcnt(5)
  s_barrier
  buffer_load_dwordx4 v[184:187], v4, s[8:11], s58 offen offset:0 nt
  buffer_load_dwordx4 v[188:191], v4, s[8:11], s58 offen offset:128 nt
  s_waitcnt vmcnt(6)
  buffer_load_dwordx4 v[192:195], v4, s[8:11], s58 offen offset:256 nt
  v_readlane_b32 s64, v0, 48
  s_add_u32 s58, s92, 11010048
  s_bfe_u32 s65, s64, 0x3000c
  s_mulk_i32 s65, 12288
  v_add_u32 v44, s65, v3
  v_add_u32 v45, 4294868992, v44
  v_min_u32 v4, v44, v45
  s_waitcnt vmcnt(5)
  s_barrier
  buffer_load_dwordx4 v[196:199], v4, s[8:11], s58 offen offset:0 nt
  buffer_load_dwordx4 v[200:203], v4, s[8:11], s58 offen offset:128 nt
  s_waitcnt vmcnt(6)
  buffer_load_dwordx4 v[204:207], v4, s[8:11], s58 offen offset:256 nt
  v_readlane_b32 s64, v0, 51
  s_add_u32 s58, s92, 11304960
  s_bfe_u32 s65, s64, 0x3000c
  s_mulk_i32 s65, 12288
  v_add_u32 v44, s65, v3
  v_add_u32 v45, 4294868992, v44
  v_min_u32 v4, v44, v45
  s_waitcnt vmcnt(5)
  s_barrier
  buffer_load_dwordx4 v[208:211], v4, s[8:11], s58 offen offset:0 nt
  buffer_load_dwordx4 v[212:215], v4, s[8:11], s58 offen offset:128 nt
  s_waitcnt vmcnt(6)
  buffer_load_dwordx4 v[216:219], v4, s[8:11], s58 offen offset:256 nt
  v_readlane_b32 s64, v0, 54
  s_add_u32 s58, s92, 11599872
  s_bfe_u32 s65, s64, 0x3000c
  s_mulk_i32 s65, 12288
  v_add_u32 v44, s65, v3
  v_add_u32 v45, 4294868992, v44
  v_min_u32 v4, v44, v45
  s_waitcnt vmcnt(5)
  s_barrier
  buffer_load_dwordx4 v[220:223], v4, s[8:11], s58 offen offset:0 nt
  buffer_load_dwordx4 v[224:227], v4, s[8:11], s58 offen offset:128 nt
  s_waitcnt vmcnt(6)
  buffer_load_dwordx4 v[228:231], v4, s[8:11], s58 offen offset:256 nt
  v_readlane_b32 s64, v0, 56
  s_add_u32 s58, s92, 11796480
  s_bfe_u32 s65, s64, 0x3000c
  s_mulk_i32 s65, 12288
  v_add_u32 v44, s65, v3
  v_add_u32 v45, 4294868992, v44
  v_min_u32 v4, v44, v45
  s_waitcnt vmcnt(5)
  s_barrier
  buffer_load_dwordx4 v[232:235], v4, s[8:11], s58 offen offset:0 nt
  buffer_load_dwordx4 v[236:239], v4, s[8:11], s58 offen offset:128 nt
  s_waitcnt vmcnt(6)
  buffer_load_dwordx4 v[240:243], v4, s[8:11], s58 offen offset:256 nt
  v_readlane_b32 s64, v0, 59
  s_add_u32 s58, s92, 12091392
  s_bfe_u32 s65, s64, 0x3000c
  s_mulk_i32 s65, 12288
  v_add_u32 v44, s65, v3
  v_add_u32 v45, 4294868992, v44
  v_min_u32 v4, v44, v45
  s_waitcnt vmcnt(5)
  s_barrier
  buffer_load_dwordx4 v[244:247], v4, s[8:11], s58 offen offset:0 nt
  buffer_load_dwordx4 v[248:251], v4, s[8:11], s58 offen offset:128 nt
  s_waitcnt vmcnt(6)
  buffer_load_dwordx4 v[252:255], v4, s[8:11], s58 offen offset:256 nt
  s_barrier
  s_mov_b32 s58, s91
  s_mov_b32 s59, 0
  s_mov_b32 s101, 0
  v_readlane_b32 s64, v0, s59
  s_lshr_b32 s64, s64, s101
  s_and_b32 s65, s64, 7
  s_mulk_i32 s65, 12288
  v_add_u32 v44, s65, v2
  v_add_u32 v45, 4294868992, v44
  v_min_u32 v4, v44, v45
  s_bitcmp1_b32 s64, 3
  s_waitcnt vmcnt(5)
  s_cbranch_scc1 L_ma_3
  buffer_load_dwordx4 v[48:51], v4, s[4:7], s58 offen offset:0 nt
L_mb_4:
  s_bitcmp1_b32 s64, 3
  s_waitcnt vmcnt(5)
  s_cbranch_scc1 L_ma_5
  buffer_load_dwordx4 v[52:55], v4, s[4:7], s58 offen offset:128 nt
L_mb_6:
  s_bitcmp1_b32 s64, 3
  s_waitcnt vmcnt(5)
  s_cbranch_scc1 L_ma_7
  buffer_load_dwordx4 v[56:59], v4, s[4:7], s58 offen offset:256 nt
L_mb_8:
  s_add_u32 s59, s59, 1
  s_add_u32 s58, s58, 98304
  v_readlane_b32 s64, v0, s59
  s_lshr_b32 s64, s64, s101
  s_and_b32 s65, s64, 7
  s_mulk_i32 s65, 12288
  v_add_u32 v44, s65, v2
  v_add_u32 v45, 4294868992, v44
  v_min_u32 v4, v44, v45
  s_bitcmp1_b32 s64, 3
  s_waitcnt vmcnt(5)
  s_cbranch_scc1 L_ma_9
  buffer_load_dwordx4 v[60:63], v4, s[4:7], s58 offen offset:0 nt
L_mb_10:
  s_bitcmp1_b32 s64, 3
  s_waitcnt vmcnt(5)
  s_cbranch_scc1 L_ma_11
  buffer_load_dwordx4 v[64:67], v4, s[4:7], s58 offen offset:128 nt
L_mb_12:
  s_bitcmp1_b32 s64, 3
  s_waitcnt vmcnt(5)
  s_cbranch_scc1 L_ma_13
  buffer_load_dwordx4 v[68:71], v4, s[4:7], s58 offen offset:256 nt
L_mb_14:
  s_add_u32 s59, s59, 1
  s_add_u32 s58, s58, 98304
  v_readlane_b32 s64, v0, s59
  s_lshr_b32 s64, s64, s101
  s_and_b32 s65, s64, 7
  s_mulk_i32 s65, 12288
  v_add_u32 v44, s65, v2
  v_add_u32 v45, 4294868992, v44
  v_min_u32 v4, v44, v45
  s_bitcmp1_b32 s64, 3
  s_waitcnt vmcnt(5)
  s_cbranch_scc1 L_ma_15
  buffer_load_dwordx4 v[72:75], v4, s[4:7], s58 offen offset:0 nt
L_mb_16:
  s_mov_b32 s61, 15
L_kloop0:
  s_bitcmp1_b32 s64, 3
  s_waitcnt vmcnt(6)
  s_cbranch_scc1 L_ma_17
  buffer_load_dwordx4 v[76:79], v4, s[4:7], s58 offen offset:128 nt
L_mb_18:
  v_mfma_f32_16x16x32_bf16 v[16:19], v[48:51], v[80:83], 0
  s_bitcmp1_b32 s64, 3
  s_waitcnt vmcnt(6)
  s_cbranch_scc1 L_ma_19
  buffer_load_dwordx4 v[48:51], v4, s[4:7], s58 offen offset:256 nt
L_mb_20:
  v_mfma_f32_16x16x32_bf16 v[16:19], v[52:55], v[84:87], v[16:19]
  s_add_u32 s59, s59, 1
  s_add_u32 s58, s58, 98304
  v_readlane_b32 s64, v0, s59
  s_lshr_b32 s64, s64, s101
  s_and_b32 s65, s64, 7
  s_mulk_i32 s65, 12288
  v_add_u32 v44, s65, v2
  v_add_u32 v45, 4294868992, v44
  v_min_u32 v4, v44, v45
  s_waitcnt vmcnt(5)
  s_bitcmp1_b32 s64, 3
  s_waitcnt vmcnt(6)
  s_barrier
  s_cbranch_scc1 L_ma_21
  buffer_load_dwordx4 v[52:55], v4, s[4:7], s58 offen offset:0 nt
L_mb_22:
  v_mfma_f32_16x16x32_bf16 v[16:19], v[56:59], v[88:91], v[16:19]
  s_mov_b32 vcc_lo, 0x1010101
  s_mov_b32 vcc_hi, vcc_lo
  s_nop 5
  v_add_f32_dpp v14, v17, v16 row_ror:8 row_mask:0xf bank_mask:0x3
  v_add_f32_dpp v14, v18, v19 row_ror:8 row_mask:0xf bank_mask:0xc
  v_cndmask_b32 v12, v12, v14, vcc
  s_bitcmp1_b32 s64, 3
  s_waitcnt vmcnt(6)
  s_cbranch_scc1 L_ma_23
  buffer_load_dwordx4 v[56:59], v4, s[4:7], s58 offen offset:128 nt
L_mb_24:
  v_mfma_f32_16x16x32_bf16 v[16:19], v[60:63], v[80:83], 0
  s_bitcmp1_b32 s64, 3
  s_waitcnt vmcnt(6)
  s_cbranch_scc1 L_ma_25
  buffer_load_dwordx4 v[60:63], v4, s[4:7], s58 offen offset:256 nt
L_mb_26:
  v_mfma_f32_16x16x32_bf16 v[16:19], v[64:67], v[84:87], v[16:19]
  s_add_u32 s59, s59, 1
  s_add_u32 s58, s58, 98304
  v_readlane_b32 s64, v0, s59
  s_lshr_b32 s64, s64, s101
  s_and_b32 s65, s64, 7
  s_mulk_i32 s65, 12288
  v_add_u32 v44, s65, v2
  v_add_u32 v45, 4294868992, v44
  v_min_u32 v4, v44, v45
  s_waitcnt vmcnt(5)
  s_bitcmp1_b32 s64, 3
  s_waitcnt vmcnt(6)
  s_barrier
  s_cbranch_scc1 L_ma_27
  buffer_load_dwordx4 v[64:67], v4, s[4:7], s58 offen offset:0 nt
L_mb_28:
  v_mfma_f32_16x16x32_bf16 v[16:19], v[68:71], v[88:91], v[16:19]
  s_mov_b32 vcc_lo, 0x2020202
  s_mov_b32 vcc_hi, vcc_lo
  s_nop 5
  v_add_f32_dpp v14, v17, v16 row_ror:8 row_mask:0xf bank_mask:0x3
  v_add_f32_dpp v14, v18, v19 row_ror:8 row_mask:0xf bank_mask:0xc
  v_cndmask_b32 v12, v12, v14, vcc
  s_bitcmp1_b32 s64, 3
  s_waitcnt vmcnt(6)
  s_cbranch_scc1 L_ma_29
  buffer_load_dwordx4 v[68:71], v4, s[4:7], s58 offen offset:128 nt
L_mb_30:
  v_mfma_f32_16x16x32_bf16 v[16:19], v[72:75], v[80:83], 0
  s_bitcmp1_b32 s64, 3
  s_waitcnt vmcnt(6)
  s_cbranch_scc1 L_ma_31
  buffer_load_dwordx4 v[72:75], v4, s[4:7], s58 offen offset:256 nt
L_mb_32:
  v_mfma_f32_16x16x32_bf16 v[16:19], v[76:79], v[84:87], v[16:19]
  s_add_u32 s59, s59, 1
  s_add_u32 s58, s58, 98304
  v_readlane_b32 s64, v0, s59
  s_lshr_b32 s64, s64, s101
  s_and_b32 s65, s64, 7
  s_mulk_i32 s65, 12288
  v_add_u32 v44, s65, v2
  v_add_u32 v45, 4294868992, v44
  v_min_u32 v4, v44, v45
  s_waitcnt vmcnt(5)
  s_bitcmp1_b32 s64, 3
  s_waitcnt vmcnt(6)
  s_barrier
  s_cbranch_scc1 L_ma_33
  buffer_load_dwordx4 v[76:79], v4, s[4:7], s58 offen offset:0 nt
L_mb_34:
  v_mfma_f32_16x16x32_bf16 v[16:19], v[48:51], v[88:91], v[16:19]
  s_mov_b32 vcc_lo, 0x4040404
  s_mov_b32 vcc_hi, vcc_lo
  s_nop 5
  v_add_f32_dpp v14, v17, v16 row_ror:8 row_mask:0xf bank_mask:0x3
  v_add_f32_dpp v14, v18, v19 row_ror:8 row_mask:0xf bank_mask:0xc
  v_cndmask_b32 v12, v12, v14, vcc
  s_bitcmp1_b32 s64, 3
  s_waitcnt vmcnt(6)
  s_cbranch_scc1 L_ma_35
  buffer_load_dwordx4 v[48:51], v4, s[4:7], s58 offen offset:128 nt
L_mb_36:
  v_mfma_f32_16x16x32_bf16 v[16:19], v[52:55], v[80:83], 0
  s_bitcmp1_b32 s64, 3
  s_waitcnt vmcnt(6)
  s_cbranch_scc1 L_ma_37
  buffer_load_dwordx4 v[52:55], v4, s[4:7], s58 offen offset:256 nt
L_mb_38:
  v_mfma_f32_16x16x32_bf16 v[16:19], v[56:59], v[84:87], v[16:19]
  s_add_u32 s59, s59, 1
  s_add_u32 s58, s58, 98304
  v_readlane_b32 s64, v0, s59
  s_lshr_b32 s64, s64, s101
  s_and_b32 s65, s64, 7
  s_mulk_i32 s65, 12288
  v_add_u32 v44, s65, v2
  v_add_u32 v45, 4294868992, v44
  v_min_u32 v4, v44, v45
  s_waitcnt vmcnt(5)
  s_bitcmp1_b32 s64, 3
  s_waitcnt vmcnt(6)
  s_barrier
  s_cbranch_scc1 L_ma_39
  buffer_load_dwordx4 v[56:59], v4, s[4:7], s58 offen offset:0 nt
L_mb_40:
  v_mfma_f32_16x16x32_bf16 v[16:19], v[60:63], v[88:91], v[16:19]
  s_mov_b32 vcc_lo, 0x8080808
  s_mov_b32 vcc_hi, vcc_lo
  s_nop 5
  v_add_f32_dpp v14, v17, v16 row_ror:8 row_mask:0xf bank_mask:0x3
  v_add_f32_dpp v14, v18, v19 row_ror:8 row_mask:0xf bank_mask:0xc
  v_cndmask_b32 v12, v12, v14, vcc
  s_bitcmp1_b32 s64, 3
  s_waitcnt vmcnt(6)
  s_cbranch_scc1 L_ma_41
  buffer_load_dwordx4 v[60:63], v4, s[4:7], s58 offen offset:128 nt
L_mb_42:
  v_mfma_f32_16x16x32_bf16 v[16:19], v[64:67], v[80:83], 0
  s_bitcmp1_b32 s64, 3
  s_waitcnt vmcnt(6)
  s_cbranch_scc1 L_ma_43
  buffer_load_dwordx4 v[64:67], v4, s[4:7], s58 offen offset:256 nt
L_mb_44:
  v_mfma_f32_16x16x32_bf16 v[16:19], v[68:71], v[84:87], v[16:19]
  s_add_u32 s59, s59, 1
  s_add_u32 s58, s58, 98304
  v_readlane_b32 s64, v0, s59
  s_lshr_b32 s64, s64, s101
  s_and_b32 s65, s64, 7
  s_mulk_i32 s65, 12288
  v_add_u32 v44, s65, v2
  v_add_u32 v45, 4294868992, v44
  v_min_u32 v4, v44, v45
  s_waitcnt vmcnt(5)
  s_bitcmp1_b32 s64, 3
  s_waitcnt vmcnt(6)
  s_barrier
  s_cbranch_scc1 L_ma_45
  buffer_load_dwordx4 v[68:71], v4, s[4:7], s58 offen offset:0 nt
L_mb_46:
  v_mfma_f32_16x16x32_bf16 v[16:19], v[72:75], v[88:91], v[16:19]
  s_mov_b32 vcc_lo, 0x10101010
  s_mov_b32 vcc_hi, vcc_lo
  s_nop 5
  v_add_f32_dpp v14, v17, v16 row_ror:8 row_mask:0xf bank_mask:0x3
  v_add_f32_dpp v14, v18, v19 row_ror:8 row_mask:0xf bank_mask:0xc
  v_cndmask_b32 v12, v12, v14, vcc
  s_bitcmp1_b32 s64, 3
  s_waitcnt vmcnt(6)
  s_cbranch_scc1 L_ma_47
  buffer_load_dwordx4 v[72:75], v4, s[4:7], s58 offen offset:128 nt
L_mb_48:
  v_mfma_f32_16x16x32_bf16 v[16:19], v[76:79], v[80:83], 0
  s_bitcmp1_b32 s64, 3
  s_waitcnt vmcnt(6)
  s_cbranch_scc1 L_ma_49
  buffer_load_dwordx4 v[76:79], v4, s[4:7], s58 offen offset:256 nt
L_mb_50:
  v_mfma_f32_16x16x32_bf16 v[16:19], v[48:51], v[84:87], v[16:19]
  s_add_u32 s59, s59, 1
  s_add_u32 s58, s58, 98304
  v_readlane_b32 s64, v0, s59
  s_lshr_b32 s77, s59, 3
  s_and_b32 s101, s77, 8
  s_cmp_ge_u32 s77, s95
  s_cselect_b32 s78, s92, s91
  s_mul_i32 s58, s59, 98304
  s_add_u32 s58, s58, s78
  s_lshr_b32 s64, s64, s101
  s_and_b32 s65, s64, 7
  s_mulk_i32 s65, 12288
  v_add_u32 v44, s65, v2
  v_add_u32 v45, 4294868992, v44
  v_min_u32 v4, v44, v45
  s_waitcnt vmcnt(5)
  s_bitcmp1_b32 s64, 3
  s_waitcnt vmcnt(6)
  s_barrier
  s_cbranch_scc1 L_ma_51
  buffer_load_dwordx4 v[48:51], v4, s[4:7], s58 offen offset:0 nt
L_mb_52:
  v_mfma_f32_16x16x32_bf16 v[16:19], v[52:55], v[88:91], v[16:19]
  s_mov_b32 vcc_lo, 0x20202020
  s_mov_b32 vcc_hi, vcc_lo
  s_nop 5
  v_add_f32_dpp v14, v17, v16 row_ror:8 row_mask:0xf bank_mask:0x3
  v_add_f32_dpp v14, v18, v19 row_ror:8 row_mask:0xf bank_mask:0xc
  v_cndmask_b32 v12, v12, v14, vcc
  s_bitcmp1_b32 s64, 3
  s_waitcnt vmcnt(6)
  s_cbranch_scc1 L_ma_53
  buffer_load_dwordx4 v[52:55], v4, s[4:7], s58 offen offset:128 nt
L_mb_54:
  v_mfma_f32_16x16x32_bf16 v[16:19], v[56:59], v[80:83], 0
  s_bitcmp1_b32 s64, 3
  s_waitcnt vmcnt(6)
  s_cbranch_scc1 L_ma_55
  buffer_load_dwordx4 v[56:59], v4, s[4:7], s58 offen offset:256 nt
L_mb_56:
  v_mfma_f32_16x16x32_bf16 v[16:19], v[60:63], v[84:87], v[16:19]
  s_add_u32 s59, s59, 1
  s_add_u32 s58, s58, 98304
  v_readlane_b32 s64, v0, s59
  s_lshr_b32 s64, s64, s101
  s_and_b32 s65, s64, 7
  s_mulk_i32 s65, 12288
  v_add_u32 v44, s65, v2
  v_add_u32 v45, 4294868992, v44
  v_min_u32 v4, v44, v45
  s_waitcnt vmcnt(5)
  s_bitcmp1_b32 s64, 3
  s_waitcnt vmcnt(6)
  s_barrier
  s_cbranch_scc1 L_ma_57
  buffer_load_dwordx4 v[60:63], v4, s[4:7], s58 offen offset:0 nt
L_mb_58:
  v_mfma_f32_16x16x32_bf16 v[16:19], v[64:67], v[88:91], v[16:19]
  s_mov_b32 vcc_lo, 0x40404040
  s_mov_b32 vcc_hi, vcc_lo
  s_nop 5
  v_add_f32_dpp v14, v17, v16 row_ror:8 row_mask:0xf bank_mask:0x3
  v_add_f32_dpp v14, v18, v19 row_ror:8 row_mask:0xf bank_mask:0xc
  v_cndmask_b32 v12, v12, v14, vcc
  s_bitcmp1_b32 s64, 3
  s_waitcnt vmcnt(6)
  s_cbranch_scc1 L_ma_59
  buffer_load_dwordx4 v[64:67], v4, s[4:7], s58 offen offset:128 nt
L_mb_60:
  v_mfma_f32_16x16x32_bf16 v[16:19], v[68:71], v[80:83], 0
  s_bitcmp1_b32 s64, 3
  s_waitcnt vmcnt(6)
  s_cbranch_scc1 L_ma_61
  buffer_load_dwordx4 v[68:71], v4, s[4:7], s58 offen offset:256 nt
L_mb_62:
  v_mfma_f32_16x16x32_bf16 v[16:19], v[72:75], v[84:87], v[16:19]
  s_add_u32 s59, s59, 1
  s_add_u32 s58, s58, 98304
  v_readlane_b32 s64, v0, s59
  s_lshr_b32 s64, s64, s101
  s_and_b32 s65, s64, 7
  s_mulk_i32 s65, 12288
  v_add_u32 v44, s65, v2
  v_add_u32 v45, 4294868992, v44
  v_min_u32 v4, v44, v45
  s_waitcnt vmcnt(5)
  s_bitcmp1_b32 s64, 3
  s_waitcnt vmcnt(6)
  s_barrier
  s_cbranch_scc1 L_ma_63
  buffer_load_dwordx4 v[72:75], v4, s[4:7], s58 offen offset:0 nt
L_mb_64:
  v_mfma_f32_16x16x32_bf16 v[16:19], v[76:79], v[88:91], v[16:19]
  s_mov_b32 vcc_lo, 0x80808080
  s_mov_b32 vcc_hi, vcc_lo
  s_nop 5
  v_add_f32_dpp v14, v17, v16 row_ror:8 row_mask:0xf bank_mask:0x3
  v_add_f32_dpp v14, v18, v19 row_ror:8 row_mask:0xf bank_mask:0xc
  v_cndmask_b32 v12, v12, v14, vcc
  v_cvt_pk_bf16_f32 v12, 0, v12
  v_mul_f32 v14, 0x3d93cd3a, v12
  v_cvt_pk_bf16_f32 v14, v14, v14
  v_alignbit_b32 v36, v37, v36, 16
  v_alignbit_b32 v37, v38, v37, 16
  v_alignbit_b32 v38, v39, v38, 16
  v_alignbit_b32 v39, v14, v39, 16
  s_cmp_eq_u32 s61, 8
  s_cbranch_scc1 L_stA0
  s_cmp_eq_u32 s61, 7
  s_cbranch_scc1 L_flagA0
  s_sub_u32 s77, 16, s61
  s_cmp_eq_u32 s77, s94
  s_cbranch_scc1 L_q10
  s_cmp_eq_u32 s77, s95
  s_cbranch_scc1 L_q20
L_flagA0_r:
  s_sub_u32 s61, s61, 1
  s_cmp_lg_u32 s61, 0
  s_cbranch_scc1 L_kloop0
  s_bitcmp1_b32 s64, 3
  s_waitcnt vmcnt(6)
  s_cbranch_scc1 L_ma_65
  buffer_load_dwordx4 v[76:79], v4, s[4:7], s58 offen offset:128 nt
L_mb_66:
  v_mfma_f32_16x16x32_bf16 v[16:19], v[48:51], v[80:83], 0
  s_xor_b32 s71, s2, 4
  s_lshl_b32 s71, s71, 7
  s_add_u32 s71, s71, 2621440
  v_mov_b32 v47, s98
  buffer_load_dword v47, v47, s[28:31], s71 offen sc1 nt
  s_bitcmp1_b32 s64, 3
  s_waitcnt vmcnt(7)
  s_cbranch_scc1 L_ma_67
  buffer_load_dwordx4 v[48:51], v4, s[4:7], s58 offen offset:256 nt
L_mb_68:
  v_mfma_f32_16x16x32_bf16 v[16:19], v[52:55], v[84:87], v[16:19]
  s_add_u32 s59, s59, 1
  s_add_u32 s58, s58, 98304
  v_readlane_b32 s64, v0, s59
  s_lshr_b32 s64, s64, s101
  s_and_b32 s65, s64, 7
  s_mulk_i32 s65, 12288
  v_add_u32 v44, s65, v2
  v_add_u32 v45, 4294868992, v44
  v_min_u32 v4, v44, v45
  s_waitcnt vmcnt(6)
  s_bitcmp1_b32 s64, 3
  s_waitcnt vmcnt(7)
  s_barrier
  s_cbranch_scc1 L_ma_69
  buffer_load_dwordx4 v[52:55], v4, s[4:7], s58 offen offset:0 nt
L_mb_70:
  v_mfma_f32_16x16x32_bf16 v[16:19], v[56:59], v[88:91], v[16:19]
  s_mov_b32 vcc_lo, 0x1010101
  s_mov_b32 vcc_hi, vcc_lo
  s_nop 5
  v_add_f32_dpp v14, v17, v16 row_ror:8 row_mask:0xf bank_mask:0x3
  v_add_f32_dpp v14, v18, v19 row_ror:8 row_mask:0xf bank_mask:0xc
  v_cndmask_b32 v12, v12, v14, vcc
  s_bitcmp1_b32 s64, 3
  s_waitcnt vmcnt(7)
  s_cbranch_scc1 L_ma_71
  buffer_load_dwordx4 v[56:59], v4, s[4:7], s58 offen offset:128 nt
L_mb_72:
  v_mfma_f32_16x16x32_bf16 v[16:19], v[60:63], v[80:83], 0
  s_bitcmp1_b32 s64, 3
  s_waitcnt vmcnt(7)
  s_cbranch_scc1 L_ma_73
  buffer_load_dwordx4 v[60:63], v4, s[4:7], s58 offen offset:256 nt
L_mb_74:
  v_mfma_f32_16x16x32_bf16 v[16:19], v[64:67], v[84:87], v[16:19]
  s_add_u32 s59, s59, 1
  s_add_u32 s58, s58, 98304
  v_readlane_b32 s64, v0, s59
  s_lshr_b32 s64, s64, s101
  s_and_b32 s65, s64, 7
  s_mulk_i32 s65, 12288
  v_add_u32 v44, s65, v2
  v_add_u32 v45, 4294868992, v44
  v_min_u32 v4, v44, v45
  s_waitcnt vmcnt(6)
  s_bitcmp1_b32 s64, 3
  s_waitcnt vmcnt(7)
  s_barrier
  s_cbranch_scc1 L_ma_75
  buffer_load_dwordx4 v[64:67], v4, s[4:7], s58 offen offset:0 nt
L_mb_76:
  v_mfma_f32_16x16x32_bf16 v[16:19], v[68:71], v[88:91], v[16:19]
  s_mov_b32 vcc_lo, 0x2020202
  s_mov_b32 vcc_hi, vcc_lo
  s_nop 5
  v_add_f32_dpp v14, v17, v16 row_ror:8 row_mask:0xf bank_mask:0x3
  v_add_f32_dpp v14, v18, v19 row_ror:8 row_mask:0xf bank_mask:0xc
  v_cndmask_b32 v12, v12, v14, vcc
  s_bitcmp1_b32 s64, 3
  s_waitcnt vmcnt(7)
  s_cbranch_scc1 L_ma_77
  buffer_load_dwordx4 v[68:71], v4, s[4:7], s58 offen offset:128 nt
L_mb_78:
  v_mfma_f32_16x16x32_bf16 v[16:19], v[72:75], v[80:83], 0
  s_bitcmp1_b32 s64, 3
  s_waitcnt vmcnt(7)
  s_cbranch_scc1 L_ma_79
  buffer_load_dwordx4 v[72:75], v4, s[4:7], s58 offen offset:256 nt
L_mb_80:
  v_mfma_f32_16x16x32_bf16 v[16:19], v[76:79], v[84:87], v[16:19]
  s_add_u32 s59, s59, 1
  s_add_u32 s58, s58, 98304
  v_readlane_b32 s64, v0, s59
  s_lshr_b32 s64, s64, s101
  s_and_b32 s65, s64, 7
  s_mulk_i32 s65, 12288
  v_add_u32 v44, s65, v2
  v_add_u32 v45, 4294868992, v44
  v_min_u32 v4, v44, v45
  s_waitcnt vmcnt(5)
  s_bitcmp1_b32 s64, 3
  s_waitcnt vmcnt(6)
  s_barrier
  s_cbranch_scc1 L_ma_81
  buffer_load_dwordx4 v[76:79], v4, s[4:7], s58 offen offset:0 nt
L_mb_82:
  v_mfma_f32_16x16x32_bf16 v[16:19], v[48:51], v[88:91], v[16:19]
  v_readfirstlane_b32 s77, v47
  s_or_b32 s78, s88, s98
  s_cmp_lt_i32 s77, s78
  s_cbranch_scc1 L_fs_83
L_fk_84:
  v_lshl_or_b32 v46, v1, 4, s98
  s_xor_b32 s77, s87, 0x8000
  buffer_load_dwordx4 v[40:43], v46, s[28:31], s77 offen offset:0 sc1 nt
  s_mov_b32 vcc_lo, 0x4040404
  s_mov_b32 vcc_hi, vcc_lo
  s_nop 5
  v_add_f32_dpp v14, v17, v16 row_ror:8 row_mask:0xf bank_mask:0x3
  v_add_f32_dpp v14, v18, v19 row_ror:8 row_mask:0xf bank_mask:0xc
  v_cndmask_b32 v12, v12, v14, vcc
  s_bitcmp1_b32 s64, 3
  s_waitcnt vmcnt(7)
  s_cbranch_scc1 L_ma_85
  buffer_load_dwordx4 v[48:51], v4, s[4:7], s58 offen offset:128 nt
L_mb_86:
  v_mfma_f32_16x16x32_bf16 v[16:19], v[52:55], v[80:83], 0
  s_bitcmp1_b32 s64, 3
  s_waitcnt vmcnt(7)
  s_cbranch_scc1 L_ma_87
  buffer_load_dwordx4 v[52:55], v4, s[4:7], s58 offen offset:256 nt
L_mb_88:
  v_mfma_f32_16x16x32_bf16 v[16:19], v[56:59], v[84:87], v[16:19]
  s_add_u32 s59, s59, 1
  s_add_u32 s58, s58, 98304
  v_readlane_b32 s64, v0, s59
  s_lshr_b32 s64, s64, s101
  s_and_b32 s65, s64, 7
  s_mulk_i32 s65, 12288
  v_add_u32 v44, s65, v2
  v_add_u32 v45, 4294868992, v44
  v_min_u32 v4, v44, v45
  s_waitcnt vmcnt(6)
  s_bitcmp1_b32 s64, 3
  s_waitcnt vmcnt(7)
  s_barrier
  s_cbranch_scc1 L_ma_89
  buffer_load_dwordx4 v[56:59], v4, s[4:7], s58 offen offset:0 nt
L_mb_90:
  v_mfma_f32_16x16x32_bf16 v[16:19], v[60:63], v[88:91], v[16:19]
  s_mov_b32 vcc_lo, 0x8080808
  s_mov_b32 vcc_hi, vcc_lo
  s_nop 5
  v_add_f32_dpp v14, v17, v16 row_ror:8 row_mask:0xf bank_mask:0x3
  v_add_f32_dpp v14, v18, v19 row_ror:8 row_mask:0xf bank_mask:0xc
  v_cndmask_b32 v12, v12, v14, vcc
  s_bitcmp1_b32 s64, 3
  s_waitcnt vmcnt(7)
  s_cbranch_scc1 L_ma_91
  buffer_load_dwordx4 v[60:63], v4, s[4:7], s58 offen offset:128 nt
L_mb_92:
  v_mfma_f32_16x16x32_bf16 v[16:19], v[64:67], v[80:83], 0
  s_bitcmp1_b32 s64, 3
  s_waitcnt vmcnt(7)
  s_cbranch_scc1 L_ma_93
  buffer_load_dwordx4 v[64:67], v4, s[4:7], s58 offen offset:256 nt
L_mb_94:
  v_mfma_f32_16x16x32_bf16 v[16:19], v[68:71], v[84:87], v[16:19]
  s_add_u32 s59, s59, 1
  s_add_u32 s58, s58, 98304
  v_readlane_b32 s64, v0, s59
  s_lshr_b32 s64, s64, s101
  s_and_b32 s65, s64, 7
  s_mulk_i32 s65, 12288
  v_add_u32 v44, s65, v2
  v_add_u32 v45, 4294868992, v44
  v_min_u32 v4, v44, v45
  s_waitcnt vmcnt(6)
  s_bitcmp1_b32 s64, 3
  s_waitcnt vmcnt(7)
  s_barrier
  s_cbranch_scc1 L_ma_95
  buffer_load_dwordx4 v[68:71], v4, s[4:7], s58 offen offset:0 nt
L_mb_96:
  v_mfma_f32_16x16x32_bf16 v[16:19], v[72:75], v[88:91], v[16:19]
  s_mov_b32 vcc_lo, 0x10101010
  s_mov_b32 vcc_hi, vcc_lo
  s_nop 5
  v_add_f32_dpp v14, v17, v16 row_ror:8 row_mask:0xf bank_mask:0x3
  v_add_f32_dpp v14, v18, v19 row_ror:8 row_mask:0xf bank_mask:0xc
  v_cndmask_b32 v12, v12, v14, vcc
  s_bitcmp1_b32 s64, 3
  s_waitcnt vmcnt(7)
  s_cbranch_scc1 L_ma_97
  buffer_load_dwordx4 v[72:75], v4, s[4:7], s58 offen offset:128 nt
L_mb_98:
  v_mfma_f32_16x16x32_bf16 v[16:19], v[76:79], v[80:83], 0
  s_bitcmp1_b32 s64, 3
  s_waitcnt vmcnt(6)
  s_cbranch_scc1 L_ma_99
  buffer_load_dwordx4 v[76:79], v4, s[4:7], s58 offen offset:256 nt
L_mb_100:
  v_mfma_f32_16x16x32_bf16 v[16:19], v[48:51], v[84:87], v[16:19]
  v_readlane_b32 s64, v0, 1
  s_add_u32 s58, s91, 98304
  s_bfe_u32 s65, s64, 0x30004
  s_mulk_i32 s65, 12288
  v_add_u32 v44, s65, v3
  v_add_u32 v45, 4294868992, v44
  v_min_u32 v4, v44, v45
  s_waitcnt vmcnt(5)
  s_bitcmp1_b32 s64, 7
  s_waitcnt vmcnt(6)
  s_barrier
  s_cbranch_scc1 L_ma_101
  buffer_load_dwordx4 v[48:51], v4, s[8:11], s58 offen offset:0 nt
L_ma_101:
  s_cbranch_scc0 L_mb_102
  buffer_load_dwordx4 v[48:51], v4, s[8:11], s58 offen offset:0
L_mb_102:
  v_mfma_f32_16x16x32_bf16 v[16:19], v[52:55], v[88:91], v[16:19]
  s_mov_b32 vcc_lo, 0x20202020
  s_mov_b32 vcc_hi, vcc_lo
  s_nop 5
  v_add_f32_dpp v14, v17, v16 row_ror:8 row_mask:0xf bank_mask:0x3
  v_add_f32_dpp v14, v18, v19 row_ror:8 row_mask:0xf bank_mask:0xc
  v_cndmask_b32 v12, v12, v14, vcc
  s_bitcmp1_b32 s64, 7
  s_waitcnt vmcnt(6)
  s_cbranch_scc1 L_ma_103
  buffer_load_dwordx4 v[52:55], v4, s[8:11], s58 offen offset:128 nt
L_ma_103:
  s_cbranch_scc0 L_mb_104
  buffer_load_dwordx4 v[52:55], v4, s[8:11], s58 offen offset:128
L_mb_104:
  v_mfma_f32_16x16x32_bf16 v[16:19], v[56:59], v[80:83], 0
  s_bitcmp1_b32 s64, 7
  s_waitcnt vmcnt(6)
  s_cbranch_scc1 L_ma_105
  buffer_load_dwordx4 v[56:59], v4, s[8:11], s58 offen offset:256 nt
L_ma_105:
  s_cbranch_scc0 L_mb_106
  buffer_load_dwordx4 v[56:59], v4, s[8:11], s58 offen offset:256
L_mb_106:
  v_mfma_f32_16x16x32_bf16 v[16:19], v[60:63], v[84:87], v[16:19]
  v_readlane_b32 s64, v0, 2
  s_add_u32 s58, s91, 196608
  s_bfe_u32 s65, s64, 0x30004
  s_mulk_i32 s65, 12288
  v_add_u32 v44, s65, v3
  v_add_u32 v45, 4294868992, v44
  v_min_u32 v4, v44, v45
  s_waitcnt vmcnt(5)
  s_bitcmp1_b32 s64, 7
  s_waitcnt vmcnt(6)
  s_barrier
  s_cbranch_scc1 L_ma_107
  buffer_load_dwordx4 v[60:63], v4, s[8:11], s58 offen offset:0 nt
L_ma_107:
  s_cbranch_scc0 L_mb_108
  buffer_load_dwordx4 v[60:63], v4, s[8:11], s58 offen offset:0
L_mb_108:
  v_mfma_f32_16x16x32_bf16 v[16:19], v[64:67], v[88:91], v[16:19]
  s_mov_b32 vcc_lo, 0x40404040
  s_mov_b32 vcc_hi, vcc_lo
  s_nop 5
  v_add_f32_dpp v14, v17, v16 row_ror:8 row_mask:0xf bank_mask:0x3
  v_add_f32_dpp v14, v18, v19 row_ror:8 row_mask:0xf bank_mask:0xc
  v_cndmask_b32 v12, v12, v14, vcc
  s_bitcmp1_b32 s64, 7
  s_waitcnt vmcnt(6)
  s_cbranch_scc1 L_ma_109
  buffer_load_dwordx4 v[64:67], v4, s[8:11], s58 offen offset:128 nt
L_ma_109:
  s_cbranch_scc0 L_mb_110
  buffer_load_dwordx4 v[64:67], v4, s[8:11], s58 offen offset:128
L_mb_110:
  v_mfma_f32_16x16x32_bf16 v[16:19], v[68:71], v[80:83], 0
  s_bitcmp1_b32 s64, 7
  s_waitcnt vmcnt(6)
  s_cbranch_scc1 L_ma_111
  buffer_load_dwordx4 v[68:71], v4, s[8:11], s58 offen offset:256 nt
L_ma_111:
  s_cbranch_scc0 L_mb_112
  buffer_load_dwordx4 v[68:71], v4, s[8:11], s58 offen offset:256
L_mb_112:
  v_mfma_f32_16x16x32_bf16 v[16:19], v[72:75], v[84:87], v[16:19]
  v_readlane_b32 s64, v0, 4
  s_add_u32 s58, s91, 393216
  s_bfe_u32 s65, s64, 0x30004
  s_mulk_i32 s65, 12288
  v_add_u32 v44, s65, v3
  v_add_u32 v45, 4294868992, v44
  v_min_u32 v4, v44, v45
  s_waitcnt vmcnt(5)
  s_bitcmp1_b32 s64, 7
  s_waitcnt vmcnt(6)
  s_barrier
  s_cbranch_scc1 L_ma_113
  buffer_load_dwordx4 v[72:75], v4, s[8:11], s58 offen offset:0 nt
L_ma_113:
  s_cbranch_scc0 L_mb_114
  buffer_load_dwordx4 v[72:75], v4, s[8:11], s58 offen offset:0
L_mb_114:
  v_mfma_f32_16x16x32_bf16 v[16:19], v[76:79], v[88:91], v[16:19]
  s_mov_b32 vcc_lo, 0x80808080
  s_mov_b32 vcc_hi, vcc_lo
  s_nop 5
  v_add_f32_dpp v14, v17, v16 row_ror:8 row_mask:0xf bank_mask:0x3
  v_add_f32_dpp v14, v18, v19 row_ror:8 row_mask:0xf bank_mask:0xc
  v_cndmask_b32 v12, v12, v14, vcc
  v_cvt_pk_bf16_f32 v12, 0, v12
  v_mul_f32 v14, 0x3d93cd3a, v12
  v_cvt_pk_bf16_f32 v14, v14, v14
  v_alignbit_b32 v36, v37, v36, 16
  v_alignbit_b32 v37, v38, v37, 16
  v_alignbit_b32 v38, v39, v38, 16
  v_alignbit_b32 v39, v14, v39, 16
  v_lshl_or_b32 v44, v1, 4, s99
  buffer_store_dwordx4 v[36:39], v44, s[28:31], s87 offen offset:1024 sc1 nt
  v_mov_b32 v20, 0
  v_mov_b32 v21, 0
  v_mov_b32 v22, 0
  v_mov_b32 v23, 0
  v_mov_b32 v24, 0
  v_mov_b32 v25, 0
  v_mov_b32 v26, 0
  v_mov_b32 v27, 0
  v_mov_b32 v28, 0
  v_mov_b32 v29, 0
  v_mov_b32 v30, 0
  v_mov_b32 v31, 0
  v_mov_b32 v15, 0
  s_mov_b32 s60, 0xff800000
  v_and_b32 v46, 7, v1
  s_xor_b32 s77, s44, s48
  v_lshrrev_b32 v44, v46, s77
  v_bfe_i32 v45, v44, 0, 1
  v_bfe_i32 v13, v44, 8, 1
  v_alignbit_b32 v45, v13, v45, 16
  v_bfi_b32 v32, v45, v40, v32
  v_bfe_i32 v45, v44, 16, 1
  v_bfe_i32 v13, v44, 24, 1
  v_alignbit_b32 v45, v13, v45, 16
  v_bfi_b32 v33, v45, v41, v33
  s_xor_b32 s77, s45, s49
  v_lshrrev_b32 v44, v46, s77
  v_bfe_i32 v45, v44, 0, 1
  v_bfe_i32 v13, v44, 8, 1
  v_alignbit_b32 v45, v13, v45, 16
  v_bfi_b32 v34, v45, v42, v34
  v_bfe_i32 v45, v44, 16, 1
  v_bfe_i32 v13, v44, 24, 1
  v_alignbit_b32 v45, v13, v45, 16
  v_bfi_b32 v35, v45, v43, v35
  v_lshlrev_b32 v14, 16, v32
  v_cmp_lt_f32 vcc, s60, v14
  s_cbranch_vccz L_nr_115
  s_call_b64 s[52:53], L_rescale
L_nr_115:
  v_subrev_f32 v14, s60, v14
  v_mul_f32 v14, s85, v14
  v_exp_f32 v14, v14
  s_nop 0
  v_add_f32 v15, v15, v14
  v_cvt_pk_bf16_f32 v14, v14, v14
  s_nop 1
  ds_read_b128 v[80:83], v6 offset:0
  ds_read_b128 v[84:87], v6 offset:1024
  ds_read_b128 v[88:91], v6 offset:2048
  v_mov_b32_dpp v13, v14 row_newbcast:1 row_mask:0xf bank_mask:0x3
  v_mov_b32_dpp v13, v14 row_newbcast:9 row_mask:0xf bank_mask:0xc
  v_and_b32 v16, v8, v13
  v_and_b32 v17, v9, v13
  v_and_b32 v18, v10, v13
  v_and_b32 v19, v11, v13
  s_nop 1
  s_bitcmp1_b32 s64, 7
  s_waitcnt vmcnt(7)
  s_cbranch_scc1 L_ma_116
  buffer_load_dwordx4 v[76:79], v4, s[8:11], s58 offen offset:128 nt
L_ma_116:
  s_cbranch_scc0 L_mb_117
  buffer_load_dwordx4 v[76:79], v4, s[8:11], s58 offen offset:128
L_mb_117:
  v_mfma_f32_16x16x32_bf16 v[20:23], v[16:19], v[48:51], v[20:23]
  s_bitcmp1_b32 s64, 7
  s_waitcnt vmcnt(7)
  s_cbranch_scc1 L_ma_118
  buffer_load_dwordx4 v[48:51], v4, s[8:11], s58 offen offset:256 nt
L_ma_118:
  s_cbranch_scc0 L_mb_119
  buffer_load_dwordx4 v[48:51], v4, s[8:11], s58 offen offset:256
L_mb_119:
  v_mfma_f32_16x16x32_bf16 v[24:27], v[16:19], v[52:55], v[24:27]
  v_readlane_b32 s64, v0, 5
  s_add_u32 s58, s91, 491520
  s_bfe_u32 s65, s64, 0x30004
  s_mulk_i32 s65, 12288
  v_add_u32 v44, s65, v3
  v_add_u32 v45, 4294868992, v44
  v_min_u32 v4, v44, v45
  s_waitcnt vmcnt(6)
  s_bitcmp1_b32 s64, 7
  s_waitcnt vmcnt(7)
  s_barrier
  s_cbranch_scc1 L_ma_120
  buffer_load_dwordx4 v[52:55], v4, s[8:11], s58 offen offset:0 nt
L_ma_120:
  s_cbranch_scc0 L_mb_121
  buffer_load_dwordx4 v[52:55], v4, s[8:11], s58 offen offset:0
L_mb_121:
  v_mfma_f32_16x16x32_bf16 v[28:31], v[16:19], v[56:59], v[28:31]
  v_mov_b32_dpp v13, v14 row_newbcast:0 row_mask:0xf bank_mask:0x3
  v_mov_b32_dpp v13, v14 row_newbcast:8 row_mask:0xf bank_mask:0xc
  v_and_b32 v16, v8, v13
  v_and_b32 v17, v9, v13
  v_and_b32 v18, v10, v13
  v_and_b32 v19, v11, v13
  s_nop 1
  s_waitcnt lgkmcnt(0)
  v_mfma_f32_16x16x32_bf16 v[20:23], v[16:19], v[80:83], v[20:23]
  v_mfma_f32_16x16x32_bf16 v[24:27], v[16:19], v[84:87], v[24:27]
  v_mfma_f32_16x16x32_bf16 v[28:31], v[16:19], v[88:91], v[28:31]
  ds_read_b128 v[80:83], v6 offset:3072
  ds_read_b128 v[84:87], v6 offset:4096
  ds_read_b128 v[88:91], v6 offset:5120
  v_mov_b32_dpp v13, v14 row_newbcast:2 row_mask:0xf bank_mask:0x3
  v_mov_b32_dpp v13, v14 row_newbcast:10 row_mask:0xf bank_mask:0xc
  v_and_b32 v16, v8, v13
  v_and_b32 v17, v9, v13
  v_and_b32 v18, v10, v13
  v_and_b32 v19, v11, v13
  s_nop 1
  s_bitcmp1_b32 s64, 7
  s_waitcnt vmcnt(7)
  s_cbranch_scc1 L_ma_122
  buffer_load_dwordx4 v[56:59], v4, s[8:11], s58 offen offset:128 nt
L_ma_122:
  s_cbranch_scc0 L_mb_123
  buffer_load_dwordx4 v[56:59], v4, s[8:11], s58 offen offset:128
L_mb_123:
  v_mfma_f32_16x16x32_bf16 v[20:23], v[16:19], v[60:63], v[20:23]
  s_bitcmp1_b32 s64, 7
  s_waitcnt vmcnt(7)
  s_cbranch_scc1 L_ma_124
  buffer_load_dwordx4 v[60:63], v4, s[8:11], s58 offen offset:256 nt
L_ma_124:
  s_cbranch_scc0 L_mb_125
  buffer_load_dwordx4 v[60:63], v4, s[8:11], s58 offen offset:256
L_mb_125:
  v_mfma_f32_16x16x32_bf16 v[24:27], v[16:19], v[64:67], v[24:27]
  v_readlane_b32 s64, v0, 7
  s_add_u32 s58, s91, 688128
  s_bfe_u32 s65, s64, 0x30004
  s_mulk_i32 s65, 12288
  v_add_u32 v44, s65, v3
  v_add_u32 v45, 4294868992, v44
  v_min_u32 v4, v44, v45
  s_waitcnt vmcnt(6)
  s_bitcmp1_b32 s64, 7
  s_waitcnt vmcnt(7)
  s_barrier
  s_cbranch_scc1 L_ma_126
  buffer_load_dwordx4 v[64:67], v4, s[8:11], s58 offen offset:0 nt
L_ma_126:
  s_cbranch_scc0 L_mb_127
  buffer_load_dwordx4 v[64:67], v4, s[8:11], s58 offen offset:0
L_mb_127:
  v_mfma_f32_16x16x32_bf16 v[28:31], v[16:19], v[68:71], v[28:31]
  v_mov_b32_dpp v13, v14 row_newbcast:3 row_mask:0xf bank_mask:0x3
  v_mov_b32_dpp v13, v14 row_newbcast:11 row_mask:0xf bank_mask:0xc
  v_and_b32 v16, v8, v13
  v_and_b32 v17, v9, v13
  v_and_b32 v18, v10, v13
  v_and_b32 v19, v11, v13
  s_nop 1
  s_waitcnt lgkmcnt(0)
  v_mfma_f32_16x16x32_bf16 v[20:23], v[16:19], v[80:83], v[20:23]
  v_mfma_f32_16x16x32_bf16 v[24:27], v[16:19], v[84:87], v[24:27]
  v_mfma_f32_16x16x32_bf16 v[28:31], v[16:19], v[88:91], v[28:31]
  v_mov_b32_dpp v13, v14 row_newbcast:4 row_mask:0xf bank_mask:0x3
  v_mov_b32_dpp v13, v14 row_newbcast:12 row_mask:0xf bank_mask:0xc
  v_and_b32 v16, v8, v13
  v_and_b32 v17, v9, v13
  v_and_b32 v18, v10, v13
  v_and_b32 v19, v11, v13
  s_nop 1
  s_bitcmp1_b32 s64, 7
  s_waitcnt vmcnt(7)
  s_cbranch_scc1 L_ma_128
  buffer_load_dwordx4 v[68:71], v4, s[8:11], s58 offen offset:128 nt
L_ma_128:
  s_cbranch_scc0 L_mb_129
  buffer_load_dwordx4 v[68:71], v4, s[8:11], s58 offen offset:128
L_mb_129:
  v_mfma_f32_16x16x32_bf16 v[20:23], v[16:19], v[72:75], v[20:23]
  s_bitcmp1_b32 s64, 7
  s_waitcnt vmcnt(6)
  s_cbranch_scc1 L_ma_130
  buffer_load_dwordx4 v[72:75], v4, s[8:11], s58 offen offset:256 nt
L_ma_130:
  s_cbranch_scc0 L_mb_131
  buffer_load_dwordx4 v[72:75], v4, s[8:11], s58 offen offset:256
L_mb_131:
  v_mfma_f32_16x16x32_bf16 v[24:27], v[16:19], v[76:79], v[24:27]
  v_readlane_b32 s64, v0, 9
  s_add_u32 s58, s91, 884736
  s_bfe_u32 s65, s64, 0x30004
  s_mulk_i32 s65, 12288
  v_add_u32 v44, s65, v3
  v_add_u32 v45, 4294868992, v44
  v_min_u32 v4, v44, v45
  s_waitcnt vmcnt(5)
  s_bitcmp1_b32 s64, 7
  s_waitcnt vmcnt(6)
  s_barrier
  s_cbranch_scc1 L_ma_132
  buffer_load_dwordx4 v[76:79], v4, s[8:11], s58 offen offset:0 nt
L_ma_132:
  s_cbranch_scc0 L_mb_133
  buffer_load_dwordx4 v[76:79], v4, s[8:11], s58 offen offset:0
L_mb_133:
  v_mfma_f32_16x16x32_bf16 v[28:31], v[16:19], v[48:51], v[28:31]
  ds_read_b128 v[80:83], v6 offset:6144
  ds_read_b128 v[84:87], v6 offset:7168
  ds_read_b128 v[88:91], v6 offset:8192
  v_mov_b32_dpp v13, v14 row_newbcast:5 row_mask:0xf bank_mask:0x3
  v_mov_b32_dpp v13, v14 row_newbcast:13 row_mask:0xf bank_mask:0xc
  v_and_b32 v16, v8, v13
  v_and_b32 v17, v9, v13
  v_and_b32 v18, v10, v13
  v_and_b32 v19, v11, v13
  s_nop 1
  s_bitcmp1_b32 s64, 7
  s_waitcnt vmcnt(6)
  s_cbranch_scc1 L_ma_134
  buffer_load_dwordx4 v[48:51], v4, s[8:11], s58 offen offset:128 nt
L_ma_134:
  s_cbranch_scc0 L_mb_135
  buffer_load_dwordx4 v[48:51], v4, s[8:11], s58 offen offset:128
L_mb_135:
  v_mfma_f32_16x16x32_bf16 v[20:23], v[16:19], v[52:55], v[20:23]
  s_bitcmp1_b32 s64, 7
  s_waitcnt vmcnt(6)
  s_cbranch_scc1 L_ma_136
  buffer_load_dwordx4 v[52:55], v4, s[8:11], s58 offen offset:256 nt
L_ma_136:
  s_cbranch_scc0 L_mb_137
  buffer_load_dwordx4 v[52:55], v4, s[8:11], s58 offen offset:256
L_mb_137:
  v_mfma_f32_16x16x32_bf16 v[24:27], v[16:19], v[56:59], v[24:27]
  v_readlane_b32 s64, v0, 10
  s_add_u32 s58, s91, 983040
  s_bfe_u32 s65, s64, 0x30004
  s_mulk_i32 s65, 12288
  v_add_u32 v44, s65, v3
  v_add_u32 v45, 4294868992, v44
  v_min_u32 v4, v44, v45
  s_waitcnt vmcnt(5)
  s_bitcmp1_b32 s64, 7
  s_waitcnt vmcnt(6)
  s_barrier
  s_cbranch_scc1 L_ma_138
  buffer_load_dwordx4 v[56:59], v4, s[8:11], s58 offen offset:0 nt
L_ma_138:
  s_cbranch_scc0 L_mb_139
  buffer_load_dwordx4 v[56:59], v4, s[8:11], s58 offen offset:0
L_mb_139:
  v_mfma_f32_16x16x32_bf16 v[28:31], v[16:19], v[60:63], v[28:31]
  s_add_u32 s88, s88, 1
  v_mov_b32 v44, s88
  s_cmp_eq_u32 s3, 0
  s_cselect_b32 s77, s99, 0x80000000
  v_lshl_or_b32 v45, v1, 2, s77
  s_lshl_b32 s77, s2, 7
  s_add_u32 s77, s77, 2621440
  s_mov_b32 exec_hi, 0
  buffer_store_dword v44, v45, s[28:31], s77 offen sc1 nt
  s_mov_b64 exec, -1
  v_mov_b32_dpp v13, v14 row_newbcast:6 row_mask:0xf bank_mask:0x3
  v_mov_b32_dpp v13, v14 row_newbcast:14 row_mask:0xf bank_mask:0xc
  v_and_b32 v16, v8, v13
  v_and_b32 v17, v9, v13
  v_and_b32 v18, v10, v13
  v_and_b32 v19, v11, v13
  s_nop 1
  s_waitcnt lgkmcnt(0)
  v_mfma_f32_16x16x32_bf16 v[20:23], v[16:19], v[80:83], v[20:23]
  v_mfma_f32_16x16x32_bf16 v[24:27], v[16:19], v[84:87], v[24:27]
  v_mfma_f32_16x16x32_bf16 v[28:31], v[16:19], v[88:91], v[28:31]
  v_mov_b32_dpp v13, v14 row_newbcast:7 row_mask:0xf bank_mask:0x3
  v_mov_b32_dpp v13, v14 row_newbcast:15 row_mask:0xf bank_mask:0xc
  v_and_b32 v16, v8, v13
  v_and_b32 v17, v9, v13
  v_and_b32 v18, v10, v13
  v_and_b32 v19, v11, v13
  s_nop 1
  s_bitcmp1_b32 s64, 7
  s_waitcnt vmcnt(7)
  s_cbranch_scc1 L_ma_140
  buffer_load_dwordx4 v[60:63], v4, s[8:11], s58 offen offset:128 nt
L_ma_140:
  s_cbranch_scc0 L_mb_141
  buffer_load_dwordx4 v[60:63], v4, s[8:11], s58 offen offset:128
L_mb_141:
  v_mfma_f32_16x16x32_bf16 v[20:23], v[16:19], v[64:67], v[20:23]
  s_bitcmp1_b32 s64, 7
  s_waitcnt vmcnt(7)
  s_cbranch_scc1 L_ma_142
  buffer_load_dwordx4 v[64:67], v4, s[8:11], s58 offen offset:256 nt
L_ma_142:
  s_cbranch_scc0 L_mb_143
  buffer_load_dwordx4 v[64:67], v4, s[8:11], s58 offen offset:256
L_mb_143:
  v_mfma_f32_16x16x32_bf16 v[24:27], v[16:19], v[68:71], v[24:27]
  v_readlane_b32 s64, v0, 12
  s_add_u32 s58, s91, 1179648
  s_bfe_u32 s65, s64, 0x30004
  s_mulk_i32 s65, 12288
  v_add_u32 v44, s65, v3
  v_add_u32 v45, 4294868992, v44
  v_min_u32 v4, v44, v45
  s_waitcnt vmcnt(6)
  s_bitcmp1_b32 s64, 7
  s_waitcnt vmcnt(7)
  s_barrier
  s_cbranch_scc1 L_ma_144
  buffer_load_dwordx4 v[68:71], v4, s[8:11], s58 offen offset:0 nt
L_ma_144:
  s_cbranch_scc0 L_mb_145
  buffer_load_dwordx4 v[68:71], v4, s[8:11], s58 offen offset:0
L_mb_145:
  v_mfma_f32_16x16x32_bf16 v[28:31], v[16:19], v[72:75], v[28:31]
  v_and_b32 v14, 0xffff0000, v32
  v_cmp_lt_f32 vcc, s60, v14
  s_cbranch_vccz L_nr_146
  s_call_b64 s[52:53], L_rescale
L_nr_146:
  v_subrev_f32 v14, s60, v14
  v_mul_f32 v14, s85, v14
  v_exp_f32 v14, v14
  s_nop 0
  v_add_f32 v15, v15, v14
  v_cvt_pk_bf16_f32 v14, v14, v14
  s_nop 1
  ds_read_b128 v[80:83], v6 offset:9216
  ds_read_b128 v[84:87], v6 offset:10240
  ds_read_b128 v[88:91], v6 offset:11264
  v_mov_b32_dpp v13, v14 row_newbcast:1 row_mask:0xf bank_mask:0x3
  v_mov_b32_dpp v13, v14 row_newbcast:9 row_mask:0xf bank_mask:0xc
  v_and_b32 v16, v8, v13
  v_and_b32 v17, v9, v13
  v_and_b32 v18, v10, v13
  v_and_b32 v19, v11, v13
  s_nop 1
  s_bitcmp1_b32 s64, 7
  s_waitcnt vmcnt(7)
  s_cbranch_scc1 L_ma_147
  buffer_load_dwordx4 v[72:75], v4, s[8:11], s58 offen offset:128 nt
L_ma_147:
  s_cbranch_scc0 L_mb_148
  buffer_load_dwordx4 v[72:75], v4, s[8:11], s58 offen offset:128
L_mb_148:
  v_mfma_f32_16x16x32_bf16 v[20:23], v[16:19], v[76:79], v[20:23]
  s_bitcmp1_b32 s64, 7
  s_waitcnt vmcnt(7)
  s_cbranch_scc1 L_ma_149
  buffer_load_dwordx4 v[76:79], v4, s[8:11], s58 offen offset:256 nt
L_ma_149:
  s_cbranch_scc0 L_mb_150
  buffer_load_dwordx4 v[76:79], v4, s[8:11], s58 offen offset:256
L_mb_150:
  v_mfma_f32_16x16x32_bf16 v[24:27], v[16:19], v[48:51], v[24:27]
  v_readlane_b32 s64, v0, 13
  s_add_u32 s58, s91, 1277952
  s_bfe_u32 s65, s64, 0x30004
  s_mulk_i32 s65, 12288
  v_add_u32 v44, s65, v3
  v_add_u32 v45, 4294868992, v44
  v_min_u32 v4, v44, v45
  s_waitcnt vmcnt(6)
  s_bitcmp1_b32 s64, 7
  s_waitcnt vmcnt(7)
  s_barrier
  s_cbranch_scc1 L_ma_151
  buffer_load_dwordx4 v[48:51], v4, s[8:11], s58 offen offset:0 nt
L_ma_151:
  s_cbranch_scc0 L_mb_152
  buffer_load_dwordx4 v[48:51], v4, s[8:11], s58 offen offset:0
L_mb_152:
  v_mfma_f32_16x16x32_bf16 v[28:31], v[16:19], v[52:55], v[28:31]
  v_mov_b32_dpp v13, v14 row_newbcast:0 row_mask:0xf bank_mask:0x3
  v_mov_b32_dpp v13, v14 row_newbcast:8 row_mask:0xf bank_mask:0xc
  v_and_b32 v16, v8, v13
  v_and_b32 v17, v9, v13
  v_and_b32 v18, v10, v13
  v_and_b32 v19, v11, v13
  s_nop 1
  s_waitcnt lgkmcnt(0)
  v_mfma_f32_16x16x32_bf16 v[20:23], v[16:19], v[80:83], v[20:23]
  v_mfma_f32_16x16x32_bf16 v[24:27], v[16:19], v[84:87], v[24:27]
  v_mfma_f32_16x16x32_bf16 v[28:31], v[16:19], v[88:91], v[28:31]
  ds_read_b128 v[80:83], v6 offset:12288
  ds_read_b128 v[84:87], v6 offset:13312
  ds_read_b128 v[88:91], v6 offset:14336
  v_mov_b32_dpp v13, v14 row_newbcast:2 row_mask:0xf bank_mask:0x3
  v_mov_b32_dpp v13, v14 row_newbcast:10 row_mask:0xf bank_mask:0xc
  v_and_b32 v16, v8, v13
  v_and_b32 v17, v9, v13
  v_and_b32 v18, v10, v13
  v_and_b32 v19, v11, v13
  s_nop 1
  s_bitcmp1_b32 s64, 7
  s_waitcnt vmcnt(7)
  s_cbranch_scc1 L_ma_153
  buffer_load_dwordx4 v[52:55], v4, s[8:11], s58 offen offset:128 nt
L_ma_153:
  s_cbranch_scc0 L_mb_154
  buffer_load_dwordx4 v[52:55], v4, s[8:11], s58 offen offset:128
L_mb_154:
  v_mfma_f32_16x16x32_bf16 v[20:23], v[16:19], v[56:59], v[20:23]
  s_bitcmp1_b32 s64, 7
  s_waitcnt vmcnt(6)
  s_cbranch_scc1 L_ma_155
  buffer_load_dwordx4 v[56:59], v4, s[8:11], s58 offen offset:256 nt
L_ma_155:
  s_cbranch_scc0 L_mb_156
  buffer_load_dwordx4 v[56:59], v4, s[8:11], s58 offen offset:256
L_mb_156:
  v_mfma_f32_16x16x32_bf16 v[24:27], v[16:19], v[60:63], v[24:27]
  v_readlane_b32 s64, v0, 15
  s_add_u32 s58, s91, 1474560
  s_bfe_u32 s65, s64, 0x30004
  s_mulk_i32 s65, 12288
  v_add_u32 v44, s65, v3
  v_add_u32 v45, 4294868992, v44
  v_min_u32 v4, v44, v45
  s_waitcnt vmcnt(5)
  s_bitcmp1_b32 s64, 7
  s_waitcnt vmcnt(6)
  s_barrier
  s_cbranch_scc1 L_ma_157
  buffer_load_dwordx4 v[60:63], v4, s[8:11], s58 offen offset:0 nt
L_ma_157:
  s_cbranch_scc0 L_mb_158
  buffer_load_dwordx4 v[60:63], v4, s[8:11], s58 offen offset:0
L_mb_158:
  v_mfma_f32_16x16x32_bf16 v[28:31], v[16:19], v[64:67], v[28:31]
  v_mov_b32_dpp v13, v14 row_newbcast:3 row_mask:0xf bank_mask:0x3
  v_mov_b32_dpp v13, v14 row_newbcast:11 row_mask:0xf bank_mask:0xc
  v_and_b32 v16, v8, v13
  v_and_b32 v17, v9, v13
  v_and_b32 v18, v10, v13
  v_and_b32 v19, v11, v13
  s_nop 1
  s_waitcnt lgkmcnt(0)
  v_mfma_f32_16x16x32_bf16 v[20:23], v[16:19], v[80:83], v[20:23]
  v_mfma_f32_16x16x32_bf16 v[24:27], v[16:19], v[84:87], v[24:27]
  v_mfma_f32_16x16x32_bf16 v[28:31], v[16:19], v[88:91], v[28:31]
  v_mov_b32_dpp v13, v14 row_newbcast:4 row_mask:0xf bank_mask:0x3
  v_mov_b32_dpp v13, v14 row_newbcast:12 row_mask:0xf bank_mask:0xc
  v_and_b32 v16, v8, v13
  v_and_b32 v17, v9, v13
  v_and_b32 v18, v10, v13
  v_and_b32 v19, v11, v13
  s_nop 1
  s_bitcmp1_b32 s64, 7
  s_waitcnt vmcnt(6)
  s_cbranch_scc1 L_ma_159
  buffer_load_dwordx4 v[64:67], v4, s[8:11], s58 offen offset:128 nt
L_ma_159:
  s_cbranch_scc0 L_mb_160
  buffer_load_dwordx4 v[64:67], v4, s[8:11], s58 offen offset:128
L_mb_160:
  v_mfma_f32_16x16x32_bf16 v[20:23], v[16:19], v[68:71], v[20:23]
  s_bitcmp1_b32 s64, 7
  s_waitcnt vmcnt(6)
  s_cbranch_scc1 L_ma_161
  buffer_load_dwordx4 v[68:71], v4, s[8:11], s58 offen offset:256 nt
L_ma_161:
  s_cbranch_scc0 L_mb_162
  buffer_load_dwordx4 v[68:71], v4, s[8:11], s58 offen offset:256
L_mb_162:
  v_mfma_f32_16x16x32_bf16 v[24:27], v[16:19], v[72:75], v[24:27]
  v_readlane_b32 s64, v0, 17
  s_add_u32 s58, s91, 1671168
  s_bfe_u32 s65, s64, 0x30004
  s_mulk_i32 s65, 12288
  v_add_u32 v44, s65, v3
  v_add_u32 v45, 4294868992, v44
  v_min_u32 v4, v44, v45
  s_waitcnt vmcnt(5)
  s_bitcmp1_b32 s64, 7
  s_waitcnt vmcnt(6)
  s_barrier
  s_cbranch_scc1 L_ma_163
  buffer_load_dwordx4 v[72:75], v4, s[8:11], s58 offen offset:0 nt
L_ma_163:
  s_cbranch_scc0 L_mb_164
  buffer_load_dwordx4 v[72:75], v4, s[8:11], s58 offen offset:0
L_mb_164:
  v_mfma_f32_16x16x32_bf16 v[28:31], v[16:19], v[76:79], v[28:31]
  ds_read_b128 v[80:83], v6 offset:15360
  ds_read_b128 v[84:87], v6 offset:16384
  ds_read_b128 v[88:91], v6 offset:17408
  v_mov_b32_dpp v13, v14 row_newbcast:5 row_mask:0xf bank_mask:0x3
  v_mov_b32_dpp v13, v14 row_newbcast:13 row_mask:0xf bank_mask:0xc
  v_and_b32 v16, v8, v13
  v_and_b32 v17, v9, v13
  v_and_b32 v18, v10, v13
  v_and_b32 v19, v11, v13
  s_nop 1
  s_bitcmp1_b32 s64, 7
  s_waitcnt vmcnt(6)
  s_cbranch_scc1 L_ma_165
  buffer_load_dwordx4 v[76:79], v4, s[8:11], s58 offen offset:128 nt
L_ma_165:
  s_cbranch_scc0 L_mb_166
  buffer_load_dwordx4 v[76:79], v4, s[8:11], s58 offen offset:128
L_mb_166:
  v_mfma_f32_16x16x32_bf16 v[20:23], v[16:19], v[48:51], v[20:23]
  s_bitcmp1_b32 s64, 7
  s_waitcnt vmcnt(6)
  s_cbranch_scc1 L_ma_167
  buffer_load_dwordx4 v[48:51], v4, s[8:11], s58 offen offset:256 nt
L_ma_167:
  s_cbranch_scc0 L_mb_168
  buffer_load_dwordx4 v[48:51], v4, s[8:11], s58 offen offset:256
L_mb_168:
  v_mfma_f32_16x16x32_bf16 v[24:27], v[16:19], v[52:55], v[24:27]
  v_readlane_b32 s64, v0, 18
  s_add_u32 s58, s91, 1769472
  s_bfe_u32 s65, s64, 0x30004
  s_mulk_i32 s65, 12288
  v_add_u32 v44, s65, v3
  v_add_u32 v45, 4294868992, v44
  v_min_u32 v4, v44, v45
  s_waitcnt vmcnt(5)
  s_bitcmp1_b32 s64, 7
  s_waitcnt vmcnt(6)
  s_barrier
  s_cbranch_scc1 L_ma_169
  buffer_load_dwordx4 v[52:55], v4, s[8:11], s58 offen offset:0 nt
L_ma_169:
  s_cbranch_scc0 L_mb_170
  buffer_load_dwordx4 v[52:55], v4, s[8:11], s58 offen offset:0
L_mb_170:
  v_mfma_f32_16x16x32_bf16 v[28:31], v[16:19], v[56:59], v[28:31]
  v_mov_b32_dpp v13, v14 row_newbcast:6 row_mask:0xf bank_mask:0x3
  v_mov_b32_dpp v13, v14 row_newbcast:14 row_mask:0xf bank_mask:0xc
  v_and_b32 v16, v8, v13
  v_and_b32 v17, v9, v13
  v_and_b32 v18, v10, v13
  v_and_b32 v19, v11, v13
  s_nop 1
  s_waitcnt lgkmcnt(0)
  v_mfma_f32_16x16x32_bf16 v[20:23], v[16:19], v[80:83], v[20:23]
  v_mfma_f32_16x16x32_bf16 v[24:27], v[16:19], v[84:87], v[24:27]
  v_mfma_f32_16x16x32_bf16 v[28:31], v[16:19], v[88:91], v[28:31]
  v_mov_b32_dpp v13, v14 row_newbcast:7 row_mask:0xf bank_mask:0x3
  v_mov_b32_dpp v13, v14 row_newbcast:15 row_mask:0xf bank_mask:0xc
  v_and_b32 v16, v8, v13
  v_and_b32 v17, v9, v13
  v_and_b32 v18, v10, v13
  v_and_b32 v19, v11, v13
  s_nop 1
  s_bitcmp1_b32 s64, 7
  s_waitcnt vmcnt(6)
  s_cbranch_scc1 L_ma_171
  buffer_load_dwordx4 v[56:59], v4, s[8:11], s58 offen offset:128 nt
L_ma_171:
  s_cbranch_scc0 L_mb_172
  buffer_load_dwordx4 v[56:59], v4, s[8:11], s58 offen offset:128
L_mb_172:
  v_mfma_f32_16x16x32_bf16 v[20:23], v[16:19], v[60:63], v[20:23]
  s_bitcmp1_b32 s64, 7
  s_waitcnt vmcnt(6)
  s_cbranch_scc1 L_ma_173
  buffer_load_dwordx4 v[60:63], v4, s[8:11], s58 offen offset:256 nt
L_ma_173:
  s_cbranch_scc0 L_mb_174
  buffer_load_dwordx4 v[60:63], v4, s[8:11], s58 offen offset:256
L_mb_174:
  v_mfma_f32_16x16x32_bf16 v[24:27], v[16:19], v[64:67], v[24:27]
  v_readlane_b32 s64, v0, 20
  s_add_u32 s58, s91, 1966080
  s_bfe_u32 s65, s64, 0x30004
  s_mulk_i32 s65, 12288
  v_add_u32 v44, s65, v3
  v_add_u32 v45, 4294868992, v44
  v_min_u32 v4, v44, v45
  s_waitcnt vmcnt(5)
  s_bitcmp1_b32 s64, 7
  s_waitcnt vmcnt(6)
  s_barrier
  s_cbranch_scc1 L_ma_175
  buffer_load_dwordx4 v[64:67], v4, s[8:11], s58 offen offset:0 nt
L_ma_175:
  s_cbranch_scc0 L_mb_176
  buffer_load_dwordx4 v[64:67], v4, s[8:11], s58 offen offset:0
L_mb_176:
  v_mfma_f32_16x16x32_bf16 v[28:31], v[16:19], v[68:71], v[28:31]
  v_lshlrev_b32 v14, 16, v33
  v_cmp_lt_f32 vcc, s60, v14
  s_cbranch_vccz L_nr_177
  s_call_b64 s[52:53], L_rescale
L_nr_177:
  v_subrev_f32 v14, s60, v14
  v_mul_f32 v14, s85, v14
  v_exp_f32 v14, v14
  s_nop 0
  v_add_f32 v15, v15, v14
  v_cvt_pk_bf16_f32 v14, v14, v14
  s_nop 1
  ds_read_b128 v[80:83], v6 offset:18432
  ds_read_b128 v[84:87], v6 offset:19456
  ds_read_b128 v[88:91], v6 offset:20480
  v_mov_b32_dpp v13, v14 row_newbcast:1 row_mask:0xf bank_mask:0x3
  v_mov_b32_dpp v13, v14 row_newbcast:9 row_mask:0xf bank_mask:0xc
  v_and_b32 v16, v8, v13
  v_and_b32 v17, v9, v13
  v_and_b32 v18, v10, v13
  v_and_b32 v19, v11, v13
  s_nop 1
  s_bitcmp1_b32 s64, 7
  s_waitcnt vmcnt(6)
  s_cbranch_scc1 L_ma_178
  buffer_load_dwordx4 v[68:71], v4, s[8:11], s58 offen offset:128 nt
L_ma_178:
  s_cbranch_scc0 L_mb_179
  buffer_load_dwordx4 v[68:71], v4, s[8:11], s58 offen offset:128
L_mb_179:
  v_mfma_f32_16x16x32_bf16 v[20:23], v[16:19], v[72:75], v[20:23]
  s_bitcmp1_b32 s64, 7
  s_waitcnt vmcnt(6)
  s_cbranch_scc1 L_ma_180
  buffer_load_dwordx4 v[72:75], v4, s[8:11], s58 offen offset:256 nt
L_ma_180:
  s_cbranch_scc0 L_mb_181
  buffer_load_dwordx4 v[72:75], v4, s[8:11], s58 offen offset:256
L_mb_181:
  v_mfma_f32_16x16x32_bf16 v[24:27], v[16:19], v[76:79], v[24:27]
  v_readlane_b32 s64, v0, 21
  s_add_u32 s58, s91, 2064384
  s_bfe_u32 s65, s64, 0x30004
  s_mulk_i32 s65, 12288
  v_add_u32 v44, s65, v3
  v_add_u32 v45, 4294868992, v44
  v_min_u32 v4, v44, v45
  s_waitcnt vmcnt(5)
  s_bitcmp1_b32 s64, 7
  s_waitcnt vmcnt(6)
  s_barrier
  s_cbranch_scc1 L_ma_182
  buffer_load_dwordx4 v[76:79], v4, s[8:11], s58 offen offset:0 nt
L_ma_182:
  s_cbranch_scc0 L_mb_183
  buffer_load_dwordx4 v[76:79], v4, s[8:11], s58 offen offset:0
L_mb_183:
  v_mfma_f32_16x16x32_bf16 v[28:31], v[16:19], v[48:51], v[28:31]
  v_mov_b32_dpp v13, v14 row_newbcast:0 row_mask:0xf bank_mask:0x3
  v_mov_b32_dpp v13, v14 row_newbcast:8 row_mask:0xf bank_mask:0xc
  v_and_b32 v16, v8, v13
  v_and_b32 v17, v9, v13
  v_and_b32 v18, v10, v13
  v_and_b32 v19, v11, v13
  s_nop 1
  s_waitcnt lgkmcnt(0)
  v_mfma_f32_16x16x32_bf16 v[20:23], v[16:19], v[80:83], v[20:23]
  v_mfma_f32_16x16x32_bf16 v[24:27], v[16:19], v[84:87], v[24:27]
  v_mfma_f32_16x16x32_bf16 v[28:31], v[16:19], v[88:91], v[28:31]
  ds_read_b128 v[80:83], v6 offset:21504
  ds_read_b128 v[84:87], v6 offset:22528
  ds_read_b128 v[88:91], v6 offset:23552
  v_mov_b32_dpp v13, v14 row_newbcast:2 row_mask:0xf bank_mask:0x3
  v_mov_b32_dpp v13, v14 row_newbcast:10 row_mask:0xf bank_mask:0xc
  v_and_b32 v16, v8, v13
  v_and_b32 v17, v9, v13
  v_and_b32 v18, v10, v13
  v_and_b32 v19, v11, v13
  s_nop 1
  s_bitcmp1_b32 s64, 7
  s_waitcnt vmcnt(6)
  s_cbranch_scc1 L_ma_184
  buffer_load_dwordx4 v[48:51], v4, s[8:11], s58 offen offset:128 nt
L_ma_184:
  s_cbranch_scc0 L_mb_185
  buffer_load_dwordx4 v[48:51], v4, s[8:11], s58 offen offset:128
L_mb_185:
  v_mfma_f32_16x16x32_bf16 v[20:23], v[16:19], v[52:55], v[20:23]
  s_bitcmp1_b32 s64, 7
  s_waitcnt vmcnt(6)
  s_cbranch_scc1 L_ma_186
  buffer_load_dwordx4 v[52:55], v4, s[8:11], s58 offen offset:256 nt
L_ma_186:
  s_cbranch_scc0 L_mb_187
  buffer_load_dwordx4 v[52:55], v4, s[8:11], s58 offen offset:256
L_mb_187:
  v_mfma_f32_16x16x32_bf16 v[24:27], v[16:19], v[56:59], v[24:27]
  v_readlane_b32 s64, v0, 23
  s_add_u32 s58, s91, 2260992
  s_bfe_u32 s65, s64, 0x30004
  s_mulk_i32 s65, 12288
  v_add_u32 v44, s65, v3
  v_add_u32 v45, 4294868992, v44
  v_min_u32 v4, v44, v45
  s_waitcnt vmcnt(5)
  s_bitcmp1_b32 s64, 7
  s_waitcnt vmcnt(6)
  s_barrier
  s_cbranch_scc1 L_ma_188
  buffer_load_dwordx4 v[56:59], v4, s[8:11], s58 offen offset:0 nt
L_ma_188:
  s_cbranch_scc0 L_mb_189
  buffer_load_dwordx4 v[56:59], v4, s[8:11], s58 offen offset:0
L_mb_189:
  v_mfma_f32_16x16x32_bf16 v[28:31], v[16:19], v[60:63], v[28:31]
  v_mov_b32_dpp v13, v14 row_newbcast:3 row_mask:0xf bank_mask:0x3
  v_mov_b32_dpp v13, v14 row_newbcast:11 row_mask:0xf bank_mask:0xc
  v_and_b32 v16, v8, v13
  v_and_b32 v17, v9, v13
  v_and_b32 v18, v10, v13
  v_and_b32 v19, v11, v13
  s_nop 1
  s_waitcnt lgkmcnt(0)
  v_mfma_f32_16x16x32_bf16 v[20:23], v[16:19], v[80:83], v[20:23]
  v_mfma_f32_16x16x32_bf16 v[24:27], v[16:19], v[84:87], v[24:27]
  v_mfma_f32_16x16x32_bf16 v[28:31], v[16:19], v[88:91], v[28:31]
  v_mov_b32_dpp v13, v14 row_newbcast:4 row_mask:0xf bank_mask:0x3
  v_mov_b32_dpp v13, v14 row_newbcast:12 row_mask:0xf bank_mask:0xc
  v_and_b32 v16, v8, v13
  v_and_b32 v17, v9, v13
  v_and_b32 v18, v10, v13
  v_and_b32 v19, v11, v13
  s_nop 1
  s_bitcmp1_b32 s64, 7
  s_waitcnt vmcnt(6)
  s_cbranch_scc1 L_ma_190
  buffer_load_dwordx4 v[60:63], v4, s[8:11], s58 offen offset:128 nt
L_ma_190:
  s_cbranch_scc0 L_mb_191
  buffer_load_dwordx4 v[60:63], v4, s[8:11], s58 offen offset:128
L_mb_191:
  v_mfma_f32_16x16x32_bf16 v[20:23], v[16:19], v[64:67], v[20:23]
  s_bitcmp1_b32 s64, 7
  s_waitcnt vmcnt(6)
  s_cbranch_scc1 L_ma_192
  buffer_load_dwordx4 v[64:67], v4, s[8:11], s58 offen offset:256 nt
L_ma_192:
  s_cbranch_scc0 L_mb_193
  buffer_load_dwordx4 v[64:67], v4, s[8:11], s58 offen offset:256
L_mb_193:
  v_mfma_f32_16x16x32_bf16 v[24:27], v[16:19], v[68:71], v[24:27]
  v_readlane_b32 s64, v0, 25
  s_add_u32 s58, s91, 2457600
  s_bfe_u32 s65, s64, 0x30004
  s_mulk_i32 s65, 12288
  v_add_u32 v44, s65, v3
  v_add_u32 v45, 4294868992, v44
  v_min_u32 v4, v44, v45
  s_waitcnt vmcnt(5)
  s_bitcmp1_b32 s64, 7
  s_waitcnt vmcnt(6)
  s_barrier
  s_cbranch_scc1 L_ma_194
  buffer_load_dwordx4 v[68:71], v4, s[8:11], s58 offen offset:0 nt
L_ma_194:
  s_cbranch_scc0 L_mb_195
  buffer_load_dwordx4 v[68:71], v4, s[8:11], s58 offen offset:0
L_mb_195:
  v_mfma_f32_16x16x32_bf16 v[28:31], v[16:19], v[72:75], v[28:31]
  ds_read_b128 v[80:83], v6 offset:24576
  ds_read_b128 v[84:87], v6 offset:25600
  ds_read_b128 v[88:91], v6 offset:26624
  v_mov_b32_dpp v13, v14 row_newbcast:5 row_mask:0xf bank_mask:0x3
  v_mov_b32_dpp v13, v14 row_newbcast:13 row_mask:0xf bank_mask:0xc
  v_and_b32 v16, v8, v13
  v_and_b32 v17, v9, v13
  v_and_b32 v18, v10, v13
  v_and_b32 v19, v11, v13
  s_nop 1
  s_bitcmp1_b32 s64, 7
  s_waitcnt vmcnt(6)
  s_cbranch_scc1 L_ma_196
  buffer_load_dwordx4 v[72:75], v4, s[8:11], s58 offen offset:128 nt
L_ma_196:
  s_cbranch_scc0 L_mb_197
  buffer_load_dwordx4 v[72:75], v4, s[8:11], s58 offen offset:128
L_mb_197:
  v_mfma_f32_16x16x32_bf16 v[20:23], v[16:19], v[76:79], v[20:23]
  s_bitcmp1_b32 s64, 7
  s_waitcnt vmcnt(6)
  s_cbranch_scc1 L_ma_198
  buffer_load_dwordx4 v[76:79], v4, s[8:11], s58 offen offset:256 nt
L_ma_198:
  s_cbranch_scc0 L_mb_199
  buffer_load_dwordx4 v[76:79], v4, s[8:11], s58 offen offset:256
L_mb_199:
  v_mfma_f32_16x16x32_bf16 v[24:27], v[16:19], v[48:51], v[24:27]
  v_readlane_b32 s64, v0, 26
  s_add_u32 s58, s91, 2555904
  s_bfe_u32 s65, s64, 0x30004
  s_mulk_i32 s65, 12288
  v_add_u32 v44, s65, v3
  v_add_u32 v45, 4294868992, v44
  v_min_u32 v4, v44, v45
  s_waitcnt vmcnt(5)
  s_bitcmp1_b32 s64, 7
  s_waitcnt vmcnt(6)
  s_barrier
  s_cbranch_scc1 L_ma_200
  buffer_load_dwordx4 v[48:51], v4, s[8:11], s58 offen offset:0 nt
L_ma_200:
  s_cbranch_scc0 L_mb_201
  buffer_load_dwordx4 v[48:51], v4, s[8:11], s58 offen offset:0
L_mb_201:
  v_mfma_f32_16x16x32_bf16 v[28:31], v[16:19], v[52:55], v[28:31]
  v_mov_b32_dpp v13, v14 row_newbcast:6 row_mask:0xf bank_mask:0x3
  v_mov_b32_dpp v13, v14 row_newbcast:14 row_mask:0xf bank_mask:0xc
  v_and_b32 v16, v8, v13
  v_and_b32 v17, v9, v13
  v_and_b32 v18, v10, v13
  v_and_b32 v19, v11, v13
  s_nop 1
  s_waitcnt lgkmcnt(0)
  v_mfma_f32_16x16x32_bf16 v[20:23], v[16:19], v[80:83], v[20:23]
  v_mfma_f32_16x16x32_bf16 v[24:27], v[16:19], v[84:87], v[24:27]
  v_mfma_f32_16x16x32_bf16 v[28:31], v[16:19], v[88:91], v[28:31]
  v_mov_b32_dpp v13, v14 row_newbcast:7 row_mask:0xf bank_mask:0x3
  v_mov_b32_dpp v13, v14 row_newbcast:15 row_mask:0xf bank_mask:0xc
  v_and_b32 v16, v8, v13
  v_and_b32 v17, v9, v13
  v_and_b32 v18, v10, v13
  v_and_b32 v19, v11, v13
  s_nop 1
  s_bitcmp1_b32 s64, 7
  s_waitcnt vmcnt(6)
  s_cbranch_scc1 L_ma_202
  buffer_load_dwordx4 v[52:55], v4, s[8:11], s58 offen offset:128 nt
L_ma_202:
  s_cbranch_scc0 L_mb_203
  buffer_load_dwordx4 v[52:55], v4, s[8:11], s58 offen offset:128
L_mb_203:
  v_mfma_f32_16x16x32_bf16 v[20:23], v[16:19], v[56:59], v[20:23]
  s_bitcmp1_b32 s64, 7
  s_waitcnt vmcnt(6)
  s_cbranch_scc1 L_ma_204
  buffer_load_dwordx4 v[56:59], v4, s[8:11], s58 offen offset:256 nt
L_ma_204:
  s_cbranch_scc0 L_mb_205
  buffer_load_dwordx4 v[56:59], v4, s[8:11], s58 offen offset:256
L_mb_205:
  v_mfma_f32_16x16x32_bf16 v[24:27], v[16:19], v[60:63], v[24:27]
  v_readlane_b32 s64, v0, 28
  s_add_u32 s58, s91, 2752512
  s_bfe_u32 s65, s64, 0x30004
  s_mulk_i32 s65, 12288
  v_add_u32 v44, s65, v3
  v_add_u32 v45, 4294868992, v44
  v_min_u32 v4, v44, v45
  s_waitcnt vmcnt(5)
  s_bitcmp1_b32 s64, 7
  s_waitcnt vmcnt(6)
  s_barrier
  s_cbranch_scc1 L_ma_206
  buffer_load_dwordx4 v[60:63], v4, s[8:11], s58 offen offset:0 nt
L_ma_206:
  s_cbranch_scc0 L_mb_207
  buffer_load_dwordx4 v[60:63], v4, s[8:11], s58 offen offset:0
L_mb_207:
  v_mfma_f32_16x16x32_bf16 v[28:31], v[16:19], v[64:67], v[28:31]
  v_and_b32 v14, 0xffff0000, v33
  v_cmp_lt_f32 vcc, s60, v14
  s_cbranch_vccz L_nr_208
  s_call_b64 s[52:53], L_rescale
L_nr_208:
  v_subrev_f32 v14, s60, v14
  v_mul_f32 v14, s85, v14
  v_exp_f32 v14, v14
  s_nop 0
  v_add_f32 v15, v15, v14
  v_cvt_pk_bf16_f32 v14, v14, v14
  s_nop 1
  ds_read_b128 v[80:83], v6 offset:27648
  ds_read_b128 v[84:87], v6 offset:28672
  ds_read_b128 v[88:91], v6 offset:29696
  v_mov_b32_dpp v13, v14 row_newbcast:1 row_mask:0xf bank_mask:0x3
  v_mov_b32_dpp v13, v14 row_newbcast:9 row_mask:0xf bank_mask:0xc
  v_and_b32 v16, v8, v13
  v_and_b32 v17, v9, v13
  v_and_b32 v18, v10, v13
  v_and_b32 v19, v11, v13
  s_nop 1
  s_bitcmp1_b32 s64, 7
  s_waitcnt vmcnt(6)
  s_cbranch_scc1 L_ma_209
  buffer_load_dwordx4 v[64:67], v4, s[8:11], s58 offen offset:128 nt
L_ma_209:
  s_cbranch_scc0 L_mb_210
  buffer_load_dwordx4 v[64:67], v4, s[8:11], s58 offen offset:128
L_mb_210:
  v_mfma_f32_16x16x32_bf16 v[20:23], v[16:19], v[68:71], v[20:23]
  s_bitcmp1_b32 s64, 7
  s_waitcnt vmcnt(6)
  s_cbranch_scc1 L_ma_211
  buffer_load_dwordx4 v[68:71], v4, s[8:11], s58 offen offset:256 nt
L_ma_211:
  s_cbranch_scc0 L_mb_212
  buffer_load_dwordx4 v[68:71], v4, s[8:11], s58 offen offset:256
L_mb_212:
  v_mfma_f32_16x16x32_bf16 v[24:27], v[16:19], v[72:75], v[24:27]
  v_readlane_b32 s64, v0, 29
  s_add_u32 s58, s91, 2850816
  s_bfe_u32 s65, s64, 0x30004
  s_mulk_i32 s65, 12288
  v_add_u32 v44, s65, v3
  v_add_u32 v45, 4294868992, v44
  v_min_u32 v4, v44, v45
  s_waitcnt vmcnt(5)
  s_bitcmp1_b32 s64, 7
  s_waitcnt vmcnt(6)
  s_barrier
  s_cbranch_scc1 L_ma_213
  buffer_load_dwordx4 v[72:75], v4, s[8:11], s58 offen offset:0 nt
L_ma_213:
  s_cbranch_scc0 L_mb_214
  buffer_load_dwordx4 v[72:75], v4, s[8:11], s58 offen offset:0
L_mb_214:
  v_mfma_f32_16x16x32_bf16 v[28:31], v[16:19], v[76:79], v[28:31]
  v_mov_b32_dpp v13, v14 row_newbcast:0 row_mask:0xf bank_mask:0x3
  v_mov_b32_dpp v13, v14 row_newbcast:8 row_mask:0xf bank_mask:0xc
  v_and_b32 v16, v8, v13
  v_and_b32 v17, v9, v13
  v_and_b32 v18, v10, v13
  v_and_b32 v19, v11, v13
  s_nop 1
  s_waitcnt lgkmcnt(0)
  v_mfma_f32_16x16x32_bf16 v[20:23], v[16:19], v[80:83], v[20:23]
  v_mfma_f32_16x16x32_bf16 v[24:27], v[16:19], v[84:87], v[24:27]
  v_mfma_f32_16x16x32_bf16 v[28:31], v[16:19], v[88:91], v[28:31]
  ds_read_b128 v[80:83], v6 offset:30720
  ds_read_b128 v[84:87], v6 offset:31744
  ds_read_b128 v[88:91], v6 offset:32768
  v_mov_b32_dpp v13, v14 row_newbcast:2 row_mask:0xf bank_mask:0x3
  v_mov_b32_dpp v13, v14 row_newbcast:10 row_mask:0xf bank_mask:0xc
  v_and_b32 v16, v8, v13
  v_and_b32 v17, v9, v13
  v_and_b32 v18, v10, v13
  v_and_b32 v19, v11, v13
  s_nop 1
  s_bitcmp1_b32 s64, 7
  s_waitcnt vmcnt(6)
  s_cbranch_scc1 L_ma_215
  buffer_load_dwordx4 v[76:79], v4, s[8:11], s58 offen offset:128 nt
L_ma_215:
  s_cbranch_scc0 L_mb_216
  buffer_load_dwordx4 v[76:79], v4, s[8:11], s58 offen offset:128
L_mb_216:
  v_mfma_f32_16x16x32_bf16 v[20:23], v[16:19], v[48:51], v[20:23]
  s_bitcmp1_b32 s64, 7
  s_waitcnt vmcnt(6)
  s_cbranch_scc1 L_ma_217
  buffer_load_dwordx4 v[48:51], v4, s[8:11], s58 offen offset:256 nt
L_ma_217:
  s_cbranch_scc0 L_mb_218
  buffer_load_dwordx4 v[48:51], v4, s[8:11], s58 offen offset:256
L_mb_218:
  v_mfma_f32_16x16x32_bf16 v[24:27], v[16:19], v[52:55], v[24:27]
  v_readlane_b32 s64, v0, 31
  s_add_u32 s58, s91, 3047424
  s_bfe_u32 s65, s64, 0x30004
  s_mulk_i32 s65, 12288
  v_add_u32 v44, s65, v3
  v_add_u32 v45, 4294868992, v44
  v_min_u32 v4, v44, v45
  s_waitcnt vmcnt(5)
  s_bitcmp1_b32 s64, 7
  s_waitcnt vmcnt(6)
  s_barrier
  s_cbranch_scc1 L_ma_219
  buffer_load_dwordx4 v[52:55], v4, s[8:11], s58 offen offset:0 nt
L_ma_219:
  s_cbranch_scc0 L_mb_220
  buffer_load_dwordx4 v[52:55], v4, s[8:11], s58 offen offset:0
L_mb_220:
  v_mfma_f32_16x16x32_bf16 v[28:31], v[16:19], v[56:59], v[28:31]
  v_mov_b32_dpp v13, v14 row_newbcast:3 row_mask:0xf bank_mask:0x3
  v_mov_b32_dpp v13, v14 row_newbcast:11 row_mask:0xf bank_mask:0xc
  v_and_b32 v16, v8, v13
  v_and_b32 v17, v9, v13
  v_and_b32 v18, v10, v13
  v_and_b32 v19, v11, v13
  s_nop 1
  s_waitcnt lgkmcnt(0)
  v_mfma_f32_16x16x32_bf16 v[20:23], v[16:19], v[80:83], v[20:23]
  v_mfma_f32_16x16x32_bf16 v[24:27], v[16:19], v[84:87], v[24:27]
  v_mfma_f32_16x16x32_bf16 v[28:31], v[16:19], v[88:91], v[28:31]
  v_mov_b32_dpp v13, v14 row_newbcast:4 row_mask:0xf bank_mask:0x3
  v_mov_b32_dpp v13, v14 row_newbcast:12 row_mask:0xf bank_mask:0xc
  v_and_b32 v16, v8, v13
  v_and_b32 v17, v9, v13
  v_and_b32 v18, v10, v13
  v_and_b32 v19, v11, v13
  s_nop 1
  s_bitcmp1_b32 s64, 7
  s_waitcnt vmcnt(6)
  s_cbranch_scc1 L_ma_221
  buffer_load_dwordx4 v[56:59], v4, s[8:11], s58 offen offset:128 nt
L_ma_221:
  s_cbranch_scc0 L_mb_222
  buffer_load_dwordx4 v[56:59], v4, s[8:11], s58 offen offset:128
L_mb_222:
  v_mfma_f32_16x16x32_bf16 v[20:23], v[16:19], v[60:63], v[20:23]
  s_bitcmp1_b32 s64, 7
  s_waitcnt vmcnt(6)
  s_cbranch_scc1 L_ma_223
  buffer_load_dwordx4 v[60:63], v4, s[8:11], s58 offen offset:256 nt
L_ma_223:
  s_cbranch_scc0 L_mb_224
  buffer_load_dwordx4 v[60:63], v4, s[8:11], s58 offen offset:256
L_mb_224:
  v_mfma_f32_16x16x32_bf16 v[24:27], v[16:19], v[64:67], v[24:27]
  v_readlane_b32 s64, v0, 33
  s_add_u32 s58, s91, 3244032
  s_bfe_u32 s65, s64, 0x30004
  s_mulk_i32 s65, 12288
  v_add_u32 v44, s65, v3
  v_add_u32 v45, 4294868992, v44
  v_min_u32 v4, v44, v45
  s_waitcnt vmcnt(5)
  s_bitcmp1_b32 s64, 7
  s_waitcnt vmcnt(6)
  s_barrier
  s_cbranch_scc1 L_ma_225
  buffer_load_dwordx4 v[64:67], v4, s[8:11], s58 offen offset:0 nt
L_ma_225:
  s_cbranch_scc0 L_mb_226
  buffer_load_dwordx4 v[64:67], v4, s[8:11], s58 offen offset:0
L_mb_226:
  v_mfma_f32_16x16x32_bf16 v[28:31], v[16:19], v[68:71], v[28:31]
  ds_read_b128 v[80:83], v6 offset:33792
  ds_read_b128 v[84:87], v6 offset:34816
  ds_read_b128 v[88:91], v6 offset:35840
  v_mov_b32_dpp v13, v14 row_newbcast:5 row_mask:0xf bank_mask:0x3
  v_mov_b32_dpp v13, v14 row_newbcast:13 row_mask:0xf bank_mask:0xc
  v_and_b32 v16, v8, v13
  v_and_b32 v17, v9, v13
  v_and_b32 v18, v10, v13
  v_and_b32 v19, v11, v13
  s_nop 1
  s_bitcmp1_b32 s64, 7
  s_waitcnt vmcnt(6)
  s_cbranch_scc1 L_ma_227
  buffer_load_dwordx4 v[68:71], v4, s[8:11], s58 offen offset:128 nt
L_ma_227:
  s_cbranch_scc0 L_mb_228
  buffer_load_dwordx4 v[68:71], v4, s[8:11], s58 offen offset:128
L_mb_228:
  v_mfma_f32_16x16x32_bf16 v[20:23], v[16:19], v[72:75], v[20:23]
  s_bitcmp1_b32 s64, 7
  s_waitcnt vmcnt(6)
  s_cbranch_scc1 L_ma_229
  buffer_load_dwordx4 v[72:75], v4, s[8:11], s58 offen offset:256 nt
L_ma_229:
  s_cbranch_scc0 L_mb_230
  buffer_load_dwordx4 v[72:75], v4, s[8:11], s58 offen offset:256
L_mb_230:
  v_mfma_f32_16x16x32_bf16 v[24:27], v[16:19], v[76:79], v[24:27]
  v_readlane_b32 s64, v0, 34
  s_add_u32 s58, s91, 3342336
  s_bfe_u32 s65, s64, 0x30004
  s_mulk_i32 s65, 12288
  v_add_u32 v44, s65, v3
  v_add_u32 v45, 4294868992, v44
  v_min_u32 v4, v44, v45
  s_waitcnt vmcnt(5)
  s_bitcmp1_b32 s64, 7
  s_waitcnt vmcnt(6)
  s_barrier
  s_cbranch_scc1 L_ma_231
  buffer_load_dwordx4 v[76:79], v4, s[8:11], s58 offen offset:0 nt
L_ma_231:
  s_cbranch_scc0 L_mb_232
  buffer_load_dwordx4 v[76:79], v4, s[8:11], s58 offen offset:0
L_mb_232:
  v_mfma_f32_16x16x32_bf16 v[28:31], v[16:19], v[48:51], v[28:31]
  v_mov_b32_dpp v13, v14 row_newbcast:6 row_mask:0xf bank_mask:0x3
  v_mov_b32_dpp v13, v14 row_newbcast:14 row_mask:0xf bank_mask:0xc
  v_and_b32 v16, v8, v13
  v_and_b32 v17, v9, v13
  v_and_b32 v18, v10, v13
  v_and_b32 v19, v11, v13
  s_nop 1
  s_waitcnt lgkmcnt(0)
  v_mfma_f32_16x16x32_bf16 v[20:23], v[16:19], v[80:83], v[20:23]
  v_mfma_f32_16x16x32_bf16 v[24:27], v[16:19], v[84:87], v[24:27]
  v_mfma_f32_16x16x32_bf16 v[28:31], v[16:19], v[88:91], v[28:31]
  v_mov_b32_dpp v13, v14 row_newbcast:7 row_mask:0xf bank_mask:0x3
  v_mov_b32_dpp v13, v14 row_newbcast:15 row_mask:0xf bank_mask:0xc
  v_and_b32 v16, v8, v13
  v_and_b32 v17, v9, v13
  v_and_b32 v18, v10, v13
  v_and_b32 v19, v11, v13
  s_nop 1
  s_bitcmp1_b32 s64, 7
  s_waitcnt vmcnt(6)
  s_cbranch_scc1 L_ma_233
  buffer_load_dwordx4 v[48:51], v4, s[8:11], s58 offen offset:128 nt
L_ma_233:
  s_cbranch_scc0 L_mb_234
  buffer_load_dwordx4 v[48:51], v4, s[8:11], s58 offen offset:128
L_mb_234:
  v_mfma_f32_16x16x32_bf16 v[20:23], v[16:19], v[52:55], v[20:23]
  s_bitcmp1_b32 s64, 7
  s_waitcnt vmcnt(6)
  s_cbranch_scc1 L_ma_235
  buffer_load_dwordx4 v[52:55], v4, s[8:11], s58 offen offset:256 nt
L_ma_235:
  s_cbranch_scc0 L_mb_236
  buffer_load_dwordx4 v[52:55], v4, s[8:11], s58 offen offset:256
L_mb_236:
  v_mfma_f32_16x16x32_bf16 v[24:27], v[16:19], v[56:59], v[24:27]
  v_readlane_b32 s64, v0, 36
  s_add_u32 s58, s91, 3538944
  s_bfe_u32 s65, s64, 0x30004
  s_mulk_i32 s65, 12288
  v_add_u32 v44, s65, v3
  v_add_u32 v45, 4294868992, v44
  v_min_u32 v4, v44, v45
  s_waitcnt vmcnt(5)
  s_bitcmp1_b32 s64, 7
  s_waitcnt vmcnt(6)
  s_barrier
  s_cbranch_scc1 L_ma_237
  buffer_load_dwordx4 v[56:59], v4, s[8:11], s58 offen offset:0 nt
L_ma_237:
  s_cbranch_scc0 L_mb_238
  buffer_load_dwordx4 v[56:59], v4, s[8:11], s58 offen offset:0
L_mb_238:
  v_mfma_f32_16x16x32_bf16 v[28:31], v[16:19], v[60:63], v[28:31]
  v_lshlrev_b32 v14, 16, v34
  v_cmp_lt_f32 vcc, s60, v14
  s_cbranch_vccz L_nr_239
  s_call_b64 s[52:53], L_rescale
L_nr_239:
  v_subrev_f32 v14, s60, v14
  v_mul_f32 v14, s85, v14
  v_exp_f32 v14, v14
  s_nop 0
  v_add_f32 v15, v15, v14
  v_cvt_pk_bf16_f32 v14, v14, v14
  s_nop 1
  v_mov_b32_dpp v13, v14 row_newbcast:1 row_mask:0xf bank_mask:0x3
  v_mov_b32_dpp v13, v14 row_newbcast:9 row_mask:0xf bank_mask:0xc
  v_and_b32 v16, v8, v13
  v_and_b32 v17, v9, v13
  v_and_b32 v18, v10, v13
  v_and_b32 v19, v11, v13
  s_nop 1
  s_bitcmp1_b32 s64, 7
  s_waitcnt vmcnt(6)
  s_cbranch_scc1 L_ma_240
  buffer_load_dwordx4 v[60:63], v4, s[8:11], s58 offen offset:128 nt
L_ma_240:
  s_cbranch_scc0 L_mb_241
  buffer_load_dwordx4 v[60:63], v4, s[8:11], s58 offen offset:128
L_mb_241:
  v_mfma_f32_16x16x32_bf16 v[20:23], v[16:19], v[64:67], v[20:23]
  s_bitcmp1_b32 s64, 7
  s_waitcnt vmcnt(6)
  s_cbranch_scc1 L_ma_242
  buffer_load_dwordx4 v[64:67], v4, s[8:11], s58 offen offset:256 nt
L_ma_242:
  s_cbranch_scc0 L_mb_243
  buffer_load_dwordx4 v[64:67], v4, s[8:11], s58 offen offset:256
L_mb_243:
  v_mfma_f32_16x16x32_bf16 v[24:27], v[16:19], v[68:71], v[24:27]
  v_readlane_b32 s64, v0, 37
  s_add_u32 s58, s91, 3637248
  s_bfe_u32 s65, s64, 0x30004
  s_mulk_i32 s65, 12288
  v_add_u32 v44, s65, v3
  v_add_u32 v45, 4294868992, v44
  v_min_u32 v4, v44, v45
  s_waitcnt vmcnt(5)
  s_bitcmp1_b32 s64, 7
  s_waitcnt vmcnt(6)
  s_barrier
  s_cbranch_scc1 L_ma_244
  buffer_load_dwordx4 v[68:71], v4, s[8:11], s58 offen offset:0 nt
L_ma_244:
  s_cbranch_scc0 L_mb_245
  buffer_load_dwordx4 v[68:71], v4, s[8:11], s58 offen offset:0
L_mb_245:
  v_mfma_f32_16x16x32_bf16 v[28:31], v[16:19], v[72:75], v[28:31]
  v_mov_b32_dpp v13, v14 row_newbcast:0 row_mask:0xf bank_mask:0x3
  v_mov_b32_dpp v13, v14 row_newbcast:8 row_mask:0xf bank_mask:0xc
  v_and_b32 v16, v8, v13
  v_and_b32 v17, v9, v13
  v_and_b32 v18, v10, v13
  v_and_b32 v19, v11, v13
  s_nop 1
  v_mfma_f32_16x16x32_bf16 v[20:23], v[16:19], a[0:3], v[20:23]
  v_mfma_f32_16x16x32_bf16 v[24:27], v[16:19], a[4:7], v[24:27]
  v_mfma_f32_16x16x32_bf16 v[28:31], v[16:19], a[8:11], v[28:31]
  v_mov_b32_dpp v13, v14 row_newbcast:2 row_mask:0xf bank_mask:0x3
  v_mov_b32_dpp v13, v14 row_newbcast:10 row_mask:0xf bank_mask:0xc
  v_and_b32 v16, v8, v13
  v_and_b32 v17, v9, v13
  v_and_b32 v18, v10, v13
  v_and_b32 v19, v11, v13
  s_nop 1
  s_bitcmp1_b32 s64, 7
  s_waitcnt vmcnt(6)
  s_cbranch_scc1 L_ma_246
  buffer_load_dwordx4 v[72:75], v4, s[8:11], s58 offen offset:128 nt
L_ma_246:
  s_cbranch_scc0 L_mb_247
  buffer_load_dwordx4 v[72:75], v4, s[8:11], s58 offen offset:128
L_mb_247:
  v_mfma_f32_16x16x32_bf16 v[20:23], v[16:19], v[76:79], v[20:23]
  s_bitcmp1_b32 s64, 7
  s_waitcnt vmcnt(6)
  s_cbranch_scc1 L_ma_248
  buffer_load_dwordx4 v[76:79], v4, s[8:11], s58 offen offset:256 nt
L_ma_248:
  s_cbranch_scc0 L_mb_249
  buffer_load_dwordx4 v[76:79], v4, s[8:11], s58 offen offset:256
L_mb_249:
  v_mfma_f32_16x16x32_bf16 v[24:27], v[16:19], v[48:51], v[24:27]
  v_readlane_b32 s64, v0, 39
  s_add_u32 s58, s91, 3833856
  s_bfe_u32 s65, s64, 0x30004
  s_mulk_i32 s65, 12288
  v_add_u32 v44, s65, v3
  v_add_u32 v45, 4294868992, v44
  v_min_u32 v4, v44, v45
  s_waitcnt vmcnt(5)
  s_bitcmp1_b32 s64, 7
  s_waitcnt vmcnt(6)
  s_barrier
  s_cbranch_scc1 L_ma_250
  buffer_load_dwordx4 v[48:51], v4, s[8:11], s58 offen offset:0 nt
L_ma_250:
  s_cbranch_scc0 L_mb_251
  buffer_load_dwordx4 v[48:51], v4, s[8:11], s58 offen offset:0
L_mb_251:
  v_mfma_f32_16x16x32_bf16 v[28:31], v[16:19], v[52:55], v[28:31]
  v_mov_b32_dpp v13, v14 row_newbcast:3 row_mask:0xf bank_mask:0x3
  v_mov_b32_dpp v13, v14 row_newbcast:11 row_mask:0xf bank_mask:0xc
  v_and_b32 v16, v8, v13
  v_and_b32 v17, v9, v13
  v_and_b32 v18, v10, v13
  v_and_b32 v19, v11, v13
  s_nop 1
  v_mfma_f32_16x16x32_bf16 v[20:23], v[16:19], a[12:15], v[20:23]
  v_mfma_f32_16x16x32_bf16 v[24:27], v[16:19], a[16:19], v[24:27]
  v_mfma_f32_16x16x32_bf16 v[28:31], v[16:19], a[20:23], v[28:31]
  v_mov_b32_dpp v13, v14 row_newbcast:4 row_mask:0xf bank_mask:0x3
  v_mov_b32_dpp v13, v14 row_newbcast:12 row_mask:0xf bank_mask:0xc
  v_and_b32 v16, v8, v13
  v_and_b32 v17, v9, v13
  v_and_b32 v18, v10, v13
  v_and_b32 v19, v11, v13
  s_nop 1
  s_bitcmp1_b32 s64, 7
  s_waitcnt vmcnt(6)
  s_cbranch_scc1 L_ma_252
  buffer_load_dwordx4 v[52:55], v4, s[8:11], s58 offen offset:128 nt
L_ma_252:
  s_cbranch_scc0 L_mb_253
  buffer_load_dwordx4 v[52:55], v4, s[8:11], s58 offen offset:128
L_mb_253:
  v_mfma_f32_16x16x32_bf16 v[20:23], v[16:19], v[56:59], v[20:23]
  s_bitcmp1_b32 s64, 7
  s_waitcnt vmcnt(6)
  s_cbranch_scc1 L_ma_254
  buffer_load_dwordx4 v[56:59], v4, s[8:11], s58 offen offset:256 nt
L_ma_254:
  s_cbranch_scc0 L_mb_255
  buffer_load_dwordx4 v[56:59], v4, s[8:11], s58 offen offset:256
L_mb_255:
  v_mfma_f32_16x16x32_bf16 v[24:27], v[16:19], v[60:63], v[24:27]
  v_readlane_b32 s64, v0, 41
  s_add_u32 s58, s91, 4030464
  s_bfe_u32 s65, s64, 0x30004
  s_mulk_i32 s65, 12288
  v_add_u32 v44, s65, v3
  v_add_u32 v45, 4294868992, v44
  v_min_u32 v4, v44, v45
  s_waitcnt vmcnt(5)
  s_bitcmp1_b32 s64, 7
  s_waitcnt vmcnt(6)
  s_barrier
  s_cbranch_scc1 L_ma_256
  buffer_load_dwordx4 v[60:63], v4, s[8:11], s58 offen offset:0 nt
L_ma_256:
  s_cbranch_scc0 L_mb_257
  buffer_load_dwordx4 v[60:63], v4, s[8:11], s58 offen offset:0
L_mb_257:
  v_mfma_f32_16x16x32_bf16 v[28:31], v[16:19], v[64:67], v[28:31]
  v_mov_b32_dpp v13, v14 row_newbcast:5 row_mask:0xf bank_mask:0x3
  v_mov_b32_dpp v13, v14 row_newbcast:13 row_mask:0xf bank_mask:0xc
  v_and_b32 v16, v8, v13
  v_and_b32 v17, v9, v13
  v_and_b32 v18, v10, v13
  v_and_b32 v19, v11, v13
  s_nop 1
  s_bitcmp1_b32 s64, 7
  s_waitcnt vmcnt(6)
  s_cbranch_scc1 L_ma_258
  buffer_load_dwordx4 v[64:67], v4, s[8:11], s58 offen offset:128 nt
L_ma_258:
  s_cbranch_scc0 L_mb_259
  buffer_load_dwordx4 v[64:67], v4, s[8:11], s58 offen offset:128
L_mb_259:
  v_mfma_f32_16x16x32_bf16 v[20:23], v[16:19], v[68:71], v[20:23]
  s_bitcmp1_b32 s64, 7
  s_waitcnt vmcnt(6)
  s_cbranch_scc1 L_ma_260
  buffer_load_dwordx4 v[68:71], v4, s[8:11], s58 offen offset:256 nt
L_ma_260:
  s_cbranch_scc0 L_mb_261
  buffer_load_dwordx4 v[68:71], v4, s[8:11], s58 offen offset:256
L_mb_261:
  v_mfma_f32_16x16x32_bf16 v[24:27], v[16:19], v[72:75], v[24:27]
  v_readlane_b32 s64, v0, 42
  s_add_u32 s58, s91, 4128768
  s_bfe_u32 s65, s64, 0x30004
  s_mulk_i32 s65, 12288
  v_add_u32 v44, s65, v3
  v_add_u32 v45, 4294868992, v44
  v_min_u32 v4, v44, v45
  s_waitcnt vmcnt(5)
  s_bitcmp1_b32 s64, 7
  s_waitcnt vmcnt(6)
  s_barrier
  s_cbranch_scc1 L_ma_262
  buffer_load_dwordx4 v[72:75], v4, s[8:11], s58 offen offset:0 nt
L_ma_262:
  s_cbranch_scc0 L_mb_263
  buffer_load_dwordx4 v[72:75], v4, s[8:11], s58 offen offset:0
L_mb_263:
  v_mfma_f32_16x16x32_bf16 v[28:31], v[16:19], v[76:79], v[28:31]
  v_mov_b32_dpp v13, v14 row_newbcast:6 row_mask:0xf bank_mask:0x3
  v_mov_b32_dpp v13, v14 row_newbcast:14 row_mask:0xf bank_mask:0xc
  v_and_b32 v16, v8, v13
  v_and_b32 v17, v9, v13
  v_and_b32 v18, v10, v13
  v_and_b32 v19, v11, v13
  s_nop 1
  v_mfma_f32_16x16x32_bf16 v[20:23], v[16:19], a[24:27], v[20:23]
  v_mfma_f32_16x16x32_bf16 v[24:27], v[16:19], a[28:31], v[24:27]
  v_mfma_f32_16x16x32_bf16 v[28:31], v[16:19], a[32:35], v[28:31]
  v_mov_b32_dpp v13, v14 row_newbcast:7 row_mask:0xf bank_mask:0x3
  v_mov_b32_dpp v13, v14 row_newbcast:15 row_mask:0xf bank_mask:0xc
  v_and_b32 v16, v8, v13
  v_and_b32 v17, v9, v13
  v_and_b32 v18, v10, v13
  v_and_b32 v19, v11, v13
  s_nop 1
  s_bitcmp1_b32 s64, 7
  s_waitcnt vmcnt(6)
  s_cbranch_scc1 L_ma_264
  buffer_load_dwordx4 v[76:79], v4, s[8:11], s58 offen offset:128 nt
L_ma_264:
  s_cbranch_scc0 L_mb_265
  buffer_load_dwordx4 v[76:79], v4, s[8:11], s58 offen offset:128
L_mb_265:
  v_mfma_f32_16x16x32_bf16 v[20:23], v[16:19], v[48:51], v[20:23]
  s_bitcmp1_b32 s64, 7
  s_waitcnt vmcnt(6)
  s_cbranch_scc1 L_ma_266
  buffer_load_dwordx4 v[48:51], v4, s[8:11], s58 offen offset:256 nt
L_ma_266:
  s_cbranch_scc0 L_mb_267
  buffer_load_dwordx4 v[48:51], v4, s[8:11], s58 offen offset:256
L_mb_267:
  v_mfma_f32_16x16x32_bf16 v[24:27], v[16:19], v[52:55], v[24:27]
  v_readlane_b32 s64, v0, 44
  s_add_u32 s58, s91, 4325376
  s_bfe_u32 s65, s64, 0x30004
  s_mulk_i32 s65, 12288
  v_add_u32 v44, s65, v3
  v_add_u32 v45, 4294868992, v44
  v_min_u32 v4, v44, v45
  s_waitcnt vmcnt(5)
  s_bitcmp1_b32 s64, 7
  s_waitcnt vmcnt(6)
  s_barrier
  s_cbranch_scc1 L_ma_268
  buffer_load_dwordx4 v[52:55], v4, s[8:11], s58 offen offset:0 nt
L_ma_268:
  s_cbranch_scc0 L_mb_269
  buffer_load_dwordx4 v[52:55], v4, s[8:11], s58 offen offset:0
L_mb_269:
  v_mfma_f32_16x16x32_bf16 v[28:31], v[16:19], v[56:59], v[28:31]
  s_cmp_lg_u32 s94, 5
  s_cbranch_scc1 L_nf_270
  s_mov_b32 s78, 0
  s_call_b64 s[52:53], L_flush
L_nf_270:
  v_and_b32 v14, 0xffff0000, v34
  v_cmp_lt_f32 vcc, s60, v14
  s_cbranch_vccz L_nr_271
  s_call_b64 s[52:53], L_rescale
L_nr_271:
  v_subrev_f32 v14, s60, v14
  v_mul_f32 v14, s85, v14
  v_exp_f32 v14, v14
  s_nop 0
  v_add_f32 v15, v15, v14
  v_cvt_pk_bf16_f32 v14, v14, v14
  s_nop 1
  v_mov_b32_dpp v13, v14 row_newbcast:1 row_mask:0xf bank_mask:0x3
  v_mov_b32_dpp v13, v14 row_newbcast:9 row_mask:0xf bank_mask:0xc
  v_and_b32 v16, v8, v13
  v_and_b32 v17, v9, v13
  v_and_b32 v18, v10, v13
  v_and_b32 v19, v11, v13
  s_nop 1
  s_bitcmp1_b32 s64, 7
  s_waitcnt vmcnt(6)
  s_cbranch_scc1 L_ma_272
  buffer_load_dwordx4 v[56:59], v4, s[8:11], s58 offen offset:128 nt
L_ma_272:
  s_cbranch_scc0 L_mb_273
  buffer_load_dwordx4 v[56:59], v4, s[8:11], s58 offen offset:128
L_mb_273:
  v_mfma_f32_16x16x32_bf16 v[20:23], v[16:19], v[60:63], v[20:23]
  s_bitcmp1_b32 s64, 7
  s_waitcnt vmcnt(6)
  s_cbranch_scc1 L_ma_274
  buffer_load_dwordx4 v[60:63], v4, s[8:11], s58 offen offset:256 nt
L_ma_274:
  s_cbranch_scc0 L_mb_275
  buffer_load_dwordx4 v[60:63], v4, s[8:11], s58 offen offset:256
L_mb_275:
  v_mfma_f32_16x16x32_bf16 v[24:27], v[16:19], v[64:67], v[24:27]
  v_readlane_b32 s64, v0, 45
  s_add_u32 s58, s91, 4423680
  s_bfe_u32 s65, s64, 0x30004
  s_mulk_i32 s65, 12288
  v_add_u32 v44, s65, v3
  v_add_u32 v45, 4294868992, v44
  v_min_u32 v4, v44, v45
  s_waitcnt vmcnt(5)
  s_bitcmp1_b32 s64, 7
  s_waitcnt vmcnt(6)
  s_barrier
  s_cbranch_scc1 L_ma_276
  buffer_load_dwordx4 v[64:67], v4, s[8:11], s58 offen offset:0 nt
L_ma_276:
  s_cbranch_scc0 L_mb_277
  buffer_load_dwordx4 v[64:67], v4, s[8:11], s58 offen offset:0
L_mb_277:
  v_mfma_f32_16x16x32_bf16 v[28:31], v[16:19], v[68:71], v[28:31]
  v_mov_b32_dpp v13, v14 row_newbcast:0 row_mask:0xf bank_mask:0x3
  v_mov_b32_dpp v13, v14 row_newbcast:8 row_mask:0xf bank_mask:0xc
  v_and_b32 v16, v8, v13
  v_and_b32 v17, v9, v13
  v_and_b32 v18, v10, v13
  v_and_b32 v19, v11, v13
  s_nop 1
  v_mfma_f32_16x16x32_bf16 v[20:23], v[16:19], a[36:39], v[20:23]
  v_mfma_f32_16x16x32_bf16 v[24:27], v[16:19], a[40:43], v[24:27]
  v_mfma_f32_16x16x32_bf16 v[28:31], v[16:19], a[44:47], v[28:31]
  v_mov_b32_dpp v13, v14 row_newbcast:2 row_mask:0xf bank_mask:0x3
  v_mov_b32_dpp v13, v14 row_newbcast:10 row_mask:0xf bank_mask:0xc
  v_and_b32 v16, v8, v13
  v_and_b32 v17, v9, v13
  v_and_b32 v18, v10, v13
  v_and_b32 v19, v11, v13
  s_nop 1
  s_bitcmp1_b32 s64, 7
  s_waitcnt vmcnt(6)
  s_cbranch_scc1 L_ma_278
  buffer_load_dwordx4 v[68:71], v4, s[8:11], s58 offen offset:128 nt
L_ma_278:
  s_cbranch_scc0 L_mb_279
  buffer_load_dwordx4 v[68:71], v4, s[8:11], s58 offen offset:128
L_mb_279:
  v_mfma_f32_16x16x32_bf16 v[20:23], v[16:19], v[72:75], v[20:23]
  s_bitcmp1_b32 s64, 7
  s_waitcnt vmcnt(6)
  s_cbranch_scc1 L_ma_280
  buffer_load_dwordx4 v[72:75], v4, s[8:11], s58 offen offset:256 nt
L_ma_280:
  s_cbranch_scc0 L_mb_281
  buffer_load_dwordx4 v[72:75], v4, s[8:11], s58 offen offset:256
L_mb_281:
  v_mfma_f32_16x16x32_bf16 v[24:27], v[16:19], v[76:79], v[24:27]
  v_readlane_b32 s64, v0, 47
  s_add_u32 s58, s91, 4620288
  s_bfe_u32 s65, s64, 0x30004
  s_mulk_i32 s65, 12288
  v_add_u32 v44, s65, v3
  v_add_u32 v45, 4294868992, v44
  v_min_u32 v4, v44, v45
  s_waitcnt vmcnt(5)
  s_bitcmp1_b32 s64, 7
  s_waitcnt vmcnt(6)
  s_barrier
  s_cbranch_scc1 L_ma_282
  buffer_load_dwordx4 v[76:79], v4, s[8:11], s58 offen offset:0 nt
L_ma_282:
  s_cbranch_scc0 L_mb_283
  buffer_load_dwordx4 v[76:79], v4, s[8:11], s58 offen offset:0
L_mb_283:
  v_mfma_f32_16x16x32_bf16 v[28:31], v[16:19], v[48:51], v[28:31]
  v_mov_b32_dpp v13, v14 row_newbcast:3 row_mask:0xf bank_mask:0x3
  v_mov_b32_dpp v13, v14 row_newbcast:11 row_mask:0xf bank_mask:0xc
  v_and_b32 v16, v8, v13
  v_and_b32 v17, v9, v13
  v_and_b32 v18, v10, v13
  v_and_b32 v19, v11, v13
  s_nop 1
  v_mfma_f32_16x16x32_bf16 v[20:23], v[16:19], a[48:51], v[20:23]
  v_mfma_f32_16x16x32_bf16 v[24:27], v[16:19], a[52:55], v[24:27]
  v_mfma_f32_16x16x32_bf16 v[28:31], v[16:19], a[56:59], v[28:31]
  v_mov_b32_dpp v13, v14 row_newbcast:4 row_mask:0xf bank_mask:0x3
  v_mov_b32_dpp v13, v14 row_newbcast:12 row_mask:0xf bank_mask:0xc
  v_and_b32 v16, v8, v13
  v_and_b32 v17, v9, v13
  v_and_b32 v18, v10, v13
  v_and_b32 v19, v11, v13
  s_nop 1
  s_bitcmp1_b32 s64, 7
  s_waitcnt vmcnt(6)
  s_cbranch_scc1 L_ma_284
  buffer_load_dwordx4 v[48:51], v4, s[8:11], s58 offen offset:128 nt
L_ma_284:
  s_cbranch_scc0 L_mb_285
  buffer_load_dwordx4 v[48:51], v4, s[8:11], s58 offen offset:128
L_mb_285:
  v_mfma_f32_16x16x32_bf16 v[20:23], v[16:19], v[52:55], v[20:23]
  s_bitcmp1_b32 s64, 7
  s_waitcnt vmcnt(6)
  s_cbranch_scc1 L_ma_286
  buffer_load_dwordx4 v[52:55], v4, s[8:11], s58 offen offset:256 nt
L_ma_286:
  s_cbranch_scc0 L_mb_287
  buffer_load_dwordx4 v[52:55], v4, s[8:11], s58 offen offset:256
L_mb_287:
  v_mfma_f32_16x16x32_bf16 v[24:27], v[16:19], v[56:59], v[24:27]
  v_readlane_b32 s64, v0, 49
  s_add_u32 s58, s91, 4816896
  s_bfe_u32 s65, s64, 0x30004
  s_mulk_i32 s65, 12288
  v_add_u32 v44, s65, v3
  v_add_u32 v45, 4294868992, v44
  v_min_u32 v4, v44, v45
  s_waitcnt vmcnt(5)
  s_bitcmp1_b32 s64, 7
  s_waitcnt vmcnt(6)
  s_barrier
  s_cbranch_scc1 L_ma_288
  buffer_load_dwordx4 v[56:59], v4, s[8:11], s58 offen offset:0 nt
L_ma_288:
  s_cbranch_scc0 L_mb_289
  buffer_load_dwordx4 v[56:59], v4, s[8:11], s58 offen offset:0
L_mb_289:
  v_mfma_f32_16x16x32_bf16 v[28:31], v[16:19], v[60:63], v[28:31]
  v_mov_b32_dpp v13, v14 row_newbcast:5 row_mask:0xf bank_mask:0x3
  v_mov_b32_dpp v13, v14 row_newbcast:13 row_mask:0xf bank_mask:0xc
  v_and_b32 v16, v8, v13
  v_and_b32 v17, v9, v13
  v_and_b32 v18, v10, v13
  v_and_b32 v19, v11, v13
  s_nop 1
  s_bitcmp1_b32 s64, 7
  s_waitcnt vmcnt(6)
  s_cbranch_scc1 L_ma_290
  buffer_load_dwordx4 v[60:63], v4, s[8:11], s58 offen offset:128 nt
L_ma_290:
  s_cbranch_scc0 L_mb_291
  buffer_load_dwordx4 v[60:63], v4, s[8:11], s58 offen offset:128
L_mb_291:
  v_mfma_f32_16x16x32_bf16 v[20:23], v[16:19], v[64:67], v[20:23]
  s_bitcmp1_b32 s64, 7
  s_waitcnt vmcnt(6)
  s_cbranch_scc1 L_ma_292
  buffer_load_dwordx4 v[64:67], v4, s[8:11], s58 offen offset:256 nt
L_ma_292:
  s_cbranch_scc0 L_mb_293
  buffer_load_dwordx4 v[64:67], v4, s[8:11], s58 offen offset:256
L_mb_293:
  v_mfma_f32_16x16x32_bf16 v[24:27], v[16:19], v[68:71], v[24:27]
  v_readlane_b32 s64, v0, 50
  s_add_u32 s58, s91, 4915200
  s_bfe_u32 s65, s64, 0x30004
  s_mulk_i32 s65, 12288
  v_add_u32 v44, s65, v3
  v_add_u32 v45, 4294868992, v44
  v_min_u32 v4, v44, v45
  s_waitcnt vmcnt(5)
  s_bitcmp1_b32 s64, 7
  s_waitcnt vmcnt(6)
  s_barrier
  s_cbranch_scc1 L_ma_294
  buffer_load_dwordx4 v[68:71], v4, s[8:11], s58 offen offset:0 nt
L_ma_294:
  s_cbranch_scc0 L_mb_295
  buffer_load_dwordx4 v[68:71], v4, s[8:11], s58 offen offset:0
L_mb_295:
  v_mfma_f32_16x16x32_bf16 v[28:31], v[16:19], v[72:75], v[28:31]
  v_mov_b32_dpp v13, v14 row_newbcast:6 row_mask:0xf bank_mask:0x3
  v_mov_b32_dpp v13, v14 row_newbcast:14 row_mask:0xf bank_mask:0xc
  v_and_b32 v16, v8, v13
  v_and_b32 v17, v9, v13
  v_and_b32 v18, v10, v13
  v_and_b32 v19, v11, v13
  s_nop 1
  v_mfma_f32_16x16x32_bf16 v[20:23], v[16:19], a[60:63], v[20:23]
  v_mfma_f32_16x16x32_bf16 v[24:27], v[16:19], a[64:67], v[24:27]
  v_mfma_f32_16x16x32_bf16 v[28:31], v[16:19], a[68:71], v[28:31]
  v_mov_b32_dpp v13, v14 row_newbcast:7 row_mask:0xf bank_mask:0x3
  v_mov_b32_dpp v13, v14 row_newbcast:15 row_mask:0xf bank_mask:0xc
  v_and_b32 v16, v8, v13
  v_and_b32 v17, v9, v13
  v_and_b32 v18, v10, v13
  v_and_b32 v19, v11, v13
  s_nop 1
  s_bitcmp1_b32 s64, 7
  s_waitcnt vmcnt(6)
  s_cbranch_scc1 L_ma_296
  buffer_load_dwordx4 v[72:75], v4, s[8:11], s58 offen offset:128 nt
L_ma_296:
  s_cbranch_scc0 L_mb_297
  buffer_load_dwordx4 v[72:75], v4, s[8:11], s58 offen offset:128
L_mb_297:
  v_mfma_f32_16x16x32_bf16 v[20:23], v[16:19], v[76:79], v[20:23]
  s_bitcmp1_b32 s64, 7
  s_waitcnt vmcnt(6)
  s_cbranch_scc1 L_ma_298
  buffer_load_dwordx4 v[76:79], v4, s[8:11], s58 offen offset:256 nt
L_ma_298:
  s_cbranch_scc0 L_mb_299
  buffer_load_dwordx4 v[76:79], v4, s[8:11], s58 offen offset:256
L_mb_299:
  v_mfma_f32_16x16x32_bf16 v[24:27], v[16:19], v[48:51], v[24:27]
  v_readlane_b32 s64, v0, 52
  s_add_u32 s58, s91, 5111808
  s_bfe_u32 s65, s64, 0x30004
  s_mulk_i32 s65, 12288
  v_add_u32 v44, s65, v3
  v_add_u32 v45, 4294868992, v44
  v_min_u32 v4, v44, v45
  s_waitcnt vmcnt(5)
  s_bitcmp1_b32 s64, 7
  s_waitcnt vmcnt(6)
  s_barrier
  s_cbranch_scc1 L_ma_300
  buffer_load_dwordx4 v[48:51], v4, s[8:11], s58 offen offset:0 nt
L_ma_300:
  s_cbranch_scc0 L_mb_301
  buffer_load_dwordx4 v[48:51], v4, s[8:11], s58 offen offset:0
L_mb_301:
  v_mfma_f32_16x16x32_bf16 v[28:31], v[16:19], v[52:55], v[28:31]
  s_cmp_lg_u32 s94, 6
  s_cbranch_scc1 L_nf_302
  s_mov_b32 s78, 0
  s_call_b64 s[52:53], L_flush
L_nf_302:
  v_lshlrev_b32 v14, 16, v35
  v_cmp_lt_f32 vcc, s60, v14
  s_cbranch_vccz L_nr_303
  s_call_b64 s[52:53], L_rescale
L_nr_303:
  v_subrev_f32 v14, s60, v14
  v_mul_f32 v14, s85, v14
  v_exp_f32 v14, v14
  s_nop 0
  v_add_f32 v15, v15, v14
  v_cvt_pk_bf16_f32 v14, v14, v14
  s_nop 1
  v_mov_b32_dpp v13, v14 row_newbcast:1 row_mask:0xf bank_mask:0x3
  v_mov_b32_dpp v13, v14 row_newbcast:9 row_mask:0xf bank_mask:0xc
  v_and_b32 v16, v8, v13
  v_and_b32 v17, v9, v13
  v_and_b32 v18, v10, v13
  v_and_b32 v19, v11, v13
  s_nop 1
  s_bitcmp1_b32 s64, 7
  s_waitcnt vmcnt(6)
  s_cbranch_scc1 L_ma_304
  buffer_load_dwordx4 v[52:55], v4, s[8:11], s58 offen offset:128 nt
L_ma_304:
  s_cbranch_scc0 L_mb_305
  buffer_load_dwordx4 v[52:55], v4, s[8:11], s58 offen offset:128
L_mb_305:
  v_mfma_f32_16x16x32_bf16 v[20:23], v[16:19], v[56:59], v[20:23]
  s_bitcmp1_b32 s64, 7
  s_waitcnt vmcnt(6)
  s_cbranch_scc1 L_ma_306
  buffer_load_dwordx4 v[56:59], v4, s[8:11], s58 offen offset:256 nt
L_ma_306:
  s_cbranch_scc0 L_mb_307
  buffer_load_dwordx4 v[56:59], v4, s[8:11], s58 offen offset:256
L_mb_307:
  v_mfma_f32_16x16x32_bf16 v[24:27], v[16:19], v[60:63], v[24:27]
  v_readlane_b32 s64, v0, 53
  s_add_u32 s58, s91, 5210112
  s_bfe_u32 s65, s64, 0x30004
  s_mulk_i32 s65, 12288
  v_add_u32 v44, s65, v3
  v_add_u32 v45, 4294868992, v44
  v_min_u32 v4, v44, v45
  s_waitcnt vmcnt(5)
  s_bitcmp1_b32 s64, 7
  s_waitcnt vmcnt(6)
  s_barrier
  s_cbranch_scc1 L_ma_308
  buffer_load_dwordx4 v[60:63], v4, s[8:11], s58 offen offset:0 nt
L_ma_308:
  s_cbranch_scc0 L_mb_309
  buffer_load_dwordx4 v[60:63], v4, s[8:11], s58 offen offset:0
L_mb_309:
  v_mfma_f32_16x16x32_bf16 v[28:31], v[16:19], v[64:67], v[28:31]
  v_mov_b32_dpp v13, v14 row_newbcast:0 row_mask:0xf bank_mask:0x3
  v_mov_b32_dpp v13, v14 row_newbcast:8 row_mask:0xf bank_mask:0xc
  v_and_b32 v16, v8, v13
  v_and_b32 v17, v9, v13
  v_and_b32 v18, v10, v13
  v_and_b32 v19, v11, v13
  s_nop 1
  v_mfma_f32_16x16x32_bf16 v[20:23], v[16:19], a[72:75], v[20:23]
  v_mfma_f32_16x16x32_bf16 v[24:27], v[16:19], a[76:79], v[24:27]
  v_mfma_f32_16x16x32_bf16 v[28:31], v[16:19], a[80:83], v[28:31]
  v_mov_b32_dpp v13, v14 row_newbcast:2 row_mask:0xf bank_mask:0x3
  v_mov_b32_dpp v13, v14 row_newbcast:10 row_mask:0xf bank_mask:0xc
  v_and_b32 v16, v8, v13
  v_and_b32 v17, v9, v13
  v_and_b32 v18, v10, v13
  v_and_b32 v19, v11, v13
  s_nop 1
  s_bitcmp1_b32 s64, 7
  s_waitcnt vmcnt(6)
  s_cbranch_scc1 L_ma_310
  buffer_load_dwordx4 v[64:67], v4, s[8:11], s58 offen offset:128 nt
L_ma_310:
  s_cbranch_scc0 L_mb_311
  buffer_load_dwordx4 v[64:67], v4, s[8:11], s58 offen offset:128
L_mb_311:
  v_mfma_f32_16x16x32_bf16 v[20:23], v[16:19], v[68:71], v[20:23]
  s_bitcmp1_b32 s64, 7
  s_waitcnt vmcnt(6)
  s_cbranch_scc1 L_ma_312
  buffer_load_dwordx4 v[68:71], v4, s[8:11], s58 offen offset:256 nt
L_ma_312:
  s_cbranch_scc0 L_mb_313
  buffer_load_dwordx4 v[68:71], v4, s[8:11], s58 offen offset:256
L_mb_313:
  v_mfma_f32_16x16x32_bf16 v[24:27], v[16:19], v[72:75], v[24:27]
  v_readlane_b32 s64, v0, 55
  s_add_u32 s58, s91, 5406720
  s_bfe_u32 s65, s64, 0x30004
  s_mulk_i32 s65, 12288
  v_add_u32 v44, s65, v3
  v_add_u32 v45, 4294868992, v44
  v_min_u32 v4, v44, v45
  s_waitcnt vmcnt(5)
  s_bitcmp1_b32 s64, 7
  s_waitcnt vmcnt(6)
  s_barrier
  s_cbranch_scc1 L_ma_314
  buffer_load_dwordx4 v[72:75], v4, s[8:11], s58 offen offset:0 nt
L_ma_314:
  s_cbranch_scc0 L_mb_315
  buffer_load_dwordx4 v[72:75], v4, s[8:11], s58 offen offset:0
L_mb_315:
  v_mfma_f32_16x16x32_bf16 v[28:31], v[16:19], v[76:79], v[28:31]
  v_mov_b32_dpp v13, v14 row_newbcast:3 row_mask:0xf bank_mask:0x3
  v_mov_b32_dpp v13, v14 row_newbcast:11 row_mask:0xf bank_mask:0xc
  v_and_b32 v16, v8, v13
  v_and_b32 v17, v9, v13
  v_and_b32 v18, v10, v13
  v_and_b32 v19, v11, v13
  s_nop 1
  v_mfma_f32_16x16x32_bf16 v[20:23], v[16:19], a[84:87], v[20:23]
  v_mfma_f32_16x16x32_bf16 v[24:27], v[16:19], a[88:91], v[24:27]
  v_mfma_f32_16x16x32_bf16 v[28:31], v[16:19], a[92:95], v[28:31]
  s_xor_b32 s71, s2, 4
  s_lshl_b32 s71, s71, 7
  s_add_u32 s71, s71, 2621440
  v_mov_b32 v47, s99
  buffer_load_dword v47, v47, s[28:31], s71 offen sc1 nt
  v_mov_b32_dpp v13, v14 row_newbcast:4 row_mask:0xf bank_mask:0x3
  v_mov_b32_dpp v13, v14 row_newbcast:12 row_mask:0xf bank_mask:0xc
  v_and_b32 v16, v8, v13
  v_and_b32 v17, v9, v13
  v_and_b32 v18, v10, v13
  v_and_b32 v19, v11, v13
  s_nop 1
  s_bitcmp1_b32 s64, 7
  s_waitcnt vmcnt(7)
  s_cbranch_scc1 L_ma_316
  buffer_load_dwordx4 v[76:79], v4, s[8:11], s58 offen offset:128 nt
L_ma_316:
  s_cbranch_scc0 L_mb_317
  buffer_load_dwordx4 v[76:79], v4, s[8:11], s58 offen offset:128
L_mb_317:
  v_mfma_f32_16x16x32_bf16 v[20:23], v[16:19], v[48:51], v[20:23]
  s_bitcmp1_b32 s64, 7
  s_waitcnt vmcnt(7)
  s_cbranch_scc1 L_ma_318
  buffer_load_dwordx4 v[48:51], v4, s[8:11], s58 offen offset:256 nt
L_ma_318:
  s_cbranch_scc0 L_mb_319
  buffer_load_dwordx4 v[48:51], v4, s[8:11], s58 offen offset:256
L_mb_319:
  v_mfma_f32_16x16x32_bf16 v[24:27], v[16:19], v[52:55], v[24:27]
  v_readlane_b32 s64, v0, 57
  s_add_u32 s58, s91, 5603328
  s_bfe_u32 s65, s64, 0x30004
  s_mulk_i32 s65, 12288
  v_add_u32 v44, s65, v3
  v_add_u32 v45, 4294868992, v44
  v_min_u32 v4, v44, v45
  s_waitcnt vmcnt(6)
  s_bitcmp1_b32 s64, 7
  s_waitcnt vmcnt(7)
  s_barrier
  s_cbranch_scc1 L_ma_320
  buffer_load_dwordx4 v[52:55], v4, s[8:11], s58 offen offset:0 nt
L_ma_320:
  s_cbranch_scc0 L_mb_321
  buffer_load_dwordx4 v[52:55], v4, s[8:11], s58 offen offset:0
L_mb_321:
  v_mfma_f32_16x16x32_bf16 v[28:31], v[16:19], v[56:59], v[28:31]
  v_mov_b32_dpp v13, v14 row_newbcast:5 row_mask:0xf bank_mask:0x3
  v_mov_b32_dpp v13, v14 row_newbcast:13 row_mask:0xf bank_mask:0xc
  v_and_b32 v16, v8, v13
  v_and_b32 v17, v9, v13
  v_and_b32 v18, v10, v13
  v_and_b32 v19, v11, v13
  s_nop 1
  s_bitcmp1_b32 s64, 7
  s_waitcnt vmcnt(7)
  s_cbranch_scc1 L_ma_322
  buffer_load_dwordx4 v[56:59], v4, s[8:11], s58 offen offset:128 nt
L_ma_322:
  s_cbranch_scc0 L_mb_323
  buffer_load_dwordx4 v[56:59], v4, s[8:11], s58 offen offset:128
L_mb_323:
  v_mfma_f32_16x16x32_bf16 v[20:23], v[16:19], v[60:63], v[20:23]
  s_bitcmp1_b32 s64, 7
  s_waitcnt vmcnt(7)
  s_cbranch_scc1 L_ma_324
  buffer_load_dwordx4 v[60:63], v4, s[8:11], s58 offen offset:256 nt
L_ma_324:
  s_cbranch_scc0 L_mb_325
  buffer_load_dwordx4 v[60:63], v4, s[8:11], s58 offen offset:256
L_mb_325:
  v_mfma_f32_16x16x32_bf16 v[24:27], v[16:19], v[64:67], v[24:27]
  v_readlane_b32 s64, v0, 58
  s_add_u32 s58, s91, 5701632
  s_bfe_u32 s65, s64, 0x30004
  s_mulk_i32 s65, 12288
  v_add_u32 v44, s65, v3
  v_add_u32 v45, 4294868992, v44
  v_min_u32 v4, v44, v45
  s_waitcnt vmcnt(6)
  s_bitcmp1_b32 s64, 7
  s_waitcnt vmcnt(7)
  s_barrier
  s_cbranch_scc1 L_ma_326
  buffer_load_dwordx4 v[64:67], v4, s[8:11], s58 offen offset:0 nt
L_ma_326:
  s_cbranch_scc0 L_mb_327
  buffer_load_dwordx4 v[64:67], v4, s[8:11], s58 offen offset:0
L_mb_327:
  v_mfma_f32_16x16x32_bf16 v[28:31], v[16:19], v[68:71], v[28:31]
  v_mov_b32_dpp v13, v14 row_newbcast:6 row_mask:0xf bank_mask:0x3
  v_mov_b32_dpp v13, v14 row_newbcast:14 row_mask:0xf bank_mask:0xc
  v_and_b32 v16, v8, v13
  v_and_b32 v17, v9, v13
  v_and_b32 v18, v10, v13
  v_and_b32 v19, v11, v13
  s_nop 1
  v_mfma_f32_16x16x32_bf16 v[20:23], v[16:19], a[96:99], v[20:23]
  v_mfma_f32_16x16x32_bf16 v[24:27], v[16:19], a[100:103], v[24:27]
  v_mfma_f32_16x16x32_bf16 v[28:31], v[16:19], a[104:107], v[28:31]
  v_mov_b32_dpp v13, v14 row_newbcast:7 row_mask:0xf bank_mask:0x3
  v_mov_b32_dpp v13, v14 row_newbcast:15 row_mask:0xf bank_mask:0xc
  v_and_b32 v16, v8, v13
  v_and_b32 v17, v9, v13
  v_and_b32 v18, v10, v13
  v_and_b32 v19, v11, v13
  s_nop 1
  s_bitcmp1_b32 s64, 7
  s_waitcnt vmcnt(7)
  s_cbranch_scc1 L_ma_328
  buffer_load_dwordx4 v[68:71], v4, s[8:11], s58 offen offset:128 nt
L_ma_328:
  s_cbranch_scc0 L_mb_329
  buffer_load_dwordx4 v[68:71], v4, s[8:11], s58 offen offset:128
L_mb_329:
  v_mfma_f32_16x16x32_bf16 v[20:23], v[16:19], v[72:75], v[20:23]
  s_bitcmp1_b32 s64, 7
  s_waitcnt vmcnt(6)
  s_cbranch_scc1 L_ma_330
  buffer_load_dwordx4 v[72:75], v4, s[8:11], s58 offen offset:256 nt
L_ma_330:
  s_cbranch_scc0 L_mb_331
  buffer_load_dwordx4 v[72:75], v4, s[8:11], s58 offen offset:256
L_mb_331:
  v_mfma_f32_16x16x32_bf16 v[24:27], v[16:19], v[76:79], v[24:27]
  v_readlane_b32 s64, v0, 60
  s_add_u32 s58, s91, 5898240
  s_bfe_u32 s65, s64, 0x30004
  s_mulk_i32 s65, 12288
  v_add_u32 v44, s65, v3
  v_add_u32 v45, 4294868992, v44
  v_min_u32 v4, v44, v45
  s_waitcnt vmcnt(5)
  s_bitcmp1_b32 s64, 7
  s_waitcnt vmcnt(6)
  s_barrier
  s_cbranch_scc1 L_ma_332
  buffer_load_dwordx4 v[76:79], v4, s[8:11], s58 offen offset:0 nt
L_ma_332:
  s_cbranch_scc0 L_mb_333
  buffer_load_dwordx4 v[76:79], v4, s[8:11], s58 offen offset:0
L_mb_333:
  v_mfma_f32_16x16x32_bf16 v[28:31], v[16:19], v[48:51], v[28:31]
  v_and_b32 v14, 0xffff0000, v35
  v_readfirstlane_b32 s77, v47
  s_or_b32 s78, s88, s99
  s_cmp_lt_i32 s77, s78
  s_cbranch_scc1 L_fs_334
L_fk_335:
  v_lshl_or_b32 v46, v1, 4, s99
  s_xor_b32 s77, s87, 0x8000
  buffer_load_dwordx4 v[40:43], v46, s[28:31], s77 offen offset:1024 sc1 nt
  v_cmp_lt_f32 vcc, s60, v14
  s_cbranch_vccz L_nr_336
  s_call_b64 s[52:53], L_rescale
L_nr_336:
  v_subrev_f32 v14, s60, v14
  v_mul_f32 v14, s85, v14
  v_exp_f32 v14, v14
  s_nop 0
  v_add_f32 v15, v15, v14
  v_cvt_pk_bf16_f32 v14, v14, v14
  s_nop 1
  v_mov_b32_dpp v13, v14 row_newbcast:1 row_mask:0xf bank_mask:0x3
  v_mov_b32_dpp v13, v14 row_newbcast:9 row_mask:0xf bank_mask:0xc
  v_and_b32 v16, v8, v13
  v_and_b32 v17, v9, v13
  v_and_b32 v18, v10, v13
  v_and_b32 v19, v11, v13
  s_nop 1
  s_bitcmp1_b32 s64, 7
  s_waitcnt vmcnt(7)
  s_cbranch_scc1 L_ma_337
  buffer_load_dwordx4 v[48:51], v4, s[8:11], s58 offen offset:128 nt
L_ma_337:
  s_cbranch_scc0 L_mb_338
  buffer_load_dwordx4 v[48:51], v4, s[8:11], s58 offen offset:128
L_mb_338:
  v_mfma_f32_16x16x32_bf16 v[20:23], v[16:19], v[52:55], v[20:23]
  s_bitcmp1_b32 s64, 7
  s_waitcnt vmcnt(7)
  s_cbranch_scc1 L_ma_339
  buffer_load_dwordx4 v[52:55], v4, s[8:11], s58 offen offset:256 nt
L_ma_339:
  s_cbranch_scc0 L_mb_340
  buffer_load_dwordx4 v[52:55], v4, s[8:11], s58 offen offset:256
L_mb_340:
  v_mfma_f32_16x16x32_bf16 v[24:27], v[16:19], v[56:59], v[24:27]
  v_readlane_b32 s64, v0, 61
  s_add_u32 s58, s91, 5996544
  s_bfe_u32 s65, s64, 0x30004
  s_mulk_i32 s65, 12288
  v_add_u32 v44, s65, v3
  v_add_u32 v45, 4294868992, v44
  v_min_u32 v4, v44, v45
  s_waitcnt vmcnt(6)
  s_bitcmp1_b32 s64, 7
  s_waitcnt vmcnt(7)
  s_barrier
  s_cbranch_scc1 L_ma_341
  buffer_load_dwordx4 v[56:59], v4, s[8:11], s58 offen offset:0 nt
L_ma_341:
  s_cbranch_scc0 L_mb_342
  buffer_load_dwordx4 v[56:59], v4, s[8:11], s58 offen offset:0
L_mb_342:
  v_mfma_f32_16x16x32_bf16 v[28:31], v[16:19], v[60:63], v[28:31]
  v_mov_b32_dpp v13, v14 row_newbcast:0 row_mask:0xf bank_mask:0x3
  v_mov_b32_dpp v13, v14 row_newbcast:8 row_mask:0xf bank_mask:0xc
  v_and_b32 v16, v8, v13
  v_and_b32 v17, v9, v13
  v_and_b32 v18, v10, v13
  v_and_b32 v19, v11, v13
  s_nop 1
  v_mfma_f32_16x16x32_bf16 v[20:23], v[16:19], a[108:111], v[20:23]
  v_mfma_f32_16x16x32_bf16 v[24:27], v[16:19], a[112:115], v[24:27]
  v_mfma_f32_16x16x32_bf16 v[28:31], v[16:19], a[116:119], v[28:31]
  v_mov_b32_dpp v13, v14 row_newbcast:2 row_mask:0xf bank_mask:0x3
  v_mov_b32_dpp v13, v14 row_newbcast:10 row_mask:0xf bank_mask:0xc
  v_and_b32 v16, v8, v13
  v_and_b32 v17, v9, v13
  v_and_b32 v18, v10, v13
  v_and_b32 v19, v11, v13
  s_nop 1
  s_bitcmp1_b32 s64, 7
  s_waitcnt vmcnt(7)
  s_cbranch_scc1 L_ma_343
  buffer_load_dwordx4 v[60:63], v4, s[8:11], s58 offen offset:128 nt
L_ma_343:
  s_cbranch_scc0 L_mb_344
  buffer_load_dwordx4 v[60:63], v4, s[8:11], s58 offen offset:128
L_mb_344:
  v_mfma_f32_16x16x32_bf16 v[20:23], v[16:19], v[64:67], v[20:23]
  s_bitcmp1_b32 s64, 7
  s_waitcnt vmcnt(7)
  s_cbranch_scc1 L_ma_345
  buffer_load_dwordx4 v[64:67], v4, s[8:11], s58 offen offset:256 nt
L_ma_345:
  s_cbranch_scc0 L_mb_346
  buffer_load_dwordx4 v[64:67], v4, s[8:11], s58 offen offset:256
L_mb_346:
  v_mfma_f32_16x16x32_bf16 v[24:27], v[16:19], v[68:71], v[24:27]
  v_readlane_b32 s64, v0, 63
  s_add_u32 s58, s91, 6193152
  s_bfe_u32 s65, s64, 0x30004
  s_mulk_i32 s65, 12288
  v_add_u32 v44, s65, v3
  v_add_u32 v45, 4294868992, v44
  v_min_u32 v4, v44, v45
  s_waitcnt vmcnt(6)
  s_bitcmp1_b32 s64, 7
  s_waitcnt vmcnt(7)
  s_barrier
  s_cbranch_scc1 L_ma_347
  buffer_load_dwordx4 v[68:71], v4, s[8:11], s58 offen offset:0 nt
L_ma_347:
  s_cbranch_scc0 L_mb_348
  buffer_load_dwordx4 v[68:71], v4, s[8:11], s58 offen offset:0
L_mb_348:
  v_mfma_f32_16x16x32_bf16 v[28:31], v[16:19], v[72:75], v[28:31]
  v_mov_b32_dpp v13, v14 row_newbcast:3 row_mask:0xf bank_mask:0x3
  v_mov_b32_dpp v13, v14 row_newbcast:11 row_mask:0xf bank_mask:0xc
  v_and_b32 v16, v8, v13
  v_and_b32 v17, v9, v13
  v_and_b32 v18, v10, v13
  v_and_b32 v19, v11, v13
  s_nop 1
  v_mfma_f32_16x16x32_bf16 v[20:23], v[16:19], a[120:123], v[20:23]
  v_mfma_f32_16x16x32_bf16 v[24:27], v[16:19], a[124:127], v[24:27]
  v_mfma_f32_16x16x32_bf16 v[28:31], v[16:19], a[128:131], v[28:31]
  v_mov_b32_dpp v13, v14 row_newbcast:4 row_mask:0xf bank_mask:0x3
  v_mov_b32_dpp v13, v14 row_newbcast:12 row_mask:0xf bank_mask:0xc
  v_and_b32 v16, v8, v13
  v_and_b32 v17, v9, v13
  v_and_b32 v18, v10, v13
  v_and_b32 v19, v11, v13
  s_nop 1
  s_bitcmp1_b32 s64, 7
  s_waitcnt vmcnt(7)
  s_cbranch_scc1 L_ma_349
  buffer_load_dwordx4 v[72:75], v4, s[8:11], s58 offen offset:128 nt
L_ma_349:
  s_cbranch_scc0 L_mb_350
  buffer_load_dwordx4 v[72:75], v4, s[8:11], s58 offen offset:128
L_mb_350:
  v_mfma_f32_16x16x32_bf16 v[20:23], v[16:19], v[76:79], v[20:23]
  s_bitcmp1_b32 s64, 7
  s_waitcnt vmcnt(6)
  s_cbranch_scc1 L_ma_351
  buffer_load_dwordx4 v[76:79], v4, s[8:11], s58 offen offset:256 nt
L_ma_351:
  s_cbranch_scc0 L_mb_352
  buffer_load_dwordx4 v[76:79], v4, s[8:11], s58 offen offset:256
L_mb_352:
  v_mfma_f32_16x16x32_bf16 v[24:27], v[16:19], v[48:51], v[24:27]
  v_readlane_b32 s64, v0, 1
  s_add_u32 s58, s91, 6389760
  s_bfe_u32 s65, s64, 0x3000c
  s_mulk_i32 s65, 12288
  v_add_u32 v44, s65, v3
  v_add_u32 v45, 4294868992, v44
  v_min_u32 v4, v44, v45
  s_waitcnt vmcnt(5)
  s_bitcmp1_b32 s64, 15
  s_waitcnt vmcnt(6)
  s_barrier
  s_cbranch_scc1 L_ma_353
  buffer_load_dwordx4 v[48:51], v4, s[8:11], s58 offen offset:0 nt
L_ma_353:
  s_cbranch_scc0 L_mb_354
  buffer_load_dwordx4 v[48:51], v4, s[8:11], s58 offen offset:0
L_mb_354:
  v_mfma_f32_16x16x32_bf16 v[28:31], v[16:19], v[52:55], v[28:31]
  v_mov_b32_dpp v13, v14 row_newbcast:5 row_mask:0xf bank_mask:0x3
  v_mov_b32_dpp v13, v14 row_newbcast:13 row_mask:0xf bank_mask:0xc
  v_and_b32 v16, v8, v13
  v_and_b32 v17, v9, v13
  v_and_b32 v18, v10, v13
  v_and_b32 v19, v11, v13
  s_nop 1
  s_bitcmp1_b32 s64, 15
  s_waitcnt vmcnt(6)
  s_cbranch_scc1 L_ma_355
  buffer_load_dwordx4 v[52:55], v4, s[8:11], s58 offen offset:128 nt
L_ma_355:
  s_cbranch_scc0 L_mb_356
  buffer_load_dwordx4 v[52:55], v4, s[8:11], s58 offen offset:128
L_mb_356:
  v_mfma_f32_16x16x32_bf16 v[20:23], v[16:19], v[56:59], v[20:23]
  s_bitcmp1_b32 s64, 15
  s_waitcnt vmcnt(6)
  s_cbranch_scc1 L_ma_357
  buffer_load_dwordx4 v[56:59], v4, s[8:11], s58 offen offset:256 nt
L_ma_357:
  s_cbranch_scc0 L_mb_358
  buffer_load_dwordx4 v[56:59], v4, s[8:11], s58 offen offset:256
L_mb_358:
  v_mfma_f32_16x16x32_bf16 v[24:27], v[16:19], v[60:63], v[24:27]
  v_readlane_b32 s64, v0, 2
  s_add_u32 s58, s91, 6488064
  s_bfe_u32 s65, s64, 0x3000c
  s_mulk_i32 s65, 12288
  v_add_u32 v44, s65, v3
  v_add_u32 v45, 4294868992, v44
  v_min_u32 v4, v44, v45
  s_waitcnt vmcnt(5)
  s_bitcmp1_b32 s64, 15
  s_waitcnt vmcnt(6)
  s_barrier
  s_cbranch_scc1 L_ma_359
  buffer_load_dwordx4 v[60:63], v4, s[8:11], s58 offen offset:0 nt
L_ma_359:
  s_cbranch_scc0 L_mb_360
  buffer_load_dwordx4 v[60:63], v4, s[8:11], s58 offen offset:0
L_mb_360:
  v_mfma_f32_16x16x32_bf16 v[28:31], v[16:19], v[64:67], v[28:31]
  v_mov_b32_dpp v13, v14 row_newbcast:6 row_mask:0xf bank_mask:0x3
  v_mov_b32_dpp v13, v14 row_newbcast:14 row_mask:0xf bank_mask:0xc
  v_and_b32 v16, v8, v13
  v_and_b32 v17, v9, v13
  v_and_b32 v18, v10, v13
  v_and_b32 v19, v11, v13
  s_nop 1
  v_mfma_f32_16x16x32_bf16 v[20:23], v[16:19], a[132:135], v[20:23]
  v_mfma_f32_16x16x32_bf16 v[24:27], v[16:19], a[136:139], v[24:27]
  v_mfma_f32_16x16x32_bf16 v[28:31], v[16:19], a[140:143], v[28:31]
  v_mov_b32_dpp v13, v14 row_newbcast:7 row_mask:0xf bank_mask:0x3
  v_mov_b32_dpp v13, v14 row_newbcast:15 row_mask:0xf bank_mask:0xc
  v_and_b32 v16, v8, v13
  v_and_b32 v17, v9, v13
  v_and_b32 v18, v10, v13
  v_and_b32 v19, v11, v13
  s_nop 1
  s_bitcmp1_b32 s64, 15
  s_waitcnt vmcnt(6)
  s_cbranch_scc1 L_ma_361
  buffer_load_dwordx4 v[64:67], v4, s[8:11], s58 offen offset:128 nt
L_ma_361:
  s_cbranch_scc0 L_mb_362
  buffer_load_dwordx4 v[64:67], v4, s[8:11], s58 offen offset:128
L_mb_362:
  v_mfma_f32_16x16x32_bf16 v[20:23], v[16:19], v[68:71], v[20:23]
  s_bitcmp1_b32 s64, 15
  s_waitcnt vmcnt(6)
  s_cbranch_scc1 L_ma_363
  buffer_load_dwordx4 v[68:71], v4, s[8:11], s58 offen offset:256 nt
L_ma_363:
  s_cbranch_scc0 L_mb_364
  buffer_load_dwordx4 v[68:71], v4, s[8:11], s58 offen offset:256
L_mb_364:
  v_mfma_f32_16x16x32_bf16 v[24:27], v[16:19], v[72:75], v[24:27]
  v_readlane_b32 s64, v0, 4
  s_add_u32 s58, s91, 6684672
  s_bfe_u32 s65, s64, 0x3000c
  s_mulk_i32 s65, 12288
  v_add_u32 v44, s65, v3
  v_add_u32 v45, 4294868992, v44
  v_min_u32 v4, v44, v45
  s_waitcnt vmcnt(5)
  s_bitcmp1_b32 s64, 15
  s_waitcnt vmcnt(6)
  s_barrier
  s_cbranch_scc1 L_ma_365
  buffer_load_dwordx4 v[72:75], v4, s[8:11], s58 offen offset:0 nt
L_ma_365:
  s_cbranch_scc0 L_mb_366
  buffer_load_dwordx4 v[72:75], v4, s[8:11], s58 offen offset:0
L_mb_366:
  v_mfma_f32_16x16x32_bf16 v[28:31], v[16:19], v[76:79], v[28:31]
  v_and_b32 v46, 7, v1
  s_xor_b32 s77, s46, s50
  v_lshrrev_b32 v44, v46, s77
  v_bfe_i32 v45, v44, 0, 1
  v_bfe_i32 v13, v44, 8, 1
  v_alignbit_b32 v45, v13, v45, 16
  v_bfi_b32 v36, v45, v40, v36
  v_bfe_i32 v45, v44, 16, 1
  v_bfe_i32 v13, v44, 24, 1
  v_alignbit_b32 v45, v13, v45, 16
  v_bfi_b32 v37, v45, v41, v37
  s_xor_b32 s77, s47, s51
  v_lshrrev_b32 v44, v46, s77
  v_bfe_i32 v45, v44, 0, 1
  v_bfe_i32 v13, v44, 8, 1
  v_alignbit_b32 v45, v13, v45, 16
  v_bfi_b32 v38, v45, v42, v38
  v_bfe_i32 v45, v44, 16, 1
  v_bfe_i32 v13, v44, 24, 1
  v_alignbit_b32 v45, v13, v45, 16
  v_bfi_b32 v39, v45, v43, v39
  v_lshlrev_b32 v14, 16, v36
  v_cmp_lt_f32 vcc, s60, v14
  s_cbranch_vccz L_nr_367
  s_call_b64 s[52:53], L_rescale
L_nr_367:
  v_subrev_f32 v14, s60, v14
  v_mul_f32 v14, s85, v14
  v_exp_f32 v14, v14
  s_nop 0
  v_add_f32 v15, v15, v14
  v_cvt_pk_bf16_f32 v14, v14, v14
  s_nop 1
  v_mov_b32_dpp v13, v14 row_newbcast:1 row_mask:0xf bank_mask:0x3
  v_mov_b32_dpp v13, v14 row_newbcast:9 row_mask:0xf bank_mask:0xc
  v_and_b32 v16, v8, v13
  v_and_b32 v17, v9, v13
  v_and_b32 v18, v10, v13
  v_and_b32 v19, v11, v13
  s_nop 1
  s_bitcmp1_b32 s64, 15
  s_waitcnt vmcnt(6)
  s_cbranch_scc1 L_ma_368
  buffer_load_dwordx4 v[76:79], v4, s[8:11], s58 offen offset:128 nt
L_ma_368:
  s_cbranch_scc0 L_mb_369
  buffer_load_dwordx4 v[76:79], v4, s[8:11], s58 offen offset:128
L_mb_369:
  v_mfma_f32_16x16x32_bf16 v[20:23], v[16:19], v[48:51], v[20:23]
  s_bitcmp1_b32 s64, 15
  s_waitcnt vmcnt(6)
  s_cbranch_scc1 L_ma_370
  buffer_load_dwordx4 v[48:51], v4, s[8:11], s58 offen offset:256 nt
L_ma_370:
  s_cbranch_scc0 L_mb_371
  buffer_load_dwordx4 v[48:51], v4, s[8:11], s58 offen offset:256
L_mb_371:
  v_mfma_f32_16x16x32_bf16 v[24:27], v[16:19], v[52:55], v[24:27]
  v_readlane_b32 s64, v0, 5
  s_add_u32 s58, s91, 6782976
  s_bfe_u32 s65, s64, 0x3000c
  s_mulk_i32 s65, 12288
  v_add_u32 v44, s65, v3
  v_add_u32 v45, 4294868992, v44
  v_min_u32 v4, v44, v45
  s_waitcnt vmcnt(5)
  s_bitcmp1_b32 s64, 15
  s_waitcnt vmcnt(6)
  s_barrier
  s_cbranch_scc1 L_ma_372
  buffer_load_dwordx4 v[52:55], v4, s[8:11], s58 offen offset:0 nt
L_ma_372:
  s_cbranch_scc0 L_mb_373
  buffer_load_dwordx4 v[52:55], v4, s[8:11], s58 offen offset:0
L_mb_373:
  v_mfma_f32_16x16x32_bf16 v[28:31], v[16:19], v[56:59], v[28:31]
  v_mov_b32_dpp v13, v14 row_newbcast:0 row_mask:0xf bank_mask:0x3
  v_mov_b32_dpp v13, v14 row_newbcast:8 row_mask:0xf bank_mask:0xc
  v_and_b32 v16, v8, v13
  v_and_b32 v17, v9, v13
  v_and_b32 v18, v10, v13
  v_and_b32 v19, v11, v13
  s_nop 1
  v_mfma_f32_16x16x32_bf16 v[20:23], v[16:19], a[144:147], v[20:23]
  v_mfma_f32_16x16x32_bf16 v[24:27], v[16:19], a[148:151], v[24:27]
  v_mfma_f32_16x16x32_bf16 v[28:31], v[16:19], a[152:155], v[28:31]
  v_mov_b32_dpp v13, v14 row_newbcast:2 row_mask:0xf bank_mask:0x3
  v_mov_b32_dpp v13, v14 row_newbcast:10 row_mask:0xf bank_mask:0xc
  v_and_b32 v16, v8, v13
  v_and_b32 v17, v9, v13
  v_and_b32 v18, v10, v13
  v_and_b32 v19, v11, v13
  s_nop 1
  s_bitcmp1_b32 s64, 15
  s_waitcnt vmcnt(6)
  s_cbranch_scc1 L_ma_374
  buffer_load_dwordx4 v[56:59], v4, s[8:11], s58 offen offset:128 nt
L_ma_374:
  s_cbranch_scc0 L_mb_375
  buffer_load_dwordx4 v[56:59], v4, s[8:11], s58 offen offset:128
L_mb_375:
  v_mfma_f32_16x16x32_bf16 v[20:23], v[16:19], v[60:63], v[20:23]
  s_bitcmp1_b32 s64, 15
  s_waitcnt vmcnt(6)
  s_cbranch_scc1 L_ma_376
  buffer_load_dwordx4 v[60:63], v4, s[8:11], s58 offen offset:256 nt
L_ma_376:
  s_cbranch_scc0 L_mb_377
  buffer_load_dwordx4 v[60:63], v4, s[8:11], s58 offen offset:256
L_mb_377:
  v_mfma_f32_16x16x32_bf16 v[24:27], v[16:19], v[64:67], v[24:27]
  v_readlane_b32 s64, v0, 7
  s_add_u32 s58, s91, 6979584
  s_bfe_u32 s65, s64, 0x3000c
  s_mulk_i32 s65, 12288
  v_add_u32 v44, s65, v3
  v_add_u32 v45, 4294868992, v44
  v_min_u32 v4, v44, v45
  s_waitcnt vmcnt(5)
  s_bitcmp1_b32 s64, 15
  s_waitcnt vmcnt(6)
  s_barrier
  s_cbranch_scc1 L_ma_378
  buffer_load_dwordx4 v[64:67], v4, s[8:11], s58 offen offset:0 nt
L_ma_378:
  s_cbranch_scc0 L_mb_379
  buffer_load_dwordx4 v[64:67], v4, s[8:11], s58 offen offset:0
L_mb_379:
  v_mfma_f32_16x16x32_bf16 v[28:31], v[16:19], v[68:71], v[28:31]
  v_mov_b32_dpp v13, v14 row_newbcast:3 row_mask:0xf bank_mask:0x3
  v_mov_b32_dpp v13, v14 row_newbcast:11 row_mask:0xf bank_mask:0xc
  v_and_b32 v16, v8, v13
  v_and_b32 v17, v9, v13
  v_and_b32 v18, v10, v13
  v_and_b32 v19, v11, v13
  s_nop 1
  v_mfma_f32_16x16x32_bf16 v[20:23], v[16:19], a[156:159], v[20:23]
  v_mfma_f32_16x16x32_bf16 v[24:27], v[16:19], a[160:163], v[24:27]
  v_mfma_f32_16x16x32_bf16 v[28:31], v[16:19], a[164:167], v[28:31]
  v_mov_b32_dpp v13, v14 row_newbcast:4 row_mask:0xf bank_mask:0x3
  v_mov_b32_dpp v13, v14 row_newbcast:12 row_mask:0xf bank_mask:0xc
  v_and_b32 v16, v8, v13
  v_and_b32 v17, v9, v13
  v_and_b32 v18, v10, v13
  v_and_b32 v19, v11, v13
  s_nop 1
  s_bitcmp1_b32 s64, 15
  s_waitcnt vmcnt(6)
  s_cbranch_scc1 L_ma_380
  buffer_load_dwordx4 v[68:71], v4, s[8:11], s58 offen offset:128 nt
L_ma_380:
  s_cbranch_scc0 L_mb_381
  buffer_load_dwordx4 v[68:71], v4, s[8:11], s58 offen offset:128
L_mb_381:
  v_mfma_f32_16x16x32_bf16 v[20:23], v[16:19], v[72:75], v[20:23]
  s_bitcmp1_b32 s64, 15
  s_waitcnt vmcnt(6)
  s_cbranch_scc1 L_ma_382
  buffer_load_dwordx4 v[72:75], v4, s[8:11], s58 offen offset:256 nt
L_ma_382:
  s_cbranch_scc0 L_mb_383
  buffer_load_dwordx4 v[72:75], v4, s[8:11], s58 offen offset:256
L_mb_383:
  v_mfma_f32_16x16x32_bf16 v[24:27], v[16:19], v[76:79], v[24:27]
  v_readlane_b32 s64, v0, 9
  s_add_u32 s58, s91, 7176192
  s_bfe_u32 s65, s64, 0x3000c
  s_mulk_i32 s65, 12288
  v_add_u32 v44, s65, v3
  v_add_u32 v45, 4294868992, v44
  v_min_u32 v4, v44, v45
  s_waitcnt vmcnt(5)
  s_bitcmp1_b32 s64, 15
  s_waitcnt vmcnt(6)
  s_barrier
  s_cbranch_scc1 L_ma_384
  buffer_load_dwordx4 v[76:79], v4, s[8:11], s58 offen offset:0 nt
L_ma_384:
  s_cbranch_scc0 L_mb_385
  buffer_load_dwordx4 v[76:79], v4, s[8:11], s58 offen offset:0
L_mb_385:
  v_mfma_f32_16x16x32_bf16 v[28:31], v[16:19], v[48:51], v[28:31]
  v_mov_b32_dpp v13, v14 row_newbcast:5 row_mask:0xf bank_mask:0x3
  v_mov_b32_dpp v13, v14 row_newbcast:13 row_mask:0xf bank_mask:0xc
  v_and_b32 v16, v8, v13
  v_and_b32 v17, v9, v13
  v_and_b32 v18, v10, v13
  v_and_b32 v19, v11, v13
  s_nop 1
  s_bitcmp1_b32 s64, 15
  s_waitcnt vmcnt(6)
  s_cbranch_scc1 L_ma_386
  buffer_load_dwordx4 v[48:51], v4, s[8:11], s58 offen offset:128 nt
L_ma_386:
  s_cbranch_scc0 L_mb_387
  buffer_load_dwordx4 v[48:51], v4, s[8:11], s58 offen offset:128
L_mb_387:
  v_mfma_f32_16x16x32_bf16 v[20:23], v[16:19], v[52:55], v[20:23]
  s_bitcmp1_b32 s64, 15
  s_waitcnt vmcnt(6)
  s_cbranch_scc1 L_ma_388
  buffer_load_dwordx4 v[52:55], v4, s[8:11], s58 offen offset:256 nt
L_ma_388:
  s_cbranch_scc0 L_mb_389
  buffer_load_dwordx4 v[52:55], v4, s[8:11], s58 offen offset:256
L_mb_389:
  v_mfma_f32_16x16x32_bf16 v[24:27], v[16:19], v[56:59], v[24:27]
  v_readlane_b32 s64, v0, 10
  s_add_u32 s58, s91, 7274496
  s_bfe_u32 s65, s64, 0x3000c
  s_mulk_i32 s65, 12288
  v_add_u32 v44, s65, v3
  v_add_u32 v45, 4294868992, v44
  v_min_u32 v4, v44, v45
  s_waitcnt vmcnt(5)
  s_bitcmp1_b32 s64, 15
  s_waitcnt vmcnt(6)
  s_barrier
  s_cbranch_scc1 L_ma_390
  buffer_load_dwordx4 v[56:59], v4, s[8:11], s58 offen offset:0 nt
L_ma_390:
  s_cbranch_scc0 L_mb_391
  buffer_load_dwordx4 v[56:59], v4, s[8:11], s58 offen offset:0
L_mb_391:
  v_mfma_f32_16x16x32_bf16 v[28:31], v[16:19], v[60:63], v[28:31]
  v_mov_b32_dpp v13, v14 row_newbcast:6 row_mask:0xf bank_mask:0x3
  v_mov_b32_dpp v13, v14 row_newbcast:14 row_mask:0xf bank_mask:0xc
  v_and_b32 v16, v8, v13
  v_and_b32 v17, v9, v13
  v_and_b32 v18, v10, v13
  v_and_b32 v19, v11, v13
  s_nop 1
  v_mfma_f32_16x16x32_bf16 v[20:23], v[16:19], a[168:171], v[20:23]
  v_mfma_f32_16x16x32_bf16 v[24:27], v[16:19], a[172:175], v[24:27]
  v_mfma_f32_16x16x32_bf16 v[28:31], v[16:19], a[176:179], v[28:31]
  v_mov_b32_dpp v13, v14 row_newbcast:7 row_mask:0xf bank_mask:0x3
  v_mov_b32_dpp v13, v14 row_newbcast:15 row_mask:0xf bank_mask:0xc
  v_and_b32 v16, v8, v13
  v_and_b32 v17, v9, v13
  v_and_b32 v18, v10, v13
  v_and_b32 v19, v11, v13
  s_nop 1
  s_bitcmp1_b32 s64, 15
  s_waitcnt vmcnt(6)
  s_cbranch_scc1 L_ma_392
  buffer_load_dwordx4 v[60:63], v4, s[8:11], s58 offen offset:128 nt
L_ma_392:
  s_cbranch_scc0 L_mb_393
  buffer_load_dwordx4 v[60:63], v4, s[8:11], s58 offen offset:128
L_mb_393:
  v_mfma_f32_16x16x32_bf16 v[20:23], v[16:19], v[64:67], v[20:23]
  s_bitcmp1_b32 s64, 15
  s_waitcnt vmcnt(6)
  s_cbranch_scc1 L_ma_394
  buffer_load_dwordx4 v[64:67], v4, s[8:11], s58 offen offset:256 nt
L_ma_394:
  s_cbranch_scc0 L_mb_395
  buffer_load_dwordx4 v[64:67], v4, s[8:11], s58 offen offset:256
L_mb_395:
  v_mfma_f32_16x16x32_bf16 v[24:27], v[16:19], v[68:71], v[24:27]
  v_readlane_b32 s64, v0, 12
  s_add_u32 s58, s91, 7471104
  s_bfe_u32 s65, s64, 0x3000c
  s_mulk_i32 s65, 12288
  v_add_u32 v44, s65, v3
  v_add_u32 v45, 4294868992, v44
  v_min_u32 v4, v44, v45
  s_waitcnt vmcnt(5)
  s_bitcmp1_b32 s64, 15
  s_waitcnt vmcnt(6)
  s_barrier
  s_cbranch_scc1 L_ma_396
  buffer_load_dwordx4 v[68:71], v4, s[8:11], s58 offen offset:0 nt
L_ma_396:
  s_cbranch_scc0 L_mb_397
  buffer_load_dwordx4 v[68:71], v4, s[8:11], s58 offen offset:0
L_mb_397:
  v_mfma_f32_16x16x32_bf16 v[28:31], v[16:19], v[72:75], v[28:31]
  v_and_b32 v14, 0xffff0000, v36
  v_cmp_lt_f32 vcc, s60, v14
  s_cbranch_vccz L_nr_398
  s_call_b64 s[52:53], L_rescale
L_nr_398:
  v_subrev_f32 v14, s60, v14
  v_mul_f32 v14, s85, v14
  v_exp_f32 v14, v14
  s_nop 0
  v_add_f32 v15, v15, v14
  v_cvt_pk_bf16_f32 v14, v14, v14
  s_nop 1
  v_mov_b32_dpp v13, v14 row_newbcast:1 row_mask:0xf bank_mask:0x3
  v_mov_b32_dpp v13, v14 row_newbcast:9 row_mask:0xf bank_mask:0xc
  v_and_b32 v16, v8, v13
  v_and_b32 v17, v9, v13
  v_and_b32 v18, v10, v13
  v_and_b32 v19, v11, v13
  s_nop 1
  s_bitcmp1_b32 s64, 15
  s_waitcnt vmcnt(6)
  s_cbranch_scc1 L_ma_399
  buffer_load_dwordx4 v[72:75], v4, s[8:11], s58 offen offset:128 nt
L_ma_399:
  s_cbranch_scc0 L_mb_400
  buffer_load_dwordx4 v[72:75], v4, s[8:11], s58 offen offset:128
L_mb_400:
  v_mfma_f32_16x16x32_bf16 v[20:23], v[16:19], v[76:79], v[20:23]
  s_bitcmp1_b32 s64, 15
  s_waitcnt vmcnt(6)
  s_cbranch_scc1 L_ma_401
  buffer_load_dwordx4 v[76:79], v4, s[8:11], s58 offen offset:256 nt
L_ma_401:
  s_cbranch_scc0 L_mb_402
  buffer_load_dwordx4 v[76:79], v4, s[8:11], s58 offen offset:256
L_mb_402:
  v_mfma_f32_16x16x32_bf16 v[24:27], v[16:19], v[48:51], v[24:27]
  v_readlane_b32 s64, v0, 13
  s_add_u32 s58, s91, 7569408
  s_bfe_u32 s65, s64, 0x3000c
  s_mulk_i32 s65, 12288
  v_add_u32 v44, s65, v3
  v_add_u32 v45, 4294868992, v44
  v_min_u32 v4, v44, v45
  s_waitcnt vmcnt(5)
  s_bitcmp1_b32 s64, 15
  s_waitcnt vmcnt(6)
  s_barrier
  s_cbranch_scc1 L_ma_403
  buffer_load_dwordx4 v[48:51], v4, s[8:11], s58 offen offset:0 nt
L_ma_403:
  s_cbranch_scc0 L_mb_404
  buffer_load_dwordx4 v[48:51], v4, s[8:11], s58 offen offset:0
L_mb_404:
  v_mfma_f32_16x16x32_bf16 v[28:31], v[16:19], v[52:55], v[28:31]
  v_mov_b32_dpp v13, v14 row_newbcast:0 row_mask:0xf bank_mask:0x3
  v_mov_b32_dpp v13, v14 row_newbcast:8 row_mask:0xf bank_mask:0xc
  v_and_b32 v16, v8, v13
  v_and_b32 v17, v9, v13
  v_and_b32 v18, v10, v13
  v_and_b32 v19, v11, v13
  s_nop 1
  v_mfma_f32_16x16x32_bf16 v[20:23], v[16:19], a[180:183], v[20:23]
  v_mfma_f32_16x16x32_bf16 v[24:27], v[16:19], a[184:187], v[24:27]
  v_mfma_f32_16x16x32_bf16 v[28:31], v[16:19], a[188:191], v[28:31]
  v_mov_b32_dpp v13, v14 row_newbcast:2 row_mask:0xf bank_mask:0x3
  v_mov_b32_dpp v13, v14 row_newbcast:10 row_mask:0xf bank_mask:0xc
  v_and_b32 v16, v8, v13
  v_and_b32 v17, v9, v13
  v_and_b32 v18, v10, v13
  v_and_b32 v19, v11, v13
  s_nop 1
  s_bitcmp1_b32 s64, 15
  s_waitcnt vmcnt(6)
  s_cbranch_scc1 L_ma_405
  buffer_load_dwordx4 v[52:55], v4, s[8:11], s58 offen offset:128 nt
L_ma_405:
  s_cbranch_scc0 L_mb_406
  buffer_load_dwordx4 v[52:55], v4, s[8:11], s58 offen offset:128
L_mb_406:
  v_mfma_f32_16x16x32_bf16 v[20:23], v[16:19], v[56:59], v[20:23]
  s_bitcmp1_b32 s64, 15
  s_waitcnt vmcnt(6)
  s_cbranch_scc1 L_ma_407
  buffer_load_dwordx4 v[56:59], v4, s[8:11], s58 offen offset:256 nt
L_ma_407:
  s_cbranch_scc0 L_mb_408
  buffer_load_dwordx4 v[56:59], v4, s[8:11], s58 offen offset:256
L_mb_408:
  v_mfma_f32_16x16x32_bf16 v[24:27], v[16:19], v[60:63], v[24:27]
  v_readlane_b32 s64, v0, 15
  s_add_u32 s58, s91, 7766016
  s_bfe_u32 s65, s64, 0x3000c
  s_mulk_i32 s65, 12288
  v_add_u32 v44, s65, v3
  v_add_u32 v45, 4294868992, v44
  v_min_u32 v4, v44, v45
  s_waitcnt vmcnt(5)
  s_bitcmp1_b32 s64, 15
  s_waitcnt vmcnt(6)
  s_barrier
  s_cbranch_scc1 L_ma_409
  buffer_load_dwordx4 v[60:63], v4, s[8:11], s58 offen offset:0 nt
L_ma_409:
  s_cbranch_scc0 L_mb_410
  buffer_load_dwordx4 v[60:63], v4, s[8:11], s58 offen offset:0
L_mb_410:
  v_mfma_f32_16x16x32_bf16 v[28:31], v[16:19], v[64:67], v[28:31]
  v_mov_b32_dpp v13, v14 row_newbcast:3 row_mask:0xf bank_mask:0x3
  v_mov_b32_dpp v13, v14 row_newbcast:11 row_mask:0xf bank_mask:0xc
  v_and_b32 v16, v8, v13
  v_and_b32 v17, v9, v13
  v_and_b32 v18, v10, v13
  v_and_b32 v19, v11, v13
  s_nop 1
  v_mfma_f32_16x16x32_bf16 v[20:23], v[16:19], a[192:195], v[20:23]
  v_mfma_f32_16x16x32_bf16 v[24:27], v[16:19], a[196:199], v[24:27]
  v_mfma_f32_16x16x32_bf16 v[28:31], v[16:19], a[200:203], v[28:31]
  v_mov_b32_dpp v13, v14 row_newbcast:4 row_mask:0xf bank_mask:0x3
  v_mov_b32_dpp v13, v14 row_newbcast:12 row_mask:0xf bank_mask:0xc
  v_and_b32 v16, v8, v13
  v_and_b32 v17, v9, v13
  v_and_b32 v18, v10, v13
  v_and_b32 v19, v11, v13
  s_nop 1
  s_bitcmp1_b32 s64, 15
  s_waitcnt vmcnt(6)
  s_cbranch_scc1 L_ma_411
  buffer_load_dwordx4 v[64:67], v4, s[8:11], s58 offen offset:128 nt
L_ma_411:
  s_cbranch_scc0 L_mb_412
  buffer_load_dwordx4 v[64:67], v4, s[8:11], s58 offen offset:128
L_mb_412:
  v_mfma_f32_16x16x32_bf16 v[20:23], v[16:19], v[68:71], v[20:23]
  s_bitcmp1_b32 s64, 15
  s_waitcnt vmcnt(6)
  s_cbranch_scc1 L_ma_413
  buffer_load_dwordx4 v[68:71], v4, s[8:11], s58 offen offset:256 nt
L_ma_413:
  s_cbranch_scc0 L_mb_414
  buffer_load_dwordx4 v[68:71], v4, s[8:11], s58 offen offset:256
L_mb_414:
  v_mfma_f32_16x16x32_bf16 v[24:27], v[16:19], v[72:75], v[24:27]
  v_readlane_b32 s64, v0, 17
  s_add_u32 s58, s93, 7962624
  s_bfe_u32 s65, s64, 0x3000c
  s_mulk_i32 s65, 12288
  v_add_u32 v44, s65, v3
  v_add_u32 v45, 4294868992, v44
  v_min_u32 v4, v44, v45
  s_waitcnt vmcnt(5)
  s_bitcmp1_b32 s64, 15
  s_waitcnt vmcnt(6)
  s_barrier
  s_cbranch_scc1 L_ma_415
  buffer_load_dwordx4 v[72:75], v4, s[8:11], s58 offen offset:0 nt
L_ma_415:
  s_cbranch_scc0 L_mb_416
  buffer_load_dwordx4 v[72:75], v4, s[8:11], s58 offen offset:0
L_mb_416:
  v_mfma_f32_16x16x32_bf16 v[28:31], v[16:19], v[76:79], v[28:31]
  v_mov_b32_dpp v13, v14 row_newbcast:5 row_mask:0xf bank_mask:0x3
  v_mov_b32_dpp v13, v14 row_newbcast:13 row_mask:0xf bank_mask:0xc
  v_and_b32 v16, v8, v13
  v_and_b32 v17, v9, v13
  v_and_b32 v18, v10, v13
  v_and_b32 v19, v11, v13
  s_nop 1
  s_bitcmp1_b32 s64, 15
  s_waitcnt vmcnt(6)
  s_cbranch_scc1 L_ma_417
  buffer_load_dwordx4 v[76:79], v4, s[8:11], s58 offen offset:128 nt
L_ma_417:
  s_cbranch_scc0 L_mb_418
  buffer_load_dwordx4 v[76:79], v4, s[8:11], s58 offen offset:128
L_mb_418:
  v_mfma_f32_16x16x32_bf16 v[20:23], v[16:19], v[48:51], v[20:23]
  s_bitcmp1_b32 s64, 15
  s_waitcnt vmcnt(6)
  s_cbranch_scc1 L_ma_419
  buffer_load_dwordx4 v[48:51], v4, s[8:11], s58 offen offset:256 nt
L_ma_419:
  s_cbranch_scc0 L_mb_420
  buffer_load_dwordx4 v[48:51], v4, s[8:11], s58 offen offset:256
L_mb_420:
  v_mfma_f32_16x16x32_bf16 v[24:27], v[16:19], v[52:55], v[24:27]
  v_readlane_b32 s64, v0, 18
  s_add_u32 s58, s93, 8060928
  s_bfe_u32 s65, s64, 0x3000c
  s_mulk_i32 s65, 12288
  v_add_u32 v44, s65, v3
  v_add_u32 v45, 4294868992, v44
  v_min_u32 v4, v44, v45
  s_waitcnt vmcnt(5)
  s_bitcmp1_b32 s64, 15
  s_waitcnt vmcnt(6)
  s_barrier
  s_cbranch_scc1 L_ma_421
  buffer_load_dwordx4 v[52:55], v4, s[8:11], s58 offen offset:0 nt
L_ma_421:
  s_cbranch_scc0 L_mb_422
  buffer_load_dwordx4 v[52:55], v4, s[8:11], s58 offen offset:0
L_mb_422:
  v_mfma_f32_16x16x32_bf16 v[28:31], v[16:19], v[56:59], v[28:31]
  v_mov_b32_dpp v13, v14 row_newbcast:6 row_mask:0xf bank_mask:0x3
  v_mov_b32_dpp v13, v14 row_newbcast:14 row_mask:0xf bank_mask:0xc
  v_and_b32 v16, v8, v13
  v_and_b32 v17, v9, v13
  v_and_b32 v18, v10, v13
  v_and_b32 v19, v11, v13
  s_nop 1
  v_mfma_f32_16x16x32_bf16 v[20:23], v[16:19], a[204:207], v[20:23]
  v_mfma_f32_16x16x32_bf16 v[24:27], v[16:19], a[208:211], v[24:27]
  v_mfma_f32_16x16x32_bf16 v[28:31], v[16:19], a[212:215], v[28:31]
  v_mov_b32_dpp v13, v14 row_newbcast:7 row_mask:0xf bank_mask:0x3
  v_mov_b32_dpp v13, v14 row_newbcast:15 row_mask:0xf bank_mask:0xc
  v_and_b32 v16, v8, v13
  v_and_b32 v17, v9, v13
  v_and_b32 v18, v10, v13
  v_and_b32 v19, v11, v13
  s_nop 1
  s_bitcmp1_b32 s64, 15
  s_waitcnt vmcnt(6)
  s_cbranch_scc1 L_ma_423
  buffer_load_dwordx4 v[56:59], v4, s[8:11], s58 offen offset:128 nt
L_ma_423:
  s_cbranch_scc0 L_mb_424
  buffer_load_dwordx4 v[56:59], v4, s[8:11], s58 offen offset:128
L_mb_424:
  v_mfma_f32_16x16x32_bf16 v[20:23], v[16:19], v[60:63], v[20:23]
  s_bitcmp1_b32 s64, 15
  s_waitcnt vmcnt(6)
  s_cbranch_scc1 L_ma_425
  buffer_load_dwordx4 v[60:63], v4, s[8:11], s58 offen offset:256 nt
L_ma_425:
  s_cbranch_scc0 L_mb_426
  buffer_load_dwordx4 v[60:63], v4, s[8:11], s58 offen offset:256
L_mb_426:
  v_mfma_f32_16x16x32_bf16 v[24:27], v[16:19], v[64:67], v[24:27]
  v_readlane_b32 s64, v0, 20
  s_add_u32 s58, s93, 8257536
  s_bfe_u32 s65, s64, 0x3000c
  s_mulk_i32 s65, 12288
  v_add_u32 v44, s65, v3
  v_add_u32 v45, 4294868992, v44
  v_min_u32 v4, v44, v45
  s_waitcnt vmcnt(5)
  s_bitcmp1_b32 s64, 15
  s_waitcnt vmcnt(6)
  s_barrier
  s_cbranch_scc1 L_ma_427
  buffer_load_dwordx4 v[64:67], v4, s[8:11], s58 offen offset:0 nt
L_ma_427:
  s_cbranch_scc0 L_mb_428
  buffer_load_dwordx4 v[64:67], v4, s[8:11], s58 offen offset:0
L_mb_428:
  v_mfma_f32_16x16x32_bf16 v[28:31], v[16:19], v[68:71], v[28:31]
  s_cmp_lg_u32 s95, 10
  s_cbranch_scc1 L_nf_429
  s_mov_b32 s78, 1
  s_call_b64 s[52:53], L_flush
L_nf_429:
  v_lshlrev_b32 v14, 16, v37
  v_cmp_lt_f32 vcc, s60, v14
  s_cbranch_vccz L_nr_430
  s_call_b64 s[52:53], L_rescale
L_nr_430:
  v_subrev_f32 v14, s60, v14
  v_mul_f32 v14, s85, v14
  v_exp_f32 v14, v14
  s_nop 0
  v_add_f32 v15, v15, v14
  v_cvt_pk_bf16_f32 v14, v14, v14
  s_nop 1
  v_mov_b32_dpp v13, v14 row_newbcast:1 row_mask:0xf bank_mask:0x3
  v_mov_b32_dpp v13, v14 row_newbcast:9 row_mask:0xf bank_mask:0xc
  v_and_b32 v16, v8, v13
  v_and_b32 v17, v9, v13
  v_and_b32 v18, v10, v13
  v_and_b32 v19, v11, v13
  s_nop 1
  s_bitcmp1_b32 s64, 15
  s_waitcnt vmcnt(6)
  s_cbranch_scc1 L_ma_431
  buffer_load_dwordx4 v[68:71], v4, s[8:11], s58 offen offset:128 nt
L_ma_431:
  s_cbranch_scc0 L_mb_432
  buffer_load_dwordx4 v[68:71], v4, s[8:11], s58 offen offset:128
L_mb_432:
  v_mfma_f32_16x16x32_bf16 v[20:23], v[16:19], v[72:75], v[20:23]
  s_bitcmp1_b32 s64, 15
  s_waitcnt vmcnt(6)
  s_cbranch_scc1 L_ma_433
  buffer_load_dwordx4 v[72:75], v4, s[8:11], s58 offen offset:256 nt
L_ma_433:
  s_cbranch_scc0 L_mb_434
  buffer_load_dwordx4 v[72:75], v4, s[8:11], s58 offen offset:256
L_mb_434:
  v_mfma_f32_16x16x32_bf16 v[24:27], v[16:19], v[76:79], v[24:27]
  v_readlane_b32 s64, v0, 21
  s_add_u32 s58, s93, 8355840
  s_bfe_u32 s65, s64, 0x3000c
  s_mulk_i32 s65, 12288
  v_add_u32 v44, s65, v3
  v_add_u32 v45, 4294868992, v44
  v_min_u32 v4, v44, v45
  s_waitcnt vmcnt(5)
  s_bitcmp1_b32 s64, 15
  s_waitcnt vmcnt(6)
  s_barrier
  s_cbranch_scc1 L_ma_435
  buffer_load_dwordx4 v[76:79], v4, s[8:11], s58 offen offset:0 nt
L_ma_435:
  s_cbranch_scc0 L_mb_436
  buffer_load_dwordx4 v[76:79], v4, s[8:11], s58 offen offset:0
L_mb_436:
  v_mfma_f32_16x16x32_bf16 v[28:31], v[16:19], v[48:51], v[28:31]
  v_mov_b32_dpp v13, v14 row_newbcast:0 row_mask:0xf bank_mask:0x3
  v_mov_b32_dpp v13, v14 row_newbcast:8 row_mask:0xf bank_mask:0xc
  v_and_b32 v16, v8, v13
  v_and_b32 v17, v9, v13
  v_and_b32 v18, v10, v13
  v_and_b32 v19, v11, v13
  s_nop 1
  v_mfma_f32_16x16x32_bf16 v[20:23], v[16:19], a[216:219], v[20:23]
  v_mfma_f32_16x16x32_bf16 v[24:27], v[16:19], a[220:223], v[24:27]
  v_mfma_f32_16x16x32_bf16 v[28:31], v[16:19], a[224:227], v[28:31]
  v_mov_b32_dpp v13, v14 row_newbcast:2 row_mask:0xf bank_mask:0x3
  v_mov_b32_dpp v13, v14 row_newbcast:10 row_mask:0xf bank_mask:0xc
  v_and_b32 v16, v8, v13
  v_and_b32 v17, v9, v13
  v_and_b32 v18, v10, v13
  v_and_b32 v19, v11, v13
  s_nop 1
  s_bitcmp1_b32 s64, 15
  s_waitcnt vmcnt(6)
  s_cbranch_scc1 L_ma_437
  buffer_load_dwordx4 v[48:51], v4, s[8:11], s58 offen offset:128 nt
L_ma_437:
  s_cbranch_scc0 L_mb_438
  buffer_load_dwordx4 v[48:51], v4, s[8:11], s58 offen offset:128
L_mb_438:
  v_mfma_f32_16x16x32_bf16 v[20:23], v[16:19], v[52:55], v[20:23]
  s_bitcmp1_b32 s64, 15
  s_waitcnt vmcnt(6)
  s_cbranch_scc1 L_ma_439
  buffer_load_dwordx4 v[52:55], v4, s[8:11], s58 offen offset:256 nt
L_ma_439:
  s_cbranch_scc0 L_mb_440
  buffer_load_dwordx4 v[52:55], v4, s[8:11], s58 offen offset:256
L_mb_440:
  v_mfma_f32_16x16x32_bf16 v[24:27], v[16:19], v[56:59], v[24:27]
  v_readlane_b32 s64, v0, 23
  s_add_u32 s58, s93, 8552448
  s_bfe_u32 s65, s64, 0x3000c
  s_mulk_i32 s65, 12288
  v_add_u32 v44, s65, v3
  v_add_u32 v45, 4294868992, v44
  v_min_u32 v4, v44, v45
  s_waitcnt vmcnt(5)
  s_bitcmp1_b32 s64, 15
  s_waitcnt vmcnt(6)
  s_barrier
  s_cbranch_scc1 L_ma_441
  buffer_load_dwordx4 v[56:59], v4, s[8:11], s58 offen offset:0 nt
L_ma_441:
  s_cbranch_scc0 L_mb_442
  buffer_load_dwordx4 v[56:59], v4, s[8:11], s58 offen offset:0
L_mb_442:
  v_mfma_f32_16x16x32_bf16 v[28:31], v[16:19], v[60:63], v[28:31]
  v_mov_b32_dpp v13, v14 row_newbcast:3 row_mask:0xf bank_mask:0x3
  v_mov_b32_dpp v13, v14 row_newbcast:11 row_mask:0xf bank_mask:0xc
  v_and_b32 v16, v8, v13
  v_and_b32 v17, v9, v13
  v_and_b32 v18, v10, v13
  v_and_b32 v19, v11, v13
  s_nop 1
  v_mfma_f32_16x16x32_bf16 v[20:23], v[16:19], a[228:231], v[20:23]
  v_mfma_f32_16x16x32_bf16 v[24:27], v[16:19], a[232:235], v[24:27]
  v_mfma_f32_16x16x32_bf16 v[28:31], v[16:19], a[236:239], v[28:31]
  v_mov_b32_dpp v13, v14 row_newbcast:4 row_mask:0xf bank_mask:0x3
  v_mov_b32_dpp v13, v14 row_newbcast:12 row_mask:0xf bank_mask:0xc
  v_and_b32 v16, v8, v13
  v_and_b32 v17, v9, v13
  v_and_b32 v18, v10, v13
  v_and_b32 v19, v11, v13
  s_nop 1
  s_bitcmp1_b32 s64, 15
  s_waitcnt vmcnt(6)
  s_cbranch_scc1 L_ma_443
  buffer_load_dwordx4 v[60:63], v4, s[8:11], s58 offen offset:128 nt
L_ma_443:
  s_cbranch_scc0 L_mb_444
  buffer_load_dwordx4 v[60:63], v4, s[8:11], s58 offen offset:128
L_mb_444:
  v_mfma_f32_16x16x32_bf16 v[20:23], v[16:19], v[64:67], v[20:23]
  s_bitcmp1_b32 s64, 15
  s_waitcnt vmcnt(6)
  s_cbranch_scc1 L_ma_445
  buffer_load_dwordx4 v[64:67], v4, s[8:11], s58 offen offset:256 nt
L_ma_445:
  s_cbranch_scc0 L_mb_446
  buffer_load_dwordx4 v[64:67], v4, s[8:11], s58 offen offset:256
L_mb_446:
  v_mfma_f32_16x16x32_bf16 v[24:27], v[16:19], v[68:71], v[24:27]
  v_readlane_b32 s64, v0, 25
  s_add_u32 s58, s92, 8749056
  s_bfe_u32 s65, s64, 0x3000c
  s_mulk_i32 s65, 12288
  v_add_u32 v44, s65, v3
  v_add_u32 v45, 4294868992, v44
  v_min_u32 v4, v44, v45
  s_waitcnt vmcnt(5)
  s_bitcmp1_b32 s64, 15
  s_waitcnt vmcnt(6)
  s_barrier
  s_cbranch_scc1 L_ma_447
  buffer_load_dwordx4 v[68:71], v4, s[8:11], s58 offen offset:0 nt
L_ma_447:
  s_cbranch_scc0 L_mb_448
  buffer_load_dwordx4 v[68:71], v4, s[8:11], s58 offen offset:0
L_mb_448:
  v_mfma_f32_16x16x32_bf16 v[28:31], v[16:19], v[72:75], v[28:31]
  v_mov_b32_dpp v13, v14 row_newbcast:5 row_mask:0xf bank_mask:0x3
  v_mov_b32_dpp v13, v14 row_newbcast:13 row_mask:0xf bank_mask:0xc
  v_and_b32 v16, v8, v13
  v_and_b32 v17, v9, v13
  v_and_b32 v18, v10, v13
  v_and_b32 v19, v11, v13
  s_nop 1
  s_bitcmp1_b32 s64, 15
  s_waitcnt vmcnt(6)
  s_cbranch_scc1 L_ma_449
  buffer_load_dwordx4 v[72:75], v4, s[8:11], s58 offen offset:128 nt
L_ma_449:
  s_cbranch_scc0 L_mb_450
  buffer_load_dwordx4 v[72:75], v4, s[8:11], s58 offen offset:128
L_mb_450:
  v_mfma_f32_16x16x32_bf16 v[20:23], v[16:19], v[76:79], v[20:23]
  s_bitcmp1_b32 s64, 15
  s_waitcnt vmcnt(6)
  s_cbranch_scc1 L_ma_451
  buffer_load_dwordx4 v[76:79], v4, s[8:11], s58 offen offset:256 nt
L_ma_451:
  s_cbranch_scc0 L_mb_452
  buffer_load_dwordx4 v[76:79], v4, s[8:11], s58 offen offset:256
L_mb_452:
  v_mfma_f32_16x16x32_bf16 v[24:27], v[16:19], v[48:51], v[24:27]
  v_readlane_b32 s64, v0, 26
  s_add_u32 s58, s92, 8847360
  s_bfe_u32 s65, s64, 0x3000c
  s_mulk_i32 s65, 12288
  v_add_u32 v44, s65, v3
  v_add_u32 v45, 4294868992, v44
  v_min_u32 v4, v44, v45
  s_waitcnt vmcnt(5)
  s_bitcmp1_b32 s64, 15
  s_waitcnt vmcnt(6)
  s_barrier
  s_cbranch_scc1 L_ma_453
  buffer_load_dwordx4 v[48:51], v4, s[8:11], s58 offen offset:0 nt
L_ma_453:
  s_cbranch_scc0 L_mb_454
  buffer_load_dwordx4 v[48:51], v4, s[8:11], s58 offen offset:0
L_mb_454:
  v_mfma_f32_16x16x32_bf16 v[28:31], v[16:19], v[52:55], v[28:31]
  v_mov_b32_dpp v13, v14 row_newbcast:6 row_mask:0xf bank_mask:0x3
  v_mov_b32_dpp v13, v14 row_newbcast:14 row_mask:0xf bank_mask:0xc
  v_and_b32 v16, v8, v13
  v_and_b32 v17, v9, v13
  v_and_b32 v18, v10, v13
  v_and_b32 v19, v11, v13
  s_nop 1
  v_mfma_f32_16x16x32_bf16 v[20:23], v[16:19], a[240:243], v[20:23]
  v_mfma_f32_16x16x32_bf16 v[24:27], v[16:19], a[244:247], v[24:27]
  v_mfma_f32_16x16x32_bf16 v[28:31], v[16:19], a[248:251], v[28:31]
  v_mov_b32_dpp v13, v14 row_newbcast:7 row_mask:0xf bank_mask:0x3
  v_mov_b32_dpp v13, v14 row_newbcast:15 row_mask:0xf bank_mask:0xc
  v_and_b32 v16, v8, v13
  v_and_b32 v17, v9, v13
  v_and_b32 v18, v10, v13
  v_and_b32 v19, v11, v13
  s_nop 1
  s_bitcmp1_b32 s64, 15
  s_waitcnt vmcnt(6)
  s_cbranch_scc1 L_ma_455
  buffer_load_dwordx4 v[52:55], v4, s[8:11], s58 offen offset:128 nt
L_ma_455:
  s_cbranch_scc0 L_mb_456
  buffer_load_dwordx4 v[52:55], v4, s[8:11], s58 offen offset:128
L_mb_456:
  v_mfma_f32_16x16x32_bf16 v[20:23], v[16:19], v[56:59], v[20:23]
  s_bitcmp1_b32 s64, 15
  s_waitcnt vmcnt(6)
  s_cbranch_scc1 L_ma_457
  buffer_load_dwordx4 v[56:59], v4, s[8:11], s58 offen offset:256 nt
L_ma_457:
  s_cbranch_scc0 L_mb_458
  buffer_load_dwordx4 v[56:59], v4, s[8:11], s58 offen offset:256
L_mb_458:
  v_mfma_f32_16x16x32_bf16 v[24:27], v[16:19], v[60:63], v[24:27]
  v_readlane_b32 s64, v0, 28
  s_add_u32 s58, s92, 9043968
  s_bfe_u32 s65, s64, 0x3000c
  s_mulk_i32 s65, 12288
  v_add_u32 v44, s65, v3
  v_add_u32 v45, 4294868992, v44
  v_min_u32 v4, v44, v45
  s_waitcnt vmcnt(5)
  s_bitcmp1_b32 s64, 15
  s_waitcnt vmcnt(6)
  s_barrier
  s_cbranch_scc1 L_ma_459
  buffer_load_dwordx4 v[60:63], v4, s[8:11], s58 offen offset:0 nt
L_ma_459:
  s_cbranch_scc0 L_mb_460
  buffer_load_dwordx4 v[60:63], v4, s[8:11], s58 offen offset:0
L_mb_460:
  v_mfma_f32_16x16x32_bf16 v[28:31], v[16:19], v[64:67], v[28:31]
  s_cmp_lg_u32 s95, 11
  s_cbranch_scc1 L_nf_461
  s_mov_b32 s78, 1
  s_call_b64 s[52:53], L_flush
L_nf_461:
  v_and_b32 v14, 0xffff0000, v37
  v_cmp_lt_f32 vcc, s60, v14
  s_cbranch_vccz L_nr_462
  s_call_b64 s[52:53], L_rescale
L_nr_462:
  v_subrev_f32 v14, s60, v14
  v_mul_f32 v14, s85, v14
  v_exp_f32 v14, v14
  s_nop 0
  v_add_f32 v15, v15, v14
  v_cvt_pk_bf16_f32 v14, v14, v14
  s_nop 1
  v_mov_b32_dpp v13, v14 row_newbcast:1 row_mask:0xf bank_mask:0x3
  v_mov_b32_dpp v13, v14 row_newbcast:9 row_mask:0xf bank_mask:0xc
  v_and_b32 v16, v8, v13
  v_and_b32 v17, v9, v13
  v_and_b32 v18, v10, v13
  v_and_b32 v19, v11, v13
  s_nop 1
  s_bitcmp1_b32 s64, 15
  s_waitcnt vmcnt(6)
  s_cbranch_scc1 L_ma_463
  buffer_load_dwordx4 v[64:67], v4, s[8:11], s58 offen offset:128 nt
L_ma_463:
  s_cbranch_scc0 L_mb_464
  buffer_load_dwordx4 v[64:67], v4, s[8:11], s58 offen offset:128
L_mb_464:
  v_mfma_f32_16x16x32_bf16 v[20:23], v[16:19], v[68:71], v[20:23]
  s_bitcmp1_b32 s64, 15
  s_waitcnt vmcnt(6)
  s_cbranch_scc1 L_ma_465
  buffer_load_dwordx4 v[68:71], v4, s[8:11], s58 offen offset:256 nt
L_ma_465:
  s_cbranch_scc0 L_mb_466
  buffer_load_dwordx4 v[68:71], v4, s[8:11], s58 offen offset:256
L_mb_466:
  v_mfma_f32_16x16x32_bf16 v[24:27], v[16:19], v[72:75], v[24:27]
  v_readlane_b32 s64, v0, 29
  s_add_u32 s58, s92, 9142272
  s_bfe_u32 s65, s64, 0x3000c
  s_mulk_i32 s65, 12288
  v_add_u32 v44, s65, v3
  v_add_u32 v45, 4294868992, v44
  v_min_u32 v4, v44, v45
  s_waitcnt vmcnt(5)
  s_bitcmp1_b32 s64, 15
  s_waitcnt vmcnt(6)
  s_barrier
  s_cbranch_scc1 L_ma_467
  buffer_load_dwordx4 v[72:75], v4, s[8:11], s58 offen offset:0 nt
L_ma_467:
  s_cbranch_scc0 L_mb_468
  buffer_load_dwordx4 v[72:75], v4, s[8:11], s58 offen offset:0
L_mb_468:
  v_mfma_f32_16x16x32_bf16 v[28:31], v[16:19], v[76:79], v[28:31]
  v_mov_b32_dpp v13, v14 row_newbcast:0 row_mask:0xf bank_mask:0x3
  v_mov_b32_dpp v13, v14 row_newbcast:8 row_mask:0xf bank_mask:0xc
  v_and_b32 v16, v8, v13
  v_and_b32 v17, v9, v13
  v_and_b32 v18, v10, v13
  v_and_b32 v19, v11, v13
  s_nop 1
  v_mfma_f32_16x16x32_bf16 v[20:23], v[16:19], a[252:255], v[20:23]
  v_mfma_f32_16x16x32_bf16 v[24:27], v[16:19], v[92:95], v[24:27]
  v_mfma_f32_16x16x32_bf16 v[28:31], v[16:19], v[96:99], v[28:31]
  v_mov_b32_dpp v13, v14 row_newbcast:2 row_mask:0xf bank_mask:0x3
  v_mov_b32_dpp v13, v14 row_newbcast:10 row_mask:0xf bank_mask:0xc
  v_and_b32 v16, v8, v13
  v_and_b32 v17, v9, v13
  v_and_b32 v18, v10, v13
  v_and_b32 v19, v11, v13
  s_nop 1
  s_bitcmp1_b32 s64, 15
  s_waitcnt vmcnt(6)
  s_cbranch_scc1 L_ma_469
  buffer_load_dwordx4 v[76:79], v4, s[8:11], s58 offen offset:128 nt
L_ma_469:
  s_cbranch_scc0 L_mb_470
  buffer_load_dwordx4 v[76:79], v4, s[8:11], s58 offen offset:128
L_mb_470:
  v_mfma_f32_16x16x32_bf16 v[20:23], v[16:19], v[48:51], v[20:23]
  s_bitcmp1_b32 s64, 15
  s_waitcnt vmcnt(6)
  s_cbranch_scc1 L_ma_471
  buffer_load_dwordx4 v[48:51], v4, s[8:11], s58 offen offset:256 nt
L_ma_471:
  s_cbranch_scc0 L_mb_472
  buffer_load_dwordx4 v[48:51], v4, s[8:11], s58 offen offset:256
L_mb_472:
  v_mfma_f32_16x16x32_bf16 v[24:27], v[16:19], v[52:55], v[24:27]
  v_readlane_b32 s64, v0, 31
  s_add_u32 s58, s92, 9338880
  s_bfe_u32 s65, s64, 0x3000c
  s_mulk_i32 s65, 12288
  v_add_u32 v44, s65, v3
  v_add_u32 v45, 4294868992, v44
  v_min_u32 v4, v44, v45
  s_waitcnt vmcnt(5)
  s_bitcmp1_b32 s64, 15
  s_waitcnt vmcnt(6)
  s_barrier
  s_cbranch_scc1 L_ma_473
  buffer_load_dwordx4 v[52:55], v4, s[8:11], s58 offen offset:0 nt
L_ma_473:
  s_cbranch_scc0 L_mb_474
  buffer_load_dwordx4 v[52:55], v4, s[8:11], s58 offen offset:0
L_mb_474:
  v_mfma_f32_16x16x32_bf16 v[28:31], v[16:19], v[56:59], v[28:31]
  v_mov_b32_dpp v13, v14 row_newbcast:3 row_mask:0xf bank_mask:0x3
  v_mov_b32_dpp v13, v14 row_newbcast:11 row_mask:0xf bank_mask:0xc
  v_and_b32 v16, v8, v13
  v_and_b32 v17, v9, v13
  v_and_b32 v18, v10, v13
  v_and_b32 v19, v11, v13
  s_nop 1
  v_mfma_f32_16x16x32_bf16 v[20:23], v[16:19], v[100:103], v[20:23]
  v_mfma_f32_16x16x32_bf16 v[24:27], v[16:19], v[104:107], v[24:27]
  v_mfma_f32_16x16x32_bf16 v[28:31], v[16:19], v[108:111], v[28:31]
  v_mov_b32_dpp v13, v14 row_newbcast:4 row_mask:0xf bank_mask:0x3
  v_mov_b32_dpp v13, v14 row_newbcast:12 row_mask:0xf bank_mask:0xc
  v_and_b32 v16, v8, v13
  v_and_b32 v17, v9, v13
  v_and_b32 v18, v10, v13
  v_and_b32 v19, v11, v13
  s_nop 1
  s_bitcmp1_b32 s64, 15
  s_waitcnt vmcnt(6)
  s_cbranch_scc1 L_ma_475
  buffer_load_dwordx4 v[56:59], v4, s[8:11], s58 offen offset:128 nt
L_ma_475:
  s_cbranch_scc0 L_mb_476
  buffer_load_dwordx4 v[56:59], v4, s[8:11], s58 offen offset:128
L_mb_476:
  v_mfma_f32_16x16x32_bf16 v[20:23], v[16:19], v[60:63], v[20:23]
  s_bitcmp1_b32 s64, 15
  s_waitcnt vmcnt(6)
  s_cbranch_scc1 L_ma_477
  buffer_load_dwordx4 v[60:63], v4, s[8:11], s58 offen offset:256 nt
L_ma_477:
  s_cbranch_scc0 L_mb_478
  buffer_load_dwordx4 v[60:63], v4, s[8:11], s58 offen offset:256
L_mb_478:
  v_mfma_f32_16x16x32_bf16 v[24:27], v[16:19], v[64:67], v[24:27]
  v_readlane_b32 s64, v0, 33
  s_add_u32 s58, s92, 9535488
  s_bfe_u32 s65, s64, 0x3000c
  s_mulk_i32 s65, 12288
  v_add_u32 v44, s65, v3
  v_add_u32 v45, 4294868992, v44
  v_min_u32 v4, v44, v45
  s_waitcnt vmcnt(5)
  s_bitcmp1_b32 s64, 15
  s_waitcnt vmcnt(6)
  s_barrier
  s_cbranch_scc1 L_ma_479
  buffer_load_dwordx4 v[64:67], v4, s[8:11], s58 offen offset:0 nt
L_ma_479:
  s_cbranch_scc0 L_mb_480
  buffer_load_dwordx4 v[64:67], v4, s[8:11], s58 offen offset:0
L_mb_480:
  v_mfma_f32_16x16x32_bf16 v[28:31], v[16:19], v[68:71], v[28:31]
  v_mov_b32_dpp v13, v14 row_newbcast:5 row_mask:0xf bank_mask:0x3
  v_mov_b32_dpp v13, v14 row_newbcast:13 row_mask:0xf bank_mask:0xc
  v_and_b32 v16, v8, v13
  v_and_b32 v17, v9, v13
  v_and_b32 v18, v10, v13
  v_and_b32 v19, v11, v13
  s_nop 1
  s_bitcmp1_b32 s64, 15
  s_waitcnt vmcnt(6)
  s_cbranch_scc1 L_ma_481
  buffer_load_dwordx4 v[68:71], v4, s[8:11], s58 offen offset:128 nt
L_ma_481:
  s_cbranch_scc0 L_mb_482
  buffer_load_dwordx4 v[68:71], v4, s[8:11], s58 offen offset:128
L_mb_482:
  v_mfma_f32_16x16x32_bf16 v[20:23], v[16:19], v[72:75], v[20:23]
  s_bitcmp1_b32 s64, 15
  s_waitcnt vmcnt(6)
  s_cbranch_scc1 L_ma_483
  buffer_load_dwordx4 v[72:75], v4, s[8:11], s58 offen offset:256 nt
L_ma_483:
  s_cbranch_scc0 L_mb_484
  buffer_load_dwordx4 v[72:75], v4, s[8:11], s58 offen offset:256
L_mb_484:
  v_mfma_f32_16x16x32_bf16 v[24:27], v[16:19], v[76:79], v[24:27]
  v_readlane_b32 s64, v0, 34
  s_add_u32 s58, s92, 9633792
  s_bfe_u32 s65, s64, 0x3000c
  s_mulk_i32 s65, 12288
  v_add_u32 v44, s65, v3
  v_add_u32 v45, 4294868992, v44
  v_min_u32 v4, v44, v45
  s_waitcnt vmcnt(5)
  s_bitcmp1_b32 s64, 15
  s_waitcnt vmcnt(6)
  s_barrier
  s_cbranch_scc1 L_ma_485
  buffer_load_dwordx4 v[76:79], v4, s[8:11], s58 offen offset:0 nt
L_ma_485:
  s_cbranch_scc0 L_mb_486
  buffer_load_dwordx4 v[76:79], v4, s[8:11], s58 offen offset:0
L_mb_486:
  v_mfma_f32_16x16x32_bf16 v[28:31], v[16:19], v[48:51], v[28:31]
  v_mov_b32_dpp v13, v14 row_newbcast:6 row_mask:0xf bank_mask:0x3
  v_mov_b32_dpp v13, v14 row_newbcast:14 row_mask:0xf bank_mask:0xc
  v_and_b32 v16, v8, v13
  v_and_b32 v17, v9, v13
  v_and_b32 v18, v10, v13
  v_and_b32 v19, v11, v13
  s_nop 1
  v_mfma_f32_16x16x32_bf16 v[20:23], v[16:19], v[112:115], v[20:23]
  v_mfma_f32_16x16x32_bf16 v[24:27], v[16:19], v[116:119], v[24:27]
  v_mfma_f32_16x16x32_bf16 v[28:31], v[16:19], v[120:123], v[28:31]
  v_mov_b32_dpp v13, v14 row_newbcast:7 row_mask:0xf bank_mask:0x3
  v_mov_b32_dpp v13, v14 row_newbcast:15 row_mask:0xf bank_mask:0xc
  v_and_b32 v16, v8, v13
  v_and_b32 v17, v9, v13
  v_and_b32 v18, v10, v13
  v_and_b32 v19, v11, v13
  s_nop 1
  s_bitcmp1_b32 s64, 15
  s_waitcnt vmcnt(6)
  s_cbranch_scc1 L_ma_487
  buffer_load_dwordx4 v[48:51], v4, s[8:11], s58 offen offset:128 nt
L_ma_487:
  s_cbranch_scc0 L_mb_488
  buffer_load_dwordx4 v[48:51], v4, s[8:11], s58 offen offset:128
L_mb_488:
  v_mfma_f32_16x16x32_bf16 v[20:23], v[16:19], v[52:55], v[20:23]
  s_bitcmp1_b32 s64, 15
  s_waitcnt vmcnt(6)
  s_cbranch_scc1 L_ma_489
  buffer_load_dwordx4 v[52:55], v4, s[8:11], s58 offen offset:256 nt
L_ma_489:
  s_cbranch_scc0 L_mb_490
  buffer_load_dwordx4 v[52:55], v4, s[8:11], s58 offen offset:256
L_mb_490:
  v_mfma_f32_16x16x32_bf16 v[24:27], v[16:19], v[56:59], v[24:27]
  v_readlane_b32 s64, v0, 36
  s_add_u32 s58, s92, 9830400
  s_bfe_u32 s65, s64, 0x3000c
  s_mulk_i32 s65, 12288
  v_add_u32 v44, s65, v3
  v_add_u32 v45, 4294868992, v44
  v_min_u32 v4, v44, v45
  s_waitcnt vmcnt(5)
  s_bitcmp1_b32 s64, 15
  s_waitcnt vmcnt(6)
  s_barrier
  s_cbranch_scc1 L_ma_491
  buffer_load_dwordx4 v[56:59], v4, s[8:11], s58 offen offset:0 nt
L_ma_491:
  s_cbranch_scc0 L_mb_492
  buffer_load_dwordx4 v[56:59], v4, s[8:11], s58 offen offset:0
L_mb_492:
  v_mfma_f32_16x16x32_bf16 v[28:31], v[16:19], v[60:63], v[28:31]
  v_lshlrev_b32 v14, 16, v38
  v_cmp_lt_f32 vcc, s60, v14
  s_cbranch_vccz L_nr_493
  s_call_b64 s[52:53], L_rescale
L_nr_493:
  v_subrev_f32 v14, s60, v14
  v_mul_f32 v14, s85, v14
  v_exp_f32 v14, v14
  s_nop 0
  v_add_f32 v15, v15, v14
  v_cvt_pk_bf16_f32 v14, v14, v14
  s_nop 1
  v_mov_b32_dpp v13, v14 row_newbcast:1 row_mask:0xf bank_mask:0x3
  v_mov_b32_dpp v13, v14 row_newbcast:9 row_mask:0xf bank_mask:0xc
  v_and_b32 v16, v8, v13
  v_and_b32 v17, v9, v13
  v_and_b32 v18, v10, v13
  v_and_b32 v19, v11, v13
  s_nop 1
  s_bitcmp1_b32 s64, 15
  s_waitcnt vmcnt(6)
  s_cbranch_scc1 L_ma_494
  buffer_load_dwordx4 v[60:63], v4, s[8:11], s58 offen offset:128 nt
L_ma_494:
  s_cbranch_scc0 L_mb_495
  buffer_load_dwordx4 v[60:63], v4, s[8:11], s58 offen offset:128
L_mb_495:
  v_mfma_f32_16x16x32_bf16 v[20:23], v[16:19], v[64:67], v[20:23]
  s_bitcmp1_b32 s64, 15
  s_waitcnt vmcnt(6)
  s_cbranch_scc1 L_ma_496
  buffer_load_dwordx4 v[64:67], v4, s[8:11], s58 offen offset:256 nt
L_ma_496:
  s_cbranch_scc0 L_mb_497
  buffer_load_dwordx4 v[64:67], v4, s[8:11], s58 offen offset:256
L_mb_497:
  v_mfma_f32_16x16x32_bf16 v[24:27], v[16:19], v[68:71], v[24:27]
  v_readlane_b32 s64, v0, 37
  s_add_u32 s58, s92, 9928704
  s_bfe_u32 s65, s64, 0x3000c
  s_mulk_i32 s65, 12288
  v_add_u32 v44, s65, v3
  v_add_u32 v45, 4294868992, v44
  v_min_u32 v4, v44, v45
  s_waitcnt vmcnt(5)
  s_bitcmp1_b32 s64, 15
  s_waitcnt vmcnt(6)
  s_barrier
  s_cbranch_scc1 L_ma_498
  buffer_load_dwordx4 v[68:71], v4, s[8:11], s58 offen offset:0 nt
L_ma_498:
  s_cbranch_scc0 L_mb_499
  buffer_load_dwordx4 v[68:71], v4, s[8:11], s58 offen offset:0
L_mb_499:
  v_mfma_f32_16x16x32_bf16 v[28:31], v[16:19], v[72:75], v[28:31]
  v_mov_b32_dpp v13, v14 row_newbcast:0 row_mask:0xf bank_mask:0x3
  v_mov_b32_dpp v13, v14 row_newbcast:8 row_mask:0xf bank_mask:0xc
  v_and_b32 v16, v8, v13
  v_and_b32 v17, v9, v13
  v_and_b32 v18, v10, v13
  v_and_b32 v19, v11, v13
  s_nop 1
  v_mfma_f32_16x16x32_bf16 v[20:23], v[16:19], v[124:127], v[20:23]
  v_mfma_f32_16x16x32_bf16 v[24:27], v[16:19], v[128:131], v[24:27]
  v_mfma_f32_16x16x32_bf16 v[28:31], v[16:19], v[132:135], v[28:31]
  v_mov_b32_dpp v13, v14 row_newbcast:2 row_mask:0xf bank_mask:0x3
  v_mov_b32_dpp v13, v14 row_newbcast:10 row_mask:0xf bank_mask:0xc
  v_and_b32 v16, v8, v13
  v_and_b32 v17, v9, v13
  v_and_b32 v18, v10, v13
  v_and_b32 v19, v11, v13
  s_nop 1
  s_bitcmp1_b32 s64, 15
  s_waitcnt vmcnt(6)
  s_cbranch_scc1 L_ma_500
  buffer_load_dwordx4 v[72:75], v4, s[8:11], s58 offen offset:128 nt
L_ma_500:
  s_cbranch_scc0 L_mb_501
  buffer_load_dwordx4 v[72:75], v4, s[8:11], s58 offen offset:128
L_mb_501:
  v_mfma_f32_16x16x32_bf16 v[20:23], v[16:19], v[76:79], v[20:23]
  s_bitcmp1_b32 s64, 15
  s_waitcnt vmcnt(6)
  s_cbranch_scc1 L_ma_502
  buffer_load_dwordx4 v[76:79], v4, s[8:11], s58 offen offset:256 nt
L_ma_502:
  s_cbranch_scc0 L_mb_503
  buffer_load_dwordx4 v[76:79], v4, s[8:11], s58 offen offset:256
L_mb_503:
  v_mfma_f32_16x16x32_bf16 v[24:27], v[16:19], v[48:51], v[24:27]
  v_readlane_b32 s64, v0, 39
  s_add_u32 s58, s92, 10125312
  s_bfe_u32 s65, s64, 0x3000c
  s_mulk_i32 s65, 12288
  v_add_u32 v44, s65, v3
  v_add_u32 v45, 4294868992, v44
  v_min_u32 v4, v44, v45
  s_waitcnt vmcnt(5)
  s_bitcmp1_b32 s64, 15
  s_waitcnt vmcnt(6)
  s_barrier
  s_cbranch_scc1 L_ma_504
  buffer_load_dwordx4 v[48:51], v4, s[8:11], s58 offen offset:0 nt
L_ma_504:
  s_cbranch_scc0 L_mb_505
  buffer_load_dwordx4 v[48:51], v4, s[8:11], s58 offen offset:0
L_mb_505:
  v_mfma_f32_16x16x32_bf16 v[28:31], v[16:19], v[52:55], v[28:31]
  v_mov_b32_dpp v13, v14 row_newbcast:3 row_mask:0xf bank_mask:0x3
  v_mov_b32_dpp v13, v14 row_newbcast:11 row_mask:0xf bank_mask:0xc
  v_and_b32 v16, v8, v13
  v_and_b32 v17, v9, v13
  v_and_b32 v18, v10, v13
  v_and_b32 v19, v11, v13
  s_nop 1
  v_mfma_f32_16x16x32_bf16 v[20:23], v[16:19], v[136:139], v[20:23]
  v_mfma_f32_16x16x32_bf16 v[24:27], v[16:19], v[140:143], v[24:27]
  v_mfma_f32_16x16x32_bf16 v[28:31], v[16:19], v[144:147], v[28:31]
  v_mov_b32_dpp v13, v14 row_newbcast:4 row_mask:0xf bank_mask:0x3
  v_mov_b32_dpp v13, v14 row_newbcast:12 row_mask:0xf bank_mask:0xc
  v_and_b32 v16, v8, v13
  v_and_b32 v17, v9, v13
  v_and_b32 v18, v10, v13
  v_and_b32 v19, v11, v13
  s_nop 1
  s_bitcmp1_b32 s64, 15
  s_waitcnt vmcnt(6)
  s_cbranch_scc1 L_ma_506
  buffer_load_dwordx4 v[52:55], v4, s[8:11], s58 offen offset:128 nt
L_ma_506:
  s_cbranch_scc0 L_mb_507
  buffer_load_dwordx4 v[52:55], v4, s[8:11], s58 offen offset:128
L_mb_507:
  v_mfma_f32_16x16x32_bf16 v[20:23], v[16:19], v[56:59], v[20:23]
  s_bitcmp1_b32 s64, 15
  s_waitcnt vmcnt(6)
  s_cbranch_scc1 L_ma_508
  buffer_load_dwordx4 v[56:59], v4, s[8:11], s58 offen offset:256 nt
L_ma_508:
  s_cbranch_scc0 L_mb_509
  buffer_load_dwordx4 v[56:59], v4, s[8:11], s58 offen offset:256
L_mb_509:
  v_mfma_f32_16x16x32_bf16 v[24:27], v[16:19], v[60:63], v[24:27]
  v_readlane_b32 s64, v0, 41
  s_add_u32 s58, s92, 10321920
  s_bfe_u32 s65, s64, 0x3000c
  s_mulk_i32 s65, 12288
  v_add_u32 v44, s65, v3
  v_add_u32 v45, 4294868992, v44
  v_min_u32 v4, v44, v45
  s_waitcnt vmcnt(5)
  s_bitcmp1_b32 s64, 15
  s_waitcnt vmcnt(6)
  s_barrier
  s_cbranch_scc1 L_ma_510
  buffer_load_dwordx4 v[60:63], v4, s[8:11], s58 offen offset:0 nt
L_ma_510:
  s_cbranch_scc0 L_mb_511
  buffer_load_dwordx4 v[60:63], v4, s[8:11], s58 offen offset:0
L_mb_511:
  v_mfma_f32_16x16x32_bf16 v[28:31], v[16:19], v[64:67], v[28:31]
  v_mov_b32_dpp v13, v14 row_newbcast:5 row_mask:0xf bank_mask:0x3
  v_mov_b32_dpp v13, v14 row_newbcast:13 row_mask:0xf bank_mask:0xc
  v_and_b32 v16, v8, v13
  v_and_b32 v17, v9, v13
  v_and_b32 v18, v10, v13
  v_and_b32 v19, v11, v13
  s_nop 1
  s_bitcmp1_b32 s64, 15
  s_waitcnt vmcnt(6)
  s_cbranch_scc1 L_ma_512
  buffer_load_dwordx4 v[64:67], v4, s[8:11], s58 offen offset:128 nt
L_ma_512:
  s_cbranch_scc0 L_mb_513
  buffer_load_dwordx4 v[64:67], v4, s[8:11], s58 offen offset:128
L_mb_513:
  v_mfma_f32_16x16x32_bf16 v[20:23], v[16:19], v[68:71], v[20:23]
  s_bitcmp1_b32 s64, 15
  s_waitcnt vmcnt(6)
  s_cbranch_scc1 L_ma_514
  buffer_load_dwordx4 v[68:71], v4, s[8:11], s58 offen offset:256 nt
L_ma_514:
  s_cbranch_scc0 L_mb_515
  buffer_load_dwordx4 v[68:71], v4, s[8:11], s58 offen offset:256
L_mb_515:
  v_mfma_f32_16x16x32_bf16 v[24:27], v[16:19], v[72:75], v[24:27]
  v_readlane_b32 s64, v0, 42
  s_add_u32 s58, s92, 10420224
  s_bfe_u32 s65, s64, 0x3000c
  s_mulk_i32 s65, 12288
  v_add_u32 v44, s65, v3
  v_add_u32 v45, 4294868992, v44
  v_min_u32 v4, v44, v45
  s_waitcnt vmcnt(5)
  s_bitcmp1_b32 s64, 15
  s_waitcnt vmcnt(6)
  s_barrier
  s_cbranch_scc1 L_ma_516
  buffer_load_dwordx4 v[72:75], v4, s[8:11], s58 offen offset:0 nt
L_ma_516:
  s_cbranch_scc0 L_mb_517
  buffer_load_dwordx4 v[72:75], v4, s[8:11], s58 offen offset:0
L_mb_517:
  v_mfma_f32_16x16x32_bf16 v[28:31], v[16:19], v[76:79], v[28:31]
  v_mov_b32_dpp v13, v14 row_newbcast:6 row_mask:0xf bank_mask:0x3
  v_mov_b32_dpp v13, v14 row_newbcast:14 row_mask:0xf bank_mask:0xc
  v_and_b32 v16, v8, v13
  v_and_b32 v17, v9, v13
  v_and_b32 v18, v10, v13
  v_and_b32 v19, v11, v13
  s_nop 1
  v_mfma_f32_16x16x32_bf16 v[20:23], v[16:19], v[148:151], v[20:23]
  v_mfma_f32_16x16x32_bf16 v[24:27], v[16:19], v[152:155], v[24:27]
  v_mfma_f32_16x16x32_bf16 v[28:31], v[16:19], v[156:159], v[28:31]
  v_mov_b32_dpp v13, v14 row_newbcast:7 row_mask:0xf bank_mask:0x3
  v_mov_b32_dpp v13, v14 row_newbcast:15 row_mask:0xf bank_mask:0xc
  v_and_b32 v16, v8, v13
  v_and_b32 v17, v9, v13
  v_and_b32 v18, v10, v13
  v_and_b32 v19, v11, v13
  s_nop 1
  s_bitcmp1_b32 s64, 15
  s_waitcnt vmcnt(6)
  s_cbranch_scc1 L_ma_518
  buffer_load_dwordx4 v[76:79], v4, s[8:11], s58 offen offset:128 nt
L_ma_518:
  s_cbranch_scc0 L_mb_519
  buffer_load_dwordx4 v[76:79], v4, s[8:11], s58 offen offset:128
L_mb_519:
  v_mfma_f32_16x16x32_bf16 v[20:23], v[16:19], v[48:51], v[20:23]
  s_bitcmp1_b32 s64, 15
  s_waitcnt vmcnt(6)
  s_cbranch_scc1 L_ma_520
  buffer_load_dwordx4 v[48:51], v4, s[8:11], s58 offen offset:256 nt
L_ma_520:
  s_cbranch_scc0 L_mb_521
  buffer_load_dwordx4 v[48:51], v4, s[8:11], s58 offen offset:256
L_mb_521:
  v_mfma_f32_16x16x32_bf16 v[24:27], v[16:19], v[52:55], v[24:27]
  v_readlane_b32 s64, v0, 44
  s_add_u32 s58, s92, 10616832
  s_bfe_u32 s65, s64, 0x3000c
  s_mulk_i32 s65, 12288
  v_add_u32 v44, s65, v3
  v_add_u32 v45, 4294868992, v44
  v_min_u32 v4, v44, v45
  s_waitcnt vmcnt(5)
  s_bitcmp1_b32 s64, 15
  s_waitcnt vmcnt(6)
  s_barrier
  s_cbranch_scc1 L_ma_522
  buffer_load_dwordx4 v[52:55], v4, s[8:11], s58 offen offset:0 nt
L_ma_522:
  s_cbranch_scc0 L_mb_523
  buffer_load_dwordx4 v[52:55], v4, s[8:11], s58 offen offset:0
L_mb_523:
  v_mfma_f32_16x16x32_bf16 v[28:31], v[16:19], v[56:59], v[28:31]
  v_and_b32 v14, 0xffff0000, v38
  v_cmp_lt_f32 vcc, s60, v14
  s_cbranch_vccz L_nr_524
  s_call_b64 s[52:53], L_rescale
L_nr_524:
  v_subrev_f32 v14, s60, v14
  v_mul_f32 v14, s85, v14
  v_exp_f32 v14, v14
  s_nop 0
  v_add_f32 v15, v15, v14
  v_cvt_pk_bf16_f32 v14, v14, v14
  s_nop 1
  v_mov_b32_dpp v13, v14 row_newbcast:1 row_mask:0xf bank_mask:0x3
  v_mov_b32_dpp v13, v14 row_newbcast:9 row_mask:0xf bank_mask:0xc
  v_and_b32 v16, v8, v13
  v_and_b32 v17, v9, v13
  v_and_b32 v18, v10, v13
  v_and_b32 v19, v11, v13
  s_nop 1
  s_bitcmp1_b32 s64, 15
  s_waitcnt vmcnt(6)
  s_cbranch_scc1 L_ma_525
  buffer_load_dwordx4 v[56:59], v4, s[8:11], s58 offen offset:128 nt
L_ma_525:
  s_cbranch_scc0 L_mb_526
  buffer_load_dwordx4 v[56:59], v4, s[8:11], s58 offen offset:128
L_mb_526:
  v_mfma_f32_16x16x32_bf16 v[20:23], v[16:19], v[60:63], v[20:23]
  s_bitcmp1_b32 s64, 15
  s_waitcnt vmcnt(6)
  s_cbranch_scc1 L_ma_527
  buffer_load_dwordx4 v[60:63], v4, s[8:11], s58 offen offset:256 nt
L_ma_527:
  s_cbranch_scc0 L_mb_528
  buffer_load_dwordx4 v[60:63], v4, s[8:11], s58 offen offset:256
L_mb_528:
  v_mfma_f32_16x16x32_bf16 v[24:27], v[16:19], v[64:67], v[24:27]
  v_readlane_b32 s64, v0, 45
  s_add_u32 s58, s92, 10715136
  s_bfe_u32 s65, s64, 0x3000c
  s_mulk_i32 s65, 12288
  v_add_u32 v44, s65, v3
  v_add_u32 v45, 4294868992, v44
  v_min_u32 v4, v44, v45
  s_waitcnt vmcnt(5)
  s_bitcmp1_b32 s64, 15
  s_waitcnt vmcnt(6)
  s_barrier
  s_cbranch_scc1 L_ma_529
  buffer_load_dwordx4 v[64:67], v4, s[8:11], s58 offen offset:0 nt
L_ma_529:
  s_cbranch_scc0 L_mb_530
  buffer_load_dwordx4 v[64:67], v4, s[8:11], s58 offen offset:0
L_mb_530:
  v_mfma_f32_16x16x32_bf16 v[28:31], v[16:19], v[68:71], v[28:31]
  v_mov_b32_dpp v13, v14 row_newbcast:0 row_mask:0xf bank_mask:0x3
  v_mov_b32_dpp v13, v14 row_newbcast:8 row_mask:0xf bank_mask:0xc
  v_and_b32 v16, v8, v13
  v_and_b32 v17, v9, v13
  v_and_b32 v18, v10, v13
  v_and_b32 v19, v11, v13
  s_nop 1
  v_mfma_f32_16x16x32_bf16 v[20:23], v[16:19], v[160:163], v[20:23]
  v_mfma_f32_16x16x32_bf16 v[24:27], v[16:19], v[164:167], v[24:27]
  v_mfma_f32_16x16x32_bf16 v[28:31], v[16:19], v[168:171], v[28:31]
  v_mov_b32_dpp v13, v14 row_newbcast:2 row_mask:0xf bank_mask:0x3
  v_mov_b32_dpp v13, v14 row_newbcast:10 row_mask:0xf bank_mask:0xc
  v_and_b32 v16, v8, v13
  v_and_b32 v17, v9, v13
  v_and_b32 v18, v10, v13
  v_and_b32 v19, v11, v13
  s_nop 1
  s_bitcmp1_b32 s64, 15
  s_waitcnt vmcnt(6)
  s_cbranch_scc1 L_ma_531
  buffer_load_dwordx4 v[68:71], v4, s[8:11], s58 offen offset:128 nt
L_ma_531:
  s_cbranch_scc0 L_mb_532
  buffer_load_dwordx4 v[68:71], v4, s[8:11], s58 offen offset:128
L_mb_532:
  v_mfma_f32_16x16x32_bf16 v[20:23], v[16:19], v[72:75], v[20:23]
  s_bitcmp1_b32 s64, 15
  s_waitcnt vmcnt(6)
  s_cbranch_scc1 L_ma_533
  buffer_load_dwordx4 v[72:75], v4, s[8:11], s58 offen offset:256 nt
L_ma_533:
  s_cbranch_scc0 L_mb_534
  buffer_load_dwordx4 v[72:75], v4, s[8:11], s58 offen offset:256
L_mb_534:
  v_mfma_f32_16x16x32_bf16 v[24:27], v[16:19], v[76:79], v[24:27]
  v_readlane_b32 s64, v0, 47
  s_add_u32 s58, s92, 10911744
  s_bfe_u32 s65, s64, 0x3000c
  s_mulk_i32 s65, 12288
  v_add_u32 v44, s65, v3
  v_add_u32 v45, 4294868992, v44
  v_min_u32 v4, v44, v45
  s_waitcnt vmcnt(5)
  s_bitcmp1_b32 s64, 15
  s_waitcnt vmcnt(6)
  s_barrier
  s_cbranch_scc1 L_ma_535
  buffer_load_dwordx4 v[76:79], v4, s[8:11], s58 offen offset:0 nt
L_ma_535:
  s_cbranch_scc0 L_mb_536
  buffer_load_dwordx4 v[76:79], v4, s[8:11], s58 offen offset:0
L_mb_536:
  v_mfma_f32_16x16x32_bf16 v[28:31], v[16:19], v[48:51], v[28:31]
  v_mov_b32_dpp v13, v14 row_newbcast:3 row_mask:0xf bank_mask:0x3
  v_mov_b32_dpp v13, v14 row_newbcast:11 row_mask:0xf bank_mask:0xc
  v_and_b32 v16, v8, v13
  v_and_b32 v17, v9, v13
  v_and_b32 v18, v10, v13
  v_and_b32 v19, v11, v13
  s_nop 1
  v_mfma_f32_16x16x32_bf16 v[20:23], v[16:19], v[172:175], v[20:23]
  v_mfma_f32_16x16x32_bf16 v[24:27], v[16:19], v[176:179], v[24:27]
  v_mfma_f32_16x16x32_bf16 v[28:31], v[16:19], v[180:183], v[28:31]
  v_mov_b32_dpp v13, v14 row_newbcast:4 row_mask:0xf bank_mask:0x3
  v_mov_b32_dpp v13, v14 row_newbcast:12 row_mask:0xf bank_mask:0xc
  v_and_b32 v16, v8, v13
  v_and_b32 v17, v9, v13
  v_and_b32 v18, v10, v13
  v_and_b32 v19, v11, v13
  s_nop 1
  s_bitcmp1_b32 s64, 15
  s_waitcnt vmcnt(6)
  s_cbranch_scc1 L_ma_537
  buffer_load_dwordx4 v[48:51], v4, s[8:11], s58 offen offset:128 nt
L_ma_537:
  s_cbranch_scc0 L_mb_538
  buffer_load_dwordx4 v[48:51], v4, s[8:11], s58 offen offset:128
L_mb_538:
  v_mfma_f32_16x16x32_bf16 v[20:23], v[16:19], v[52:55], v[20:23]
  s_bitcmp1_b32 s64, 15
  s_waitcnt vmcnt(6)
  s_cbranch_scc1 L_ma_539
  buffer_load_dwordx4 v[52:55], v4, s[8:11], s58 offen offset:256 nt
L_ma_539:
  s_cbranch_scc0 L_mb_540
  buffer_load_dwordx4 v[52:55], v4, s[8:11], s58 offen offset:256
L_mb_540:
  v_mfma_f32_16x16x32_bf16 v[24:27], v[16:19], v[56:59], v[24:27]
  v_readlane_b32 s64, v0, 49
  s_add_u32 s58, s92, 11108352
  s_bfe_u32 s65, s64, 0x3000c
  s_mulk_i32 s65, 12288
  v_add_u32 v44, s65, v3
  v_add_u32 v45, 4294868992, v44
  v_min_u32 v4, v44, v45
  s_waitcnt vmcnt(5)
  s_bitcmp1_b32 s64, 15
  s_waitcnt vmcnt(6)
  s_barrier
  s_cbranch_scc1 L_ma_541
  buffer_load_dwordx4 v[56:59], v4, s[8:11], s58 offen offset:0 nt
L_ma_541:
  s_cbranch_scc0 L_mb_542
  buffer_load_dwordx4 v[56:59], v4, s[8:11], s58 offen offset:0
L_mb_542:
  v_mfma_f32_16x16x32_bf16 v[28:31], v[16:19], v[60:63], v[28:31]
  v_mov_b32_dpp v13, v14 row_newbcast:5 row_mask:0xf bank_mask:0x3
  v_mov_b32_dpp v13, v14 row_newbcast:13 row_mask:0xf bank_mask:0xc
  v_and_b32 v16, v8, v13
  v_and_b32 v17, v9, v13
  v_and_b32 v18, v10, v13
  v_and_b32 v19, v11, v13
  s_nop 1
  s_bitcmp1_b32 s64, 15
  s_waitcnt vmcnt(6)
  s_cbranch_scc1 L_ma_543
  buffer_load_dwordx4 v[60:63], v4, s[8:11], s58 offen offset:128 nt
L_ma_543:
  s_cbranch_scc0 L_mb_544
  buffer_load_dwordx4 v[60:63], v4, s[8:11], s58 offen offset:128
L_mb_544:
  v_mfma_f32_16x16x32_bf16 v[20:23], v[16:19], v[64:67], v[20:23]
  s_bitcmp1_b32 s64, 15
  s_waitcnt vmcnt(6)
  s_cbranch_scc1 L_ma_545
  buffer_load_dwordx4 v[64:67], v4, s[8:11], s58 offen offset:256 nt
L_ma_545:
  s_cbranch_scc0 L_mb_546
  buffer_load_dwordx4 v[64:67], v4, s[8:11], s58 offen offset:256
L_mb_546:
  v_mfma_f32_16x16x32_bf16 v[24:27], v[16:19], v[68:71], v[24:27]
  v_readlane_b32 s64, v0, 50
  s_add_u32 s58, s92, 11206656
  s_bfe_u32 s65, s64, 0x3000c
  s_mulk_i32 s65, 12288
  v_add_u32 v44, s65, v3
  v_add_u32 v45, 4294868992, v44
  v_min_u32 v4, v44, v45
  s_waitcnt vmcnt(5)
  s_bitcmp1_b32 s64, 15
  s_waitcnt vmcnt(6)
  s_barrier
  s_cbranch_scc1 L_ma_547
  buffer_load_dwordx4 v[68:71], v4, s[8:11], s58 offen offset:0 nt
L_ma_547:
  s_cbranch_scc0 L_mb_548
  buffer_load_dwordx4 v[68:71], v4, s[8:11], s58 offen offset:0
L_mb_548:
  v_mfma_f32_16x16x32_bf16 v[28:31], v[16:19], v[72:75], v[28:31]
  v_mov_b32_dpp v13, v14 row_newbcast:6 row_mask:0xf bank_mask:0x3
  v_mov_b32_dpp v13, v14 row_newbcast:14 row_mask:0xf bank_mask:0xc
  v_and_b32 v16, v8, v13
  v_and_b32 v17, v9, v13
  v_and_b32 v18, v10, v13
  v_and_b32 v19, v11, v13
  s_nop 1
  v_mfma_f32_16x16x32_bf16 v[20:23], v[16:19], v[184:187], v[20:23]
  v_mfma_f32_16x16x32_bf16 v[24:27], v[16:19], v[188:191], v[24:27]
  v_mfma_f32_16x16x32_bf16 v[28:31], v[16:19], v[192:195], v[28:31]
  v_mov_b32_dpp v13, v14 row_newbcast:7 row_mask:0xf bank_mask:0x3
  v_mov_b32_dpp v13, v14 row_newbcast:15 row_mask:0xf bank_mask:0xc
  v_and_b32 v16, v8, v13
  v_and_b32 v17, v9, v13
  v_and_b32 v18, v10, v13
  v_and_b32 v19, v11, v13
  s_nop 1
  s_bitcmp1_b32 s64, 15
  s_waitcnt vmcnt(6)
  s_cbranch_scc1 L_ma_549
  buffer_load_dwordx4 v[72:75], v4, s[8:11], s58 offen offset:128 nt
L_ma_549:
  s_cbranch_scc0 L_mb_550
  buffer_load_dwordx4 v[72:75], v4, s[8:11], s58 offen offset:128
L_mb_550:
  v_mfma_f32_16x16x32_bf16 v[20:23], v[16:19], v[76:79], v[20:23]
  s_bitcmp1_b32 s64, 15
  s_waitcnt vmcnt(6)
  s_cbranch_scc1 L_ma_551
  buffer_load_dwordx4 v[76:79], v4, s[8:11], s58 offen offset:256 nt
L_ma_551:
  s_cbranch_scc0 L_mb_552
  buffer_load_dwordx4 v[76:79], v4, s[8:11], s58 offen offset:256
L_mb_552:
  v_mfma_f32_16x16x32_bf16 v[24:27], v[16:19], v[48:51], v[24:27]
  v_readlane_b32 s64, v0, 52
  s_add_u32 s58, s92, 11403264
  s_bfe_u32 s65, s64, 0x3000c
  s_mulk_i32 s65, 12288
  v_add_u32 v44, s65, v3
  v_add_u32 v45, 4294868992, v44
  v_min_u32 v4, v44, v45
  s_waitcnt vmcnt(5)
  s_bitcmp1_b32 s64, 15
  s_waitcnt vmcnt(6)
  s_barrier
  s_cbranch_scc1 L_ma_553
  buffer_load_dwordx4 v[48:51], v4, s[8:11], s58 offen offset:0 nt
L_ma_553:
  s_cbranch_scc0 L_mb_554
  buffer_load_dwordx4 v[48:51], v4, s[8:11], s58 offen offset:0
L_mb_554:
  v_mfma_f32_16x16x32_bf16 v[28:31], v[16:19], v[52:55], v[28:31]
  v_lshlrev_b32 v14, 16, v39
  v_cmp_lt_f32 vcc, s60, v14
  s_cbranch_vccz L_nr_555
  s_call_b64 s[52:53], L_rescale
L_nr_555:
  v_subrev_f32 v14, s60, v14
  v_mul_f32 v14, s85, v14
  v_exp_f32 v14, v14
  s_nop 0
  v_add_f32 v15, v15, v14
  v_cvt_pk_bf16_f32 v14, v14, v14
  s_nop 1
  v_mov_b32_dpp v13, v14 row_newbcast:1 row_mask:0xf bank_mask:0x3
  v_mov_b32_dpp v13, v14 row_newbcast:9 row_mask:0xf bank_mask:0xc
  v_and_b32 v16, v8, v13
  v_and_b32 v17, v9, v13
  v_and_b32 v18, v10, v13
  v_and_b32 v19, v11, v13
  s_nop 1
  s_bitcmp1_b32 s64, 15
  s_waitcnt vmcnt(6)
  s_cbranch_scc1 L_ma_556
  buffer_load_dwordx4 v[52:55], v4, s[8:11], s58 offen offset:128 nt
L_ma_556:
  s_cbranch_scc0 L_mb_557
  buffer_load_dwordx4 v[52:55], v4, s[8:11], s58 offen offset:128
L_mb_557:
  v_mfma_f32_16x16x32_bf16 v[20:23], v[16:19], v[56:59], v[20:23]
  s_bitcmp1_b32 s64, 15
  s_waitcnt vmcnt(6)
  s_cbranch_scc1 L_ma_558
  buffer_load_dwordx4 v[56:59], v4, s[8:11], s58 offen offset:256 nt
L_ma_558:
  s_cbranch_scc0 L_mb_559
  buffer_load_dwordx4 v[56:59], v4, s[8:11], s58 offen offset:256
L_mb_559:
  v_mfma_f32_16x16x32_bf16 v[24:27], v[16:19], v[60:63], v[24:27]
  v_readlane_b32 s64, v0, 53
  s_add_u32 s58, s92, 11501568
  s_bfe_u32 s65, s64, 0x3000c
  s_mulk_i32 s65, 12288
  v_add_u32 v44, s65, v3
  v_add_u32 v45, 4294868992, v44
  v_min_u32 v4, v44, v45
  s_waitcnt vmcnt(5)
  s_bitcmp1_b32 s64, 15
  s_waitcnt vmcnt(6)
  s_barrier
  s_cbranch_scc1 L_ma_560
  buffer_load_dwordx4 v[60:63], v4, s[8:11], s58 offen offset:0 nt
L_ma_560:
  s_cbranch_scc0 L_mb_561
  buffer_load_dwordx4 v[60:63], v4, s[8:11], s58 offen offset:0
L_mb_561:
  v_mfma_f32_16x16x32_bf16 v[28:31], v[16:19], v[64:67], v[28:31]
  v_mov_b32_dpp v13, v14 row_newbcast:0 row_mask:0xf bank_mask:0x3
  v_mov_b32_dpp v13, v14 row_newbcast:8 row_mask:0xf bank_mask:0xc
  v_and_b32 v16, v8, v13
  v_and_b32 v17, v9, v13
  v_and_b32 v18, v10, v13
  v_and_b32 v19, v11, v13
  s_nop 1
  v_mfma_f32_16x16x32_bf16 v[20:23], v[16:19], v[196:199], v[20:23]
  v_mfma_f32_16x16x32_bf16 v[24:27], v[16:19], v[200:203], v[24:27]
  v_mfma_f32_16x16x32_bf16 v[28:31], v[16:19], v[204:207], v[28:31]
  v_mov_b32_dpp v13, v14 row_newbcast:2 row_mask:0xf bank_mask:0x3
  v_mov_b32_dpp v13, v14 row_newbcast:10 row_mask:0xf bank_mask:0xc
  v_and_b32 v16, v8, v13
  v_and_b32 v17, v9, v13
  v_and_b32 v18, v10, v13
  v_and_b32 v19, v11, v13
  s_nop 1
  s_bitcmp1_b32 s64, 15
  s_waitcnt vmcnt(6)
  s_cbranch_scc1 L_ma_562
  buffer_load_dwordx4 v[64:67], v4, s[8:11], s58 offen offset:128 nt
L_ma_562:
  s_cbranch_scc0 L_mb_563
  buffer_load_dwordx4 v[64:67], v4, s[8:11], s58 offen offset:128
L_mb_563:
  v_mfma_f32_16x16x32_bf16 v[20:23], v[16:19], v[68:71], v[20:23]
  s_bitcmp1_b32 s64, 15
  s_waitcnt vmcnt(6)
  s_cbranch_scc1 L_ma_564
  buffer_load_dwordx4 v[68:71], v4, s[8:11], s58 offen offset:256 nt
L_ma_564:
  s_cbranch_scc0 L_mb_565
  buffer_load_dwordx4 v[68:71], v4, s[8:11], s58 offen offset:256
L_mb_565:
  v_mfma_f32_16x16x32_bf16 v[24:27], v[16:19], v[72:75], v[24:27]
  v_readlane_b32 s64, v0, 55
  s_add_u32 s58, s92, 11698176
  s_bfe_u32 s65, s64, 0x3000c
  s_mulk_i32 s65, 12288
  v_add_u32 v44, s65, v3
  v_add_u32 v45, 4294868992, v44
  v_min_u32 v4, v44, v45
  s_waitcnt vmcnt(5)
  s_bitcmp1_b32 s64, 15
  s_waitcnt vmcnt(6)
  s_barrier
  s_cbranch_scc1 L_ma_566
  buffer_load_dwordx4 v[72:75], v4, s[8:11], s58 offen offset:0 nt
L_ma_566:
  s_cbranch_scc0 L_mb_567
  buffer_load_dwordx4 v[72:75], v4, s[8:11], s58 offen offset:0
L_mb_567:
  v_mfma_f32_16x16x32_bf16 v[28:31], v[16:19], v[76:79], v[28:31]
  v_mov_b32_dpp v13, v14 row_newbcast:3 row_mask:0xf bank_mask:0x3
  v_mov_b32_dpp v13, v14 row_newbcast:11 row_mask:0xf bank_mask:0xc
  v_and_b32 v16, v8, v13
  v_and_b32 v17, v9, v13
  v_and_b32 v18, v10, v13
  v_and_b32 v19, v11, v13
  s_nop 1
  v_mfma_f32_16x16x32_bf16 v[20:23], v[16:19], v[208:211], v[20:23]
  v_mfma_f32_16x16x32_bf16 v[24:27], v[16:19], v[212:215], v[24:27]
  v_mfma_f32_16x16x32_bf16 v[28:31], v[16:19], v[216:219], v[28:31]
  v_mov_b32_dpp v13, v14 row_newbcast:4 row_mask:0xf bank_mask:0x3
  v_mov_b32_dpp v13, v14 row_newbcast:12 row_mask:0xf bank_mask:0xc
  v_and_b32 v16, v8, v13
  v_and_b32 v17, v9, v13
  v_and_b32 v18, v10, v13
  v_and_b32 v19, v11, v13
  s_nop 1
  s_bitcmp1_b32 s64, 15
  s_waitcnt vmcnt(6)
  s_cbranch_scc1 L_ma_568
  buffer_load_dwordx4 v[76:79], v4, s[8:11], s58 offen offset:128 nt
L_ma_568:
  s_cbranch_scc0 L_mb_569
  buffer_load_dwordx4 v[76:79], v4, s[8:11], s58 offen offset:128
L_mb_569:
  v_mfma_f32_16x16x32_bf16 v[20:23], v[16:19], v[48:51], v[20:23]
  s_bitcmp1_b32 s64, 15
  s_waitcnt vmcnt(6)
  s_cbranch_scc1 L_ma_570
  buffer_load_dwordx4 v[48:51], v4, s[8:11], s58 offen offset:256 nt
L_ma_570:
  s_cbranch_scc0 L_mb_571
  buffer_load_dwordx4 v[48:51], v4, s[8:11], s58 offen offset:256
L_mb_571:
  v_mfma_f32_16x16x32_bf16 v[24:27], v[16:19], v[52:55], v[24:27]
  v_readlane_b32 s64, v0, 57
  s_add_u32 s58, s92, 11894784
  s_bfe_u32 s65, s64, 0x3000c
  s_mulk_i32 s65, 12288
  v_add_u32 v44, s65, v3
  v_add_u32 v45, 4294868992, v44
  v_min_u32 v4, v44, v45
  s_waitcnt vmcnt(5)
  s_bitcmp1_b32 s64, 15
  s_waitcnt vmcnt(6)
  s_barrier
  s_cbranch_scc1 L_ma_572
  buffer_load_dwordx4 v[52:55], v4, s[8:11], s58 offen offset:0 nt
L_ma_572:
  s_cbranch_scc0 L_mb_573
  buffer_load_dwordx4 v[52:55], v4, s[8:11], s58 offen offset:0
L_mb_573:
  v_mfma_f32_16x16x32_bf16 v[28:31], v[16:19], v[56:59], v[28:31]
  v_mov_b32_dpp v13, v14 row_newbcast:5 row_mask:0xf bank_mask:0x3
  v_mov_b32_dpp v13, v14 row_newbcast:13 row_mask:0xf bank_mask:0xc
  v_and_b32 v16, v8, v13
  v_and_b32 v17, v9, v13
  v_and_b32 v18, v10, v13
  v_and_b32 v19, v11, v13
  s_nop 1
  s_bitcmp1_b32 s64, 15
  s_waitcnt vmcnt(6)
  s_cbranch_scc1 L_ma_574
  buffer_load_dwordx4 v[56:59], v4, s[8:11], s58 offen offset:128 nt
L_ma_574:
  s_cbranch_scc0 L_mb_575
  buffer_load_dwordx4 v[56:59], v4, s[8:11], s58 offen offset:128
L_mb_575:
  v_mfma_f32_16x16x32_bf16 v[20:23], v[16:19], v[60:63], v[20:23]
  s_bitcmp1_b32 s64, 15
  s_waitcnt vmcnt(6)
  s_cbranch_scc1 L_ma_576
  buffer_load_dwordx4 v[60:63], v4, s[8:11], s58 offen offset:256 nt
L_ma_576:
  s_cbranch_scc0 L_mb_577
  buffer_load_dwordx4 v[60:63], v4, s[8:11], s58 offen offset:256
L_mb_577:
  v_mfma_f32_16x16x32_bf16 v[24:27], v[16:19], v[64:67], v[24:27]
  v_readlane_b32 s64, v0, 58
  s_add_u32 s58, s92, 11993088
  s_bfe_u32 s65, s64, 0x3000c
  s_mulk_i32 s65, 12288
  v_add_u32 v44, s65, v3
  v_add_u32 v45, 4294868992, v44
  v_min_u32 v4, v44, v45
  s_waitcnt vmcnt(5)
  s_bitcmp1_b32 s64, 15
  s_waitcnt vmcnt(6)
  s_barrier
  s_cbranch_scc1 L_ma_578
  buffer_load_dwordx4 v[64:67], v4, s[8:11], s58 offen offset:0 nt
L_ma_578:
  s_cbranch_scc0 L_mb_579
  buffer_load_dwordx4 v[64:67], v4, s[8:11], s58 offen offset:0
L_mb_579:
  v_mfma_f32_16x16x32_bf16 v[28:31], v[16:19], v[68:71], v[28:31]
  v_mov_b32_dpp v13, v14 row_newbcast:6 row_mask:0xf bank_mask:0x3
  v_mov_b32_dpp v13, v14 row_newbcast:14 row_mask:0xf bank_mask:0xc
  v_and_b32 v16, v8, v13
  v_and_b32 v17, v9, v13
  v_and_b32 v18, v10, v13
  v_and_b32 v19, v11, v13
  s_nop 1
  v_mfma_f32_16x16x32_bf16 v[20:23], v[16:19], v[220:223], v[20:23]
  v_mfma_f32_16x16x32_bf16 v[24:27], v[16:19], v[224:227], v[24:27]
  v_mfma_f32_16x16x32_bf16 v[28:31], v[16:19], v[228:231], v[28:31]
  v_mov_b32_dpp v13, v14 row_newbcast:7 row_mask:0xf bank_mask:0x3
  v_mov_b32_dpp v13, v14 row_newbcast:15 row_mask:0xf bank_mask:0xc
  v_and_b32 v16, v8, v13
  v_and_b32 v17, v9, v13
  v_and_b32 v18, v10, v13
  v_and_b32 v19, v11, v13
  s_nop 1
  s_bitcmp1_b32 s64, 15
  s_waitcnt vmcnt(6)
  s_cbranch_scc1 L_ma_580
  buffer_load_dwordx4 v[68:71], v4, s[8:11], s58 offen offset:128 nt
L_ma_580:
  s_cbranch_scc0 L_mb_581
  buffer_load_dwordx4 v[68:71], v4, s[8:11], s58 offen offset:128
L_mb_581:
  v_mfma_f32_16x16x32_bf16 v[20:23], v[16:19], v[72:75], v[20:23]
  s_bitcmp1_b32 s64, 15
  s_waitcnt vmcnt(6)
  s_cbranch_scc1 L_ma_582
  buffer_load_dwordx4 v[72:75], v4, s[8:11], s58 offen offset:256 nt
L_ma_582:
  s_cbranch_scc0 L_mb_583
  buffer_load_dwordx4 v[72:75], v4, s[8:11], s58 offen offset:256
L_mb_583:
  v_mfma_f32_16x16x32_bf16 v[24:27], v[16:19], v[76:79], v[24:27]
  v_readlane_b32 s64, v0, 60
  s_add_u32 s58, s92, 12189696
  s_bfe_u32 s65, s64, 0x3000c
  s_mulk_i32 s65, 12288
  v_add_u32 v44, s65, v3
  v_add_u32 v45, 4294868992, v44
  v_min_u32 v4, v44, v45
  s_waitcnt vmcnt(5)
  s_bitcmp1_b32 s64, 15
  s_waitcnt vmcnt(6)
  s_barrier
  s_cbranch_scc1 L_ma_584
  buffer_load_dwordx4 v[76:79], v4, s[8:11], s58 offen offset:0 nt
L_ma_584:
  s_cbranch_scc0 L_mb_585
  buffer_load_dwordx4 v[76:79], v4, s[8:11], s58 offen offset:0
L_mb_585:
  v_mfma_f32_16x16x32_bf16 v[28:31], v[16:19], v[48:51], v[28:31]
  v_and_b32 v14, 0xffff0000, v39
  v_cmp_lt_f32 vcc, s60, v14
  s_cbranch_vccz L_nr_586
  s_call_b64 s[52:53], L_rescale
L_nr_586:
  v_subrev_f32 v14, s60, v14
  v_mul_f32 v14, s85, v14
  v_exp_f32 v14, v14
  s_nop 0
  v_add_f32 v15, v15, v14
  v_cvt_pk_bf16_f32 v14, v14, v14
  s_nop 1
  v_lshrrev_b32 v84, 3, v1
  v_and_b32 v85, 7, v1
  v_mul_u32_u24 v84, 10240, v84
  v_lshl_add_u32 v84, v85, 4, v84
  v_or_b32 v85, s90, v84
  s_mul_i32 s78, s72, 192
  s_add_u32 s77, s89, s78
  s_mul_i32 s80, s77, 1280
  v_mov_b32_dpp v13, v14 row_newbcast:1 row_mask:0xf bank_mask:0x3
  v_mov_b32_dpp v13, v14 row_newbcast:9 row_mask:0xf bank_mask:0xc
  v_and_b32 v16, v8, v13
  v_and_b32 v17, v9, v13
  v_and_b32 v18, v10, v13
  v_and_b32 v19, v11, v13
  s_nop 1
  s_bitcmp1_b32 s64, 15
  s_waitcnt vmcnt(6)
  s_cbranch_scc1 L_ma_587
  buffer_load_dwordx4 v[48:51], v4, s[8:11], s58 offen offset:128 nt
L_ma_587:
  s_cbranch_scc0 L_mb_588
  buffer_load_dwordx4 v[48:51], v4, s[8:11], s58 offen offset:128
L_mb_588:
  v_mfma_f32_16x16x32_bf16 v[20:23], v[16:19], v[52:55], v[20:23]
  s_mul_i32 s77, s84, 128
  s_add_u32 s77, s77, s80
  s_add_u32 s77, s77, 163840
  buffer_load_dwordx4 v[80:83], v85, s[16:19], s77 offen nt
  s_bitcmp1_b32 s64, 15
  s_waitcnt vmcnt(7)
  s_cbranch_scc1 L_ma_589
  buffer_load_dwordx4 v[52:55], v4, s[8:11], s58 offen offset:256 nt
L_ma_589:
  s_cbranch_scc0 L_mb_590
  buffer_load_dwordx4 v[52:55], v4, s[8:11], s58 offen offset:256
L_mb_590:
  v_mfma_f32_16x16x32_bf16 v[24:27], v[16:19], v[56:59], v[24:27]
  v_readlane_b32 s64, v0, 61
  s_add_u32 s58, s92, 12288000
  s_bfe_u32 s65, s64, 0x3000c
  s_mulk_i32 s65, 12288
  v_add_u32 v44, s65, v3
  v_add_u32 v45, 4294868992, v44
  v_min_u32 v4, v44, v45
  s_waitcnt vmcnt(6)
  s_bitcmp1_b32 s64, 15
  s_waitcnt vmcnt(7)
  s_barrier
  s_cbranch_scc1 L_ma_591
  buffer_load_dwordx4 v[56:59], v4, s[8:11], s58 offen offset:0 nt
L_ma_591:
  s_cbranch_scc0 L_mb_592
  buffer_load_dwordx4 v[56:59], v4, s[8:11], s58 offen offset:0
L_mb_592:
  v_mfma_f32_16x16x32_bf16 v[28:31], v[16:19], v[60:63], v[28:31]
  v_mov_b32_dpp v13, v14 row_newbcast:0 row_mask:0xf bank_mask:0x3
  v_mov_b32_dpp v13, v14 row_newbcast:8 row_mask:0xf bank_mask:0xc
  v_and_b32 v16, v8, v13
  v_and_b32 v17, v9, v13
  v_and_b32 v18, v10, v13
  v_and_b32 v19, v11, v13
  s_nop 1
  v_mfma_f32_16x16x32_bf16 v[20:23], v[16:19], v[232:235], v[20:23]
  v_mfma_f32_16x16x32_bf16 v[24:27], v[16:19], v[236:239], v[24:27]
  v_mfma_f32_16x16x32_bf16 v[28:31], v[16:19], v[240:243], v[28:31]
  v_mov_b32_dpp v13, v14 row_newbcast:2 row_mask:0xf bank_mask:0x3
  v_mov_b32_dpp v13, v14 row_newbcast:10 row_mask:0xf bank_mask:0xc
  v_and_b32 v16, v8, v13
  v_and_b32 v17, v9, v13
  v_and_b32 v18, v10, v13
  v_and_b32 v19, v11, v13
  s_nop 1
  s_bitcmp1_b32 s64, 15
  s_waitcnt vmcnt(7)
  s_cbranch_scc1 L_ma_593
  buffer_load_dwordx4 v[60:63], v4, s[8:11], s58 offen offset:128 nt
L_ma_593:
  s_cbranch_scc0 L_mb_594
  buffer_load_dwordx4 v[60:63], v4, s[8:11], s58 offen offset:128
L_mb_594:
  v_mfma_f32_16x16x32_bf16 v[20:23], v[16:19], v[64:67], v[20:23]
  s_bitcmp1_b32 s64, 15
  s_waitcnt vmcnt(7)
  s_cbranch_scc1 L_ma_595
  buffer_load_dwordx4 v[64:67], v4, s[8:11], s58 offen offset:256 nt
L_ma_595:
  s_cbranch_scc0 L_mb_596
  buffer_load_dwordx4 v[64:67], v4, s[8:11], s58 offen offset:256
L_mb_596:
  v_mfma_f32_16x16x32_bf16 v[24:27], v[16:19], v[68:71], v[24:27]
  v_readlane_b32 s64, v0, 62
  s_add_u32 s58, s92, 12386304
  s_bfe_u32 s65, s64, 0x3000c
  s_mulk_i32 s65, 12288
  v_add_u32 v44, s65, v3
  v_add_u32 v45, 4294868992, v44
  v_min_u32 v4, v44, v45
  s_waitcnt vmcnt(6)
  s_bitcmp1_b32 s64, 15
  s_waitcnt vmcnt(7)
  s_barrier
  s_cbranch_scc1 L_ma_597
  buffer_load_dwordx4 v[68:71], v4, s[8:11], s58 offen offset:0 nt
L_ma_597:
  s_cbranch_scc0 L_mb_598
  buffer_load_dwordx4 v[68:71], v4, s[8:11], s58 offen offset:0
L_mb_598:
  v_mfma_f32_16x16x32_bf16 v[28:31], v[16:19], v[72:75], v[28:31]
  v_mov_b32_dpp v13, v14 row_newbcast:4 row_mask:0xf bank_mask:0x3
  v_mov_b32_dpp v13, v14 row_newbcast:12 row_mask:0xf bank_mask:0xc
  v_and_b32 v16, v8, v13
  v_and_b32 v17, v9, v13
  v_and_b32 v18, v10, v13
  v_and_b32 v19, v11, v13
  s_nop 1
  s_bitcmp1_b32 s64, 15
  s_waitcnt vmcnt(7)
  s_cbranch_scc1 L_ma_599
  buffer_load_dwordx4 v[72:75], v4, s[8:11], s58 offen offset:128 nt
L_ma_599:
  s_cbranch_scc0 L_mb_600
  buffer_load_dwordx4 v[72:75], v4, s[8:11], s58 offen offset:128
L_mb_600:
  v_mfma_f32_16x16x32_bf16 v[20:23], v[16:19], v[76:79], v[20:23]
  s_bitcmp1_b32 s64, 15
  s_waitcnt vmcnt(7)
  s_cbranch_scc1 L_ma_601
  buffer_load_dwordx4 v[76:79], v4, s[8:11], s58 offen offset:256 nt
L_ma_601:
  s_cbranch_scc0 L_mb_602
  buffer_load_dwordx4 v[76:79], v4, s[8:11], s58 offen offset:256
L_mb_602:
  v_mfma_f32_16x16x32_bf16 v[24:27], v[16:19], v[48:51], v[24:27]
  v_readlane_b32 s64, v0, 63
  s_add_u32 s58, s92, 12484608
  s_bfe_u32 s65, s64, 0x3000c
  s_mulk_i32 s65, 12288
  v_add_u32 v44, s65, v3
  v_add_u32 v45, 4294868992, v44
  v_min_u32 v4, v44, v45
  s_waitcnt vmcnt(5)
  s_bitcmp1_b32 s64, 15
  s_waitcnt vmcnt(6)
  s_barrier
  s_cbranch_scc1 L_ma_603
  buffer_load_dwordx4 v[48:51], v4, s[8:11], s58 offen offset:0 nt
L_ma_603:
  s_cbranch_scc0 L_mb_604
  buffer_load_dwordx4 v[48:51], v4, s[8:11], s58 offen offset:0
L_mb_604:
  v_mfma_f32_16x16x32_bf16 v[28:31], v[16:19], v[52:55], v[28:31]
  v_mov_b32_dpp v13, v14 row_newbcast:5 row_mask:0xf bank_mask:0x3
  v_mov_b32_dpp v13, v14 row_newbcast:13 row_mask:0xf bank_mask:0xc
  v_and_b32 v16, v8, v13
  v_and_b32 v17, v9, v13
  v_and_b32 v18, v10, v13
  v_and_b32 v19, v11, v13
  s_nop 1
  s_bitcmp1_b32 s64, 15
  s_waitcnt vmcnt(6)
  s_cbranch_scc1 L_ma_605
  buffer_load_dwordx4 v[52:55], v4, s[8:11], s58 offen offset:128 nt
L_ma_605:
  s_cbranch_scc0 L_mb_606
  buffer_load_dwordx4 v[52:55], v4, s[8:11], s58 offen offset:128
L_mb_606:
  v_mfma_f32_16x16x32_bf16 v[20:23], v[16:19], v[56:59], v[20:23]
  s_bitcmp1_b32 s64, 15
  s_waitcnt vmcnt(6)
  s_cbranch_scc1 L_ma_607
  buffer_load_dwordx4 v[56:59], v4, s[8:11], s58 offen offset:256 nt
L_ma_607:
  s_cbranch_scc0 L_mb_608
  buffer_load_dwordx4 v[56:59], v4, s[8:11], s58 offen offset:256
L_mb_608:
  v_mfma_f32_16x16x32_bf16 v[24:27], v[16:19], v[60:63], v[24:27]
  s_waitcnt vmcnt(6)
  s_barrier
  s_add_u32 s77, s3, 0
  s_mul_i32 s77, s77, 128
  s_add_u32 s77, s77, s80
  s_add_u32 s77, s77, 81920
  buffer_load_dwordx4 v[60:63], v84, s[16:19], s77 offen nt
  v_mfma_f32_16x16x32_bf16 v[28:31], v[16:19], v[64:67], v[28:31]
  v_mov_b32_dpp v13, v14 row_newbcast:3 row_mask:0xf bank_mask:0x3
  v_mov_b32_dpp v13, v14 row_newbcast:11 row_mask:0xf bank_mask:0xc
  v_and_b32 v16, v8, v13
  v_and_b32 v17, v9, v13
  v_and_b32 v18, v10, v13
  v_and_b32 v19, v11, v13
  s_nop 1
  v_mfma_f32_16x16x32_bf16 v[20:23], v[16:19], v[244:247], v[20:23]
  v_mfma_f32_16x16x32_bf16 v[24:27], v[16:19], v[248:251], v[24:27]
  v_mfma_f32_16x16x32_bf16 v[28:31], v[16:19], v[252:255], v[28:31]
  v_mov_b32_dpp v13, v14 row_newbcast:6 row_mask:0xf bank_mask:0x3
  v_mov_b32_dpp v13, v14 row_newbcast:14 row_mask:0xf bank_mask:0xc
  v_and_b32 v16, v8, v13
  v_and_b32 v17, v9, v13
  v_and_b32 v18, v10, v13
  v_and_b32 v19, v11, v13
  s_nop 1
  s_waitcnt vmcnt(6)
  s_add_u32 s77, s3, 4
  s_mul_i32 s77, s77, 128
  s_add_u32 s77, s77, s80
  s_add_u32 s77, s77, 81920
  buffer_load_dwordx4 v[64:67], v84, s[16:19], s77 offen nt
  v_mfma_f32_16x16x32_bf16 v[20:23], v[16:19], v[68:71], v[20:23]
  s_waitcnt vmcnt(6)
  s_mul_i32 s77, s84, 128
  s_add_u32 s77, s77, s80
  s_add_u32 s77, s77, 81920
  buffer_load_dwordx4 v[68:71], v85, s[16:19], s77 offen nt
  v_mfma_f32_16x16x32_bf16 v[24:27], v[16:19], v[72:75], v[24:27]
  s_waitcnt vmcnt(6)
  s_barrier
  s_add_u32 s77, s3, 0
  s_mul_i32 s77, s77, 128
  s_add_u32 s77, s77, s80
  s_add_u32 s77, s77, 163840
  buffer_load_dwordx4 v[72:75], v84, s[16:19], s77 offen nt
  v_mfma_f32_16x16x32_bf16 v[28:31], v[16:19], v[76:79], v[28:31]
  v_mov_b32_dpp v13, v14 row_newbcast:7 row_mask:0xf bank_mask:0x3
  v_mov_b32_dpp v13, v14 row_newbcast:15 row_mask:0xf bank_mask:0xc
  v_and_b32 v16, v8, v13
  v_and_b32 v17, v9, v13
  v_and_b32 v18, v10, v13
  v_and_b32 v19, v11, v13
  s_nop 1
  s_waitcnt vmcnt(6)
  s_add_u32 s77, s3, 4
  s_mul_i32 s77, s77, 128
  s_add_u32 s77, s77, s80
  s_add_u32 s77, s77, 163840
  buffer_load_dwordx4 v[76:79], v84, s[16:19], s77 offen nt
  v_mfma_f32_16x16x32_bf16 v[20:23], v[16:19], v[48:51], v[20:23]
  s_waitcnt vmcnt(6)
  s_add_u32 s77, s3, 0
  s_mul_i32 s77, s77, 128
  s_add_u32 s77, s77, s80
  buffer_load_dwordx4 v[48:51], v84, s[16:19], s77 offen nt
  v_mfma_f32_16x16x32_bf16 v[24:27], v[16:19], v[52:55], v[24:27]
  s_waitcnt vmcnt(6)
  s_barrier
  s_add_u32 s77, s3, 4
  s_mul_i32 s77, s77, 128
  s_add_u32 s77, s77, s80
  buffer_load_dwordx4 v[52:55], v84, s[16:19], s77 offen nt
  v_mfma_f32_16x16x32_bf16 v[28:31], v[16:19], v[56:59], v[28:31]
  s_mul_i32 s77, s84, 128
  s_add_u32 s77, s77, s80
  buffer_load_dwordx4 v[56:59], v85, s[16:19], s77 offen nt
  s_branch L_passend
L_x2:
  s_mov_b32 s76, 1
  v_lshlrev_b32 v44, 4, v1
  s_and_b32 s77, s2, 3
  s_lshl2_add_u32 s77, s77, s3
  s_lshl_b32 s77, s77, 10
  s_add_u32 s77, s77, 2686976
  s_lshl_b32 s78, s3, 10
  s_add_u32 s78, s78, 151552
  v_lshl_add_u32 v46, v1, 4, s78
  s_mov_b32 s86, 200000
L_poll_609:
  buffer_load_dwordx4 v[84:87], v44, s[28:31], s77 offen sc1
  s_waitcnt vmcnt(0)
  v_bitop3_b32 v45, v84, v85, s75 bitop3:0x7e
  v_bitop3_b32 v45, v45, v86, s75 bitop3:0xf6
  v_and_b32 v45, 1, v45
  v_cmp_ne_u32 vcc, 0, v45
  s_cbranch_vccz L_pollx_610
  s_mov_b64 exec, vcc
  s_sub_u32 s86, s86, 1
  s_cmp_lg_u32 s86, 0
  s_cbranch_scc1 L_poll_609
L_pollx_610:
  s_mov_b64 exec, -1
  v_and_b32 v84, 0xffff0000, v84
  v_and_b32 v85, 0xffff0000, v85
  v_and_b32 v86, 0xffff0000, v86
  s_branch L_pass
L_q_pass1:
  s_barrier
L_q_pass1b:
  s_add_u32 s59, s59, 1
  s_add_u32 s58, s58, 98304
  v_readlane_b32 s64, v0, s59
  s_lshr_b32 s64, s64, s101
  s_and_b32 s65, s64, 7
  s_mulk_i32 s65, 12288
  v_add_u32 v44, s65, v2
  v_add_u32 v45, 4294868992, v44
  v_min_u32 v4, v44, v45
  buffer_load_dwordx4 v[48:51], v4, s[4:7], s58 offen offset:0 nt
  buffer_load_dwordx4 v[52:55], v4, s[4:7], s58 offen offset:128 nt
  buffer_load_dwordx4 v[56:59], v4, s[4:7], s58 offen offset:256 nt
  s_add_u32 s59, s59, 1
  s_add_u32 s58, s58, 98304
  v_readlane_b32 s64, v0, s59
  s_lshr_b32 s64, s64, s101
  s_and_b32 s65, s64, 7
  s_mulk_i32 s65, 12288
  v_add_u32 v44, s65, v2
  v_add_u32 v45, 4294868992, v44
  v_min_u32 v4, v44, v45
  buffer_load_dwordx4 v[60:63], v4, s[4:7], s58 offen offset:0 nt
  v_min_u32 v46, 47, v1
  v_lshlrev_b32 v46, 4, v46
  s_lshl_b32 s80, s96, 11
  s_add_u32 s80, s80, 2883584
  s_waitcnt vmcnt(3)
  buffer_load_dwordx4 v[84:87], v46, s[28:31], s80 offen offset:0 sc1
  buffer_load_dwordx4 v[88:91], v46, s[28:31], s80 offen offset:1024 sc1
  buffer_load_dwordx4 v[64:67], v4, s[4:7], s58 offen offset:128 nt
  buffer_load_dwordx4 v[68:71], v4, s[4:7], s58 offen offset:256 nt
  s_add_u32 s59, s59, 1
  s_add_u32 s58, s58, 98304
  v_readlane_b32 s64, v0, s59
  s_lshr_b32 s64, s64, s101
  s_and_b32 s65, s64, 7
  s_mulk_i32 s65, 12288
  v_add_u32 v44, s65, v2
  v_add_u32 v45, 4294868992, v44
  v_min_u32 v4, v44, v45
  buffer_load_dwordx4 v[20:23], v4, s[4:7], s58 offen offset:0 nt
  buffer_load_dwordx4 v[24:27], v4, s[4:7], s58 offen offset:128 nt
  s_waitcnt vmcnt(4)
  v_bitop3_b32 v45, v84, v85, s75 bitop3:0x7e
  v_bitop3_b32 v45, v45, v86, s75 bitop3:0xf6
  v_bitop3_b32 v45, v45, v87, s75 bitop3:0xf6
  v_bitop3_b32 v45, v45, v88, s75 bitop3:0xf6
  v_bitop3_b32 v45, v45, v89, s75 bitop3:0xf6
  v_bitop3_b32 v45, v45, v90, s75 bitop3:0xf6
  v_bitop3_b32 v45, v45, v91, s75 bitop3:0xf6
  v_and_b32 v45, 1, v45
  v_cmp_ne_u32 vcc, 0, v45
  s_cbranch_vccz L_q1ok
  s_mov_b32 s86, 200000
L_poll_611:
  buffer_load_dwordx4 v[84:87], v46, s[28:31], s80 offen offset:0 sc1
  buffer_load_dwordx4 v[88:91], v46, s[28:31], s80 offen offset:1024 sc1
  s_waitcnt vmcnt(0)
  v_bitop3_b32 v45, v84, v85, s75 bitop3:0x7e
  v_bitop3_b32 v45, v45, v86, s75 bitop3:0xf6
  v_bitop3_b32 v45, v45, v87, s75 bitop3:0xf6
  v_bitop3_b32 v45, v45, v88, s75 bitop3:0xf6
  v_bitop3_b32 v45, v45, v89, s75 bitop3:0xf6
  v_bitop3_b32 v45, v45, v90, s75 bitop3:0xf6
  v_bitop3_b32 v45, v45, v91, s75 bitop3:0xf6
  v_and_b32 v45, 1, v45
  v_cmp_ne_u32 vcc, 0, v45
  s_cbranch_vccz L_pollx_612
  s_mov_b64 exec, vcc
  s_sub_u32 s86, s86, 1
  s_cmp_lg_u32 s86, 0
  s_cbranch_scc1 L_poll_611
L_pollx_612:
  s_mov_b64 exec, -1
L_q1ok:
  s_mul_i32 s77, s3, 384
  s_add_u32 s77, s77, 160000
  v_add_f32 v84, v84, v88
  v_add_f32 v85, v85, v89
  v_add_f32 v86, v86, v90
  v_add_f32 v87, v87, v91
  v_lshrrev_b32 v46, 1, v46
  v_cvt_pk_bf16_f32 v84, v84, v85
  v_cvt_pk_bf16_f32 v85, v86, v87
  v_add_u32 v46, s77, v46
  ds_write_b64 v46, v[84:85]
L_q_w3:
  v_bfe_u32 v45, v1, 3, 1
  v_lshlrev_b32 v45, 6, v45
  v_lshrrev_b32 v46, 4, v1
  v_lshl_add_u32 v45, v46, 4, v45
  v_add_u32 v45, 160000, v45
  s_waitcnt lgkmcnt(0)
  s_barrier
  ds_read_b128 v[80:83], v45 offset:0
  ds_read_b128 v[84:87], v45 offset:128
  ds_read_b128 v[88:91], v45 offset:256
  s_waitcnt lgkmcnt(0)
  s_mov_b32 s61, 15
L_kloop1:
  s_waitcnt vmcnt(10)
  buffer_load_dwordx4 v[28:31], v4, s[4:7], s58 offen offset:256 nt
  v_mfma_f32_16x16x32_bf16 v[16:19], v[72:75], v[80:83], 0
  s_add_u32 s59, s59, 1
  s_add_u32 s58, s58, 98304
  v_readlane_b32 s64, v0, s59
  s_lshr_b32 s64, s64, s101
  s_and_b32 s65, s64, 7
  s_mulk_i32 s65, 12288
  v_add_u32 v44, s65, v2
  v_add_u32 v45, 4294868992, v44
  v_min_u32 v4, v44, v45
  s_waitcnt vmcnt(10)
  s_barrier
  buffer_load_dwordx4 v[72:75], v4, s[4:7], s58 offen offset:0 nt
  v_mfma_f32_16x16x32_bf16 v[16:19], v[76:79], v[84:87], v[16:19]
  s_waitcnt vmcnt(10)
  buffer_load_dwordx4 v[76:79], v4, s[4:7], s58 offen offset:128 nt
  v_mfma_f32_16x16x32_bf16 v[16:19], v[40:43], v[88:91], v[16:19]
  s_mov_b32 vcc_lo, 0x1010101
  s_mov_b32 vcc_hi, vcc_lo
  s_nop 5
  v_add_f32_dpp v14, v17, v16 row_ror:8 row_mask:0xf bank_mask:0x3
  v_add_f32_dpp v14, v18, v19 row_ror:8 row_mask:0xf bank_mask:0xc
  v_cndmask_b32 v12, v12, v14, vcc
  s_waitcnt vmcnt(10)
  buffer_load_dwordx4 v[40:43], v4, s[4:7], s58 offen offset:256 nt
  v_mfma_f32_16x16x32_bf16 v[16:19], v[48:51], v[80:83], 0
  s_add_u32 s59, s59, 1
  s_add_u32 s58, s58, 98304
  v_readlane_b32 s64, v0, s59
  s_lshr_b32 s64, s64, s101
  s_and_b32 s65, s64, 7
  s_mulk_i32 s65, 12288
  v_add_u32 v44, s65, v2
  v_add_u32 v45, 4294868992, v44
  v_min_u32 v4, v44, v45
  s_waitcnt vmcnt(10)
  s_barrier
  buffer_load_dwordx4 v[48:51], v4, s[4:7], s58 offen offset:0 nt
  v_mfma_f32_16x16x32_bf16 v[16:19], v[52:55], v[84:87], v[16:19]
  s_waitcnt vmcnt(10)
  buffer_load_dwordx4 v[52:55], v4, s[4:7], s58 offen offset:128 nt
  v_mfma_f32_16x16x32_bf16 v[16:19], v[56:59], v[88:91], v[16:19]
  s_mov_b32 vcc_lo, 0x2020202
  s_mov_b32 vcc_hi, vcc_lo
  s_nop 5
  v_add_f32_dpp v14, v17, v16 row_ror:8 row_mask:0xf bank_mask:0x3
  v_add_f32_dpp v14, v18, v19 row_ror:8 row_mask:0xf bank_mask:0xc
  v_cndmask_b32 v12, v12, v14, vcc
  s_waitcnt vmcnt(10)
  buffer_load_dwordx4 v[56:59], v4, s[4:7], s58 offen offset:256 nt
  v_mfma_f32_16x16x32_bf16 v[16:19], v[60:63], v[80:83], 0
  s_add_u32 s59, s59, 1
  s_add_u32 s58, s58, 98304
  v_readlane_b32 s64, v0, s59
  s_lshr_b32 s64, s64, s101
  s_and_b32 s65, s64, 7
  s_mulk_i32 s65, 12288
  v_add_u32 v44, s65, v2
  v_add_u32 v45, 4294868992, v44
  v_min_u32 v4, v44, v45
  s_waitcnt vmcnt(10)
  s_barrier
  buffer_load_dwordx4 v[60:63], v4, s[4:7], s58 offen offset:0 nt
  v_mfma_f32_16x16x32_bf16 v[16:19], v[64:67], v[84:87], v[16:19]
  s_waitcnt vmcnt(10)
  buffer_load_dwordx4 v[64:67], v4, s[4:7], s58 offen offset:128 nt
  v_mfma_f32_16x16x32_bf16 v[16:19], v[68:71], v[88:91], v[16:19]
  s_mov_b32 vcc_lo, 0x4040404
  s_mov_b32 vcc_hi, vcc_lo
  s_nop 5
  v_add_f32_dpp v14, v17, v16 row_ror:8 row_mask:0xf bank_mask:0x3
  v_add_f32_dpp v14, v18, v19 row_ror:8 row_mask:0xf bank_mask:0xc
  v_cndmask_b32 v12, v12, v14, vcc
  s_waitcnt vmcnt(10)
  buffer_load_dwordx4 v[68:71], v4, s[4:7], s58 offen offset:256 nt
  v_mfma_f32_16x16x32_bf16 v[16:19], v[20:23], v[80:83], 0
  s_add_u32 s59, s59, 1
  s_add_u32 s58, s58, 98304
  v_readlane_b32 s64, v0, s59
  s_lshr_b32 s64, s64, s101
  s_and_b32 s65, s64, 7
  s_mulk_i32 s65, 12288
  v_add_u32 v44, s65, v2
  v_add_u32 v45, 4294868992, v44
  v_min_u32 v4, v44, v45
  s_waitcnt vmcnt(10)
  s_barrier
  buffer_load_dwordx4 v[20:23], v4, s[4:7], s58 offen offset:0 nt
  v_mfma_f32_16x16x32_bf16 v[16:19], v[24:27], v[84:87], v[16:19]
  s_waitcnt vmcnt(10)
  buffer_load_dwordx4 v[24:27], v4, s[4:7], s58 offen offset:128 nt
  v_mfma_f32_16x16x32_bf16 v[16:19], v[28:31], v[88:91], v[16:19]
  s_mov_b32 vcc_lo, 0x8080808
  s_mov_b32 vcc_hi, vcc_lo
  s_nop 5
  v_add_f32_dpp v14, v17, v16 row_ror:8 row_mask:0xf bank_mask:0x3
  v_add_f32_dpp v14, v18, v19 row_ror:8 row_mask:0xf bank_mask:0xc
  v_cndmask_b32 v12, v12, v14, vcc
  s_waitcnt vmcnt(10)
  buffer_load_dwordx4 v[28:31], v4, s[4:7], s58 offen offset:256 nt
  v_mfma_f32_16x16x32_bf16 v[16:19], v[72:75], v[80:83], 0
  s_add_u32 s59, s59, 1
  s_add_u32 s58, s58, 98304
  v_readlane_b32 s64, v0, s59
  s_lshr_b32 s77, s59, 3
  s_and_b32 s101, s77, 8
  s_cmp_ge_u32 s77, s95
  s_cselect_b32 s78, s92, s91
  s_mul_i32 s58, s59, 98304
  s_add_u32 s58, s58, s78
  s_lshr_b32 s64, s64, s101
  s_and_b32 s65, s64, 7
  s_mulk_i32 s65, 12288
  v_add_u32 v44, s65, v2
  v_add_u32 v45, 4294868992, v44
  v_min_u32 v4, v44, v45
  s_waitcnt vmcnt(10)
  s_barrier
  buffer_load_dwordx4 v[72:75], v4, s[4:7], s58 offen offset:0 nt
  v_mfma_f32_16x16x32_bf16 v[16:19], v[76:79], v[84:87], v[16:19]
  s_waitcnt vmcnt(10)
  buffer_load_dwordx4 v[76:79], v4, s[4:7], s58 offen offset:128 nt
  v_mfma_f32_16x16x32_bf16 v[16:19], v[40:43], v[88:91], v[16:19]
  s_mov_b32 vcc_lo, 0x10101010
  s_mov_b32 vcc_hi, vcc_lo
  s_nop 5
  v_add_f32_dpp v14, v17, v16 row_ror:8 row_mask:0xf bank_mask:0x3
  v_add_f32_dpp v14, v18, v19 row_ror:8 row_mask:0xf bank_mask:0xc
  v_cndmask_b32 v12, v12, v14, vcc
  s_waitcnt vmcnt(10)
  buffer_load_dwordx4 v[40:43], v4, s[4:7], s58 offen offset:256 nt
  v_mfma_f32_16x16x32_bf16 v[16:19], v[48:51], v[80:83], 0
  s_add_u32 s59, s59, 1
  s_add_u32 s58, s58, 98304
  v_readlane_b32 s64, v0, s59
  s_lshr_b32 s64, s64, s101
  s_and_b32 s65, s64, 7
  s_mulk_i32 s65, 12288
  v_add_u32 v44, s65, v2
  v_add_u32 v45, 4294868992, v44
  v_min_u32 v4, v44, v45
  s_waitcnt vmcnt(10)
  s_barrier
  buffer_load_dwordx4 v[48:51], v4, s[4:7], s58 offen offset:0 nt
  v_mfma_f32_16x16x32_bf16 v[16:19], v[52:55], v[84:87], v[16:19]
  s_waitcnt vmcnt(10)
  buffer_load_dwordx4 v[52:55], v4, s[4:7], s58 offen offset:128 nt
  v_mfma_f32_16x16x32_bf16 v[16:19], v[56:59], v[88:91], v[16:19]
  s_mov_b32 vcc_lo, 0x20202020
  s_mov_b32 vcc_hi, vcc_lo
  s_nop 5
  v_add_f32_dpp v14, v17, v16 row_ror:8 row_mask:0xf bank_mask:0x3
  v_add_f32_dpp v14, v18, v19 row_ror:8 row_mask:0xf bank_mask:0xc
  v_cndmask_b32 v12, v12, v14, vcc
  s_waitcnt vmcnt(10)
  buffer_load_dwordx4 v[56:59], v4, s[4:7], s58 offen offset:256 nt
  v_mfma_f32_16x16x32_bf16 v[16:19], v[60:63], v[80:83], 0
  s_add_u32 s59, s59, 1
  s_add_u32 s58, s58, 98304
  v_readlane_b32 s64, v0, s59
  s_lshr_b32 s64, s64, s101
  s_and_b32 s65, s64, 7
  s_mulk_i32 s65, 12288
  v_add_u32 v44, s65, v2
  v_add_u32 v45, 4294868992, v44
  v_min_u32 v4, v44, v45
  s_waitcnt vmcnt(10)
  s_barrier
  buffer_load_dwordx4 v[60:63], v4, s[4:7], s58 offen offset:0 nt
  v_mfma_f32_16x16x32_bf16 v[16:19], v[64:67], v[84:87], v[16:19]
  s_waitcnt vmcnt(10)
  buffer_load_dwordx4 v[64:67], v4, s[4:7], s58 offen offset:128 nt
  v_mfma_f32_16x16x32_bf16 v[16:19], v[68:71], v[88:91], v[16:19]
  s_mov_b32 vcc_lo, 0x40404040
  s_mov_b32 vcc_hi, vcc_lo
  s_nop 5
  v_add_f32_dpp v14, v17, v16 row_ror:8 row_mask:0xf bank_mask:0x3
  v_add_f32_dpp v14, v18, v19 row_ror:8 row_mask:0xf bank_mask:0xc
  v_cndmask_b32 v12, v12, v14, vcc
  s_waitcnt vmcnt(10)
  buffer_load_dwordx4 v[68:71], v4, s[4:7], s58 offen offset:256 nt
  v_mfma_f32_16x16x32_bf16 v[16:19], v[20:23], v[80:83], 0
  s_add_u32 s59, s59, 1
  s_add_u32 s58, s58, 98304
  v_readlane_b32 s64, v0, s59
  s_lshr_b32 s64, s64, s101
  s_and_b32 s65, s64, 7
  s_mulk_i32 s65, 12288
  v_add_u32 v44, s65, v2
  v_add_u32 v45, 4294868992, v44
  v_min_u32 v4, v44, v45
  s_waitcnt vmcnt(10)
  s_barrier
  buffer_load_dwordx4 v[20:23], v4, s[4:7], s58 offen offset:0 nt
  v_mfma_f32_16x16x32_bf16 v[16:19], v[24:27], v[84:87], v[16:19]
  s_waitcnt vmcnt(10)
  buffer_load_dwordx4 v[24:27], v4, s[4:7], s58 offen offset:128 nt
  v_mfma_f32_16x16x32_bf16 v[16:19], v[28:31], v[88:91], v[16:19]
  s_mov_b32 vcc_lo, 0x80808080
  s_mov_b32 vcc_hi, vcc_lo
  s_nop 5
  v_add_f32_dpp v14, v17, v16 row_ror:8 row_mask:0xf bank_mask:0x3
  v_add_f32_dpp v14, v18, v19 row_ror:8 row_mask:0xf bank_mask:0xc
  v_cndmask_b32 v12, v12, v14, vcc
  v_cvt_pk_bf16_f32 v12, 0, v12
  v_mul_f32 v14, 0x3d93cd3a, v12
  v_cvt_pk_bf16_f32 v14, v14, v14
  v_alignbit_b32 v36, v37, v36, 16
  v_alignbit_b32 v37, v38, v37, 16
  v_alignbit_b32 v38, v39, v38, 16
  v_alignbit_b32 v39, v14, v39, 16
  s_cmp_eq_u32 s61, 8
  s_cbranch_scc1 L_stA1
  s_cmp_eq_u32 s61, 7
  s_cbranch_scc1 L_flagA1
  s_sub_u32 s77, 16, s61
  s_cmp_eq_u32 s77, s94
  s_cbranch_scc1 L_q11
  s_cmp_eq_u32 s77, s95
  s_cbranch_scc1 L_q21
L_flagA1_r:
  s_sub_u32 s61, s61, 1
  s_cmp_lg_u32 s61, 0
  s_cbranch_scc1 L_kloop1
  s_waitcnt vmcnt(10)
  buffer_load_dwordx4 v[28:31], v4, s[4:7], s58 offen offset:256 nt
  v_mfma_f32_16x16x32_bf16 v[16:19], v[72:75], v[80:83], 0
  s_xor_b32 s71, s2, 4
  s_lshl_b32 s71, s71, 7
  s_add_u32 s71, s71, 2621440
  v_mov_b32 v47, s98
  buffer_load_dword v47, v47, s[28:31], s71 offen sc1 nt
  s_add_u32 s59, s59, 1
  s_add_u32 s58, s58, 98304
  v_readlane_b32 s64, v0, s59
  s_lshr_b32 s64, s64, s101
  s_and_b32 s65, s64, 7
  s_mulk_i32 s65, 12288
  v_add_u32 v44, s65, v2
  v_add_u32 v45, 4294868992, v44
  v_min_u32 v4, v44, v45
  s_waitcnt vmcnt(11)
  s_barrier
  buffer_load_dwordx4 v[72:75], v4, s[4:7], s58 offen offset:0 nt
  v_mfma_f32_16x16x32_bf16 v[16:19], v[76:79], v[84:87], v[16:19]
  s_waitcnt vmcnt(11)
  buffer_load_dwordx4 v[76:79], v4, s[4:7], s58 offen offset:128 nt
  v_mfma_f32_16x16x32_bf16 v[16:19], v[40:43], v[88:91], v[16:19]
  s_mov_b32 vcc_lo, 0x1010101
  s_mov_b32 vcc_hi, vcc_lo
  s_nop 5
  v_add_f32_dpp v14, v17, v16 row_ror:8 row_mask:0xf bank_mask:0x3
  v_add_f32_dpp v14, v18, v19 row_ror:8 row_mask:0xf bank_mask:0xc
  v_cndmask_b32 v12, v12, v14, vcc
  s_waitcnt vmcnt(11)
  buffer_load_dwordx4 v[40:43], v4, s[4:7], s58 offen offset:256 nt
  v_mfma_f32_16x16x32_bf16 v[16:19], v[48:51], v[80:83], 0
  s_add_u32 s59, s59, 1
  s_add_u32 s58, s58, 98304
  v_readlane_b32 s64, v0, s59
  s_lshr_b32 s64, s64, s101
  s_and_b32 s65, s64, 7
  s_mulk_i32 s65, 12288
  v_add_u32 v44, s65, v2
  v_add_u32 v45, 4294868992, v44
  v_min_u32 v4, v44, v45
  s_waitcnt vmcnt(11)
  s_barrier
  buffer_load_dwordx4 v[48:51], v4, s[4:7], s58 offen offset:0 nt
  v_mfma_f32_16x16x32_bf16 v[16:19], v[52:55], v[84:87], v[16:19]
  s_waitcnt vmcnt(11)
  buffer_load_dwordx4 v[52:55], v4, s[4:7], s58 offen offset:128 nt
  v_mfma_f32_16x16x32_bf16 v[16:19], v[56:59], v[88:91], v[16:19]
  s_mov_b32 vcc_lo, 0x2020202
  s_mov_b32 vcc_hi, vcc_lo
  s_nop 5
  v_add_f32_dpp v14, v17, v16 row_ror:8 row_mask:0xf bank_mask:0x3
  v_add_f32_dpp v14, v18, v19 row_ror:8 row_mask:0xf bank_mask:0xc
  v_cndmask_b32 v12, v12, v14, vcc
  s_waitcnt vmcnt(11)
  buffer_load_dwordx4 v[56:59], v4, s[4:7], s58 offen offset:256 nt
  v_mfma_f32_16x16x32_bf16 v[16:19], v[60:63], v[80:83], 0
  s_add_u32 s59, s59, 1
  s_add_u32 s58, s58, 98304
  v_readlane_b32 s64, v0, s59
  s_lshr_b32 s64, s64, s101
  s_and_b32 s65, s64, 7
  s_mulk_i32 s65, 12288
  v_add_u32 v44, s65, v2
  v_add_u32 v45, 4294868992, v44
  v_min_u32 v4, v44, v45
  s_waitcnt vmcnt(11)
  s_barrier
  buffer_load_dwordx4 v[60:63], v4, s[4:7], s58 offen offset:0 nt
  v_mfma_f32_16x16x32_bf16 v[16:19], v[64:67], v[84:87], v[16:19]
  s_waitcnt vmcnt(11)
  buffer_load_dwordx4 v[64:67], v4, s[4:7], s58 offen offset:128 nt
  v_mfma_f32_16x16x32_bf16 v[16:19], v[68:71], v[88:91], v[16:19]
  s_mov_b32 vcc_lo, 0x4040404
  s_mov_b32 vcc_hi, vcc_lo
  s_nop 5
  v_add_f32_dpp v14, v17, v16 row_ror:8 row_mask:0xf bank_mask:0x3
  v_add_f32_dpp v14, v18, v19 row_ror:8 row_mask:0xf bank_mask:0xc
  v_cndmask_b32 v12, v12, v14, vcc
  s_waitcnt vmcnt(11)
  buffer_load_dwordx4 v[68:71], v4, s[4:7], s58 offen offset:256 nt
  v_mfma_f32_16x16x32_bf16 v[16:19], v[20:23], v[80:83], 0
  s_add_u32 s59, s59, 1
  s_add_u32 s58, s58, 98304
  v_readlane_b32 s64, v0, s59
  s_lshr_b32 s64, s64, s101
  s_and_b32 s65, s64, 7
  s_mulk_i32 s65, 12288
  v_add_u32 v44, s65, v2
  v_add_u32 v45, 4294868992, v44
  v_min_u32 v4, v44, v45
  s_waitcnt vmcnt(11)
  s_barrier
  buffer_load_dwordx4 v[20:23], v4, s[4:7], s58 offen offset:0 nt
  v_mfma_f32_16x16x32_bf16 v[16:19], v[24:27], v[84:87], v[16:19]
  s_waitcnt vmcnt(11)
  buffer_load_dwordx4 v[24:27], v4, s[4:7], s58 offen offset:128 nt
  v_mfma_f32_16x16x32_bf16 v[16:19], v[28:31], v[88:91], v[16:19]
  s_mov_b32 vcc_lo, 0x8080808
  s_mov_b32 vcc_hi, vcc_lo
  s_nop 5
  v_add_f32_dpp v14, v17, v16 row_ror:8 row_mask:0xf bank_mask:0x3
  v_add_f32_dpp v14, v18, v19 row_ror:8 row_mask:0xf bank_mask:0xc
  v_cndmask_b32 v12, v12, v14, vcc
  s_waitcnt vmcnt(10)
  buffer_load_dwordx4 v[28:31], v4, s[4:7], s58 offen offset:256 nt
  v_mfma_f32_16x16x32_bf16 v[16:19], v[72:75], v[80:83], 0
  s_waitcnt vmcnt(10)
  v_mfma_f32_16x16x32_bf16 v[16:19], v[76:79], v[84:87], v[16:19]
  s_waitcnt vmcnt(9)
  v_mfma_f32_16x16x32_bf16 v[16:19], v[40:43], v[88:91], v[16:19]
  s_mov_b32 vcc_lo, 0x10101010
  s_mov_b32 vcc_hi, vcc_lo
  s_nop 5
  v_add_f32_dpp v14, v17, v16 row_ror:8 row_mask:0xf bank_mask:0x3
  v_add_f32_dpp v14, v18, v19 row_ror:8 row_mask:0xf bank_mask:0xc
  v_cndmask_b32 v12, v12, v14, vcc
  s_waitcnt vmcnt(8)
  v_mfma_f32_16x16x32_bf16 v[16:19], v[48:51], v[80:83], 0
  v_readfirstlane_b32 s77, v47
  s_or_b32 s78, s88, s98
  s_cmp_lt_i32 s77, s78
  s_cbranch_scc1 L_fs_613
L_fk_614:
  v_lshl_or_b32 v46, v1, 4, s98
  s_xor_b32 s77, s87, 0x8000
  buffer_load_dwordx4 v[40:43], v46, s[28:31], s77 offen offset:0 sc1 nt
  s_waitcnt vmcnt(8)
  v_mfma_f32_16x16x32_bf16 v[16:19], v[52:55], v[84:87], v[16:19]
  v_readlane_b32 s64, v0, 1
  s_add_u32 s58, s91, 98304
  s_bfe_u32 s65, s64, 0x30004
  s_mulk_i32 s65, 12288
  v_add_u32 v44, s65, v3
  v_add_u32 v45, 4294868992, v44
  v_min_u32 v4, v44, v45
  s_waitcnt vmcnt(7)
  s_barrier
  buffer_load_dwordx4 v[48:51], v4, s[8:11], s58 offen offset:0 nt
  v_mfma_f32_16x16x32_bf16 v[16:19], v[56:59], v[88:91], v[16:19]
  s_mov_b32 vcc_lo, 0x20202020
  s_mov_b32 vcc_hi, vcc_lo
  s_nop 5
  v_add_f32_dpp v14, v17, v16 row_ror:8 row_mask:0xf bank_mask:0x3
  v_add_f32_dpp v14, v18, v19 row_ror:8 row_mask:0xf bank_mask:0xc
  v_cndmask_b32 v12, v12, v14, vcc
  s_waitcnt vmcnt(7)
  buffer_load_dwordx4 v[52:55], v4, s[8:11], s58 offen offset:128 nt
  v_mfma_f32_16x16x32_bf16 v[16:19], v[60:63], v[80:83], 0
  s_waitcnt vmcnt(7)
  buffer_load_dwordx4 v[56:59], v4, s[8:11], s58 offen offset:256 nt
  v_mfma_f32_16x16x32_bf16 v[16:19], v[64:67], v[84:87], v[16:19]
  v_readlane_b32 s64, v0, 2
  s_add_u32 s58, s91, 196608
  s_bfe_u32 s65, s64, 0x30004
  s_mulk_i32 s65, 12288
  v_add_u32 v44, s65, v3
  v_add_u32 v45, 4294868992, v44
  v_min_u32 v4, v44, v45
  s_waitcnt vmcnt(7)
  s_barrier
  buffer_load_dwordx4 v[60:63], v4, s[8:11], s58 offen offset:0 nt
  v_mfma_f32_16x16x32_bf16 v[16:19], v[68:71], v[88:91], v[16:19]
  s_mov_b32 vcc_lo, 0x40404040
  s_mov_b32 vcc_hi, vcc_lo
  s_nop 5
  v_add_f32_dpp v14, v17, v16 row_ror:8 row_mask:0xf bank_mask:0x3
  v_add_f32_dpp v14, v18, v19 row_ror:8 row_mask:0xf bank_mask:0xc
  v_cndmask_b32 v12, v12, v14, vcc
  s_waitcnt vmcnt(7)
  buffer_load_dwordx4 v[64:67], v4, s[8:11], s58 offen offset:128 nt
  v_mfma_f32_16x16x32_bf16 v[16:19], v[20:23], v[80:83], 0
  s_waitcnt vmcnt(7)
  buffer_load_dwordx4 v[68:71], v4, s[8:11], s58 offen offset:256 nt
  v_mfma_f32_16x16x32_bf16 v[16:19], v[24:27], v[84:87], v[16:19]
  v_readlane_b32 s64, v0, 4
  s_add_u32 s58, s91, 393216
  s_bfe_u32 s65, s64, 0x30004
  s_mulk_i32 s65, 12288
  v_add_u32 v44, s65, v3
  v_add_u32 v45, 4294868992, v44
  v_min_u32 v4, v44, v45
  s_waitcnt vmcnt(7)
  s_barrier
  buffer_load_dwordx4 v[72:75], v4, s[8:11], s58 offen offset:0 nt
  v_mfma_f32_16x16x32_bf16 v[16:19], v[28:31], v[88:91], v[16:19]
  s_mov_b32 vcc_lo, 0x80808080
  s_mov_b32 vcc_hi, vcc_lo
  s_nop 5
  v_add_f32_dpp v14, v17, v16 row_ror:8 row_mask:0xf bank_mask:0x3
  v_add_f32_dpp v14, v18, v19 row_ror:8 row_mask:0xf bank_mask:0xc
  v_cndmask_b32 v12, v12, v14, vcc
  v_cvt_pk_bf16_f32 v12, 0, v12
  v_mul_f32 v14, 0x3d93cd3a, v12
  v_cvt_pk_bf16_f32 v14, v14, v14
  v_alignbit_b32 v36, v37, v36, 16
  v_alignbit_b32 v37, v38, v37, 16
  v_alignbit_b32 v38, v39, v38, 16
  v_alignbit_b32 v39, v14, v39, 16
  v_lshl_or_b32 v44, v1, 4, s99
  buffer_store_dwordx4 v[36:39], v44, s[28:31], s87 offen offset:1024 sc1 nt
  v_mov_b32 v20, 0
  v_mov_b32 v21, 0
  v_mov_b32 v22, 0
  v_mov_b32 v23, 0
  v_mov_b32 v24, 0
  v_mov_b32 v25, 0
  v_mov_b32 v26, 0
  v_mov_b32 v27, 0
  v_mov_b32 v28, 0
  v_mov_b32 v29, 0
  v_mov_b32 v30, 0
  v_mov_b32 v31, 0
  v_mov_b32 v15, 0
  s_mov_b32 s60, 0xff800000
  s_waitcnt vmcnt(8)
  v_and_b32 v46, 7, v1
  s_xor_b32 s77, s44, s48
  v_lshrrev_b32 v44, v46, s77
  v_bfe_i32 v45, v44, 0, 1
  v_bfe_i32 v13, v44, 8, 1
  v_alignbit_b32 v45, v13, v45, 16
  v_bfi_b32 v32, v45, v40, v32
  v_bfe_i32 v45, v44, 16, 1
  v_bfe_i32 v13, v44, 24, 1
  v_alignbit_b32 v45, v13, v45, 16
  v_bfi_b32 v33, v45, v41, v33
  s_xor_b32 s77, s45, s49
  v_lshrrev_b32 v44, v46, s77
  v_bfe_i32 v45, v44, 0, 1
  v_bfe_i32 v13, v44, 8, 1
  v_alignbit_b32 v45, v13, v45, 16
  v_bfi_b32 v34, v45, v42, v34
  v_bfe_i32 v45, v44, 16, 1
  v_bfe_i32 v13, v44, 24, 1
  v_alignbit_b32 v45, v13, v45, 16
  v_bfi_b32 v35, v45, v43, v35
  v_lshlrev_b32 v14, 16, v32
  v_cmp_lt_f32 vcc, s60, v14
  s_cbranch_vccz L_nr_615
  s_call_b64 s[52:53], L_rescale
L_nr_615:
  v_subrev_f32 v14, s60, v14
  v_mul_f32 v14, s85, v14
  v_exp_f32 v14, v14
  s_nop 0
  v_add_f32 v15, v15, v14
  v_cvt_pk_bf16_f32 v14, v14, v14
  s_nop 1
  ds_read_b128 v[80:83], v6 offset:0
  ds_read_b128 v[84:87], v6 offset:1024
  ds_read_b128 v[88:91], v6 offset:2048
  v_mov_b32_dpp v13, v14 row_newbcast:1 row_mask:0xf bank_mask:0x3
  v_mov_b32_dpp v13, v14 row_newbcast:9 row_mask:0xf bank_mask:0xc
  v_and_b32 v16, v8, v13
  v_and_b32 v17, v9, v13
  v_and_b32 v18, v10, v13
  v_and_b32 v19, v11, v13
  s_nop 1
  s_waitcnt vmcnt(7)
  buffer_load_dwordx4 v[76:79], v4, s[8:11], s58 offen offset:128 nt
  v_mfma_f32_16x16x32_bf16 v[20:23], v[16:19], v[48:51], v[20:23]
  s_waitcnt vmcnt(7)
  buffer_load_dwordx4 v[48:51], v4, s[8:11], s58 offen offset:256 nt
  v_mfma_f32_16x16x32_bf16 v[24:27], v[16:19], v[52:55], v[24:27]
  v_readlane_b32 s64, v0, 5
  s_add_u32 s58, s91, 491520
  s_bfe_u32 s65, s64, 0x30004
  s_mulk_i32 s65, 12288
  v_add_u32 v44, s65, v3
  v_add_u32 v45, 4294868992, v44
  v_min_u32 v4, v44, v45
  s_waitcnt vmcnt(7)
  s_barrier
  buffer_load_dwordx4 v[52:55], v4, s[8:11], s58 offen offset:0 nt
  v_mfma_f32_16x16x32_bf16 v[28:31], v[16:19], v[56:59], v[28:31]
  v_mov_b32_dpp v13, v14 row_newbcast:0 row_mask:0xf bank_mask:0x3
  v_mov_b32_dpp v13, v14 row_newbcast:8 row_mask:0xf bank_mask:0xc
  v_and_b32 v16, v8, v13
  v_and_b32 v17, v9, v13
  v_and_b32 v18, v10, v13
  v_and_b32 v19, v11, v13
  s_nop 1
  s_waitcnt lgkmcnt(0)
  v_mfma_f32_16x16x32_bf16 v[20:23], v[16:19], v[80:83], v[20:23]
  v_mfma_f32_16x16x32_bf16 v[24:27], v[16:19], v[84:87], v[24:27]
  v_mfma_f32_16x16x32_bf16 v[28:31], v[16:19], v[88:91], v[28:31]
  ds_read_b128 v[80:83], v6 offset:3072
  ds_read_b128 v[84:87], v6 offset:4096
  ds_read_b128 v[88:91], v6 offset:5120
  v_mov_b32_dpp v13, v14 row_newbcast:2 row_mask:0xf bank_mask:0x3
  v_mov_b32_dpp v13, v14 row_newbcast:10 row_mask:0xf bank_mask:0xc
  v_and_b32 v16, v8, v13
  v_and_b32 v17, v9, v13
  v_and_b32 v18, v10, v13
  v_and_b32 v19, v11, v13
  s_nop 1
  s_waitcnt vmcnt(7)
  buffer_load_dwordx4 v[56:59], v4, s[8:11], s58 offen offset:128 nt
  v_mfma_f32_16x16x32_bf16 v[20:23], v[16:19], v[60:63], v[20:23]
  s_waitcnt vmcnt(7)
  buffer_load_dwordx4 v[60:63], v4, s[8:11], s58 offen offset:256 nt
  v_mfma_f32_16x16x32_bf16 v[24:27], v[16:19], v[64:67], v[24:27]
  v_readlane_b32 s64, v0, 7
  s_add_u32 s58, s91, 688128
  s_bfe_u32 s65, s64, 0x30004
  s_mulk_i32 s65, 12288
  v_add_u32 v44, s65, v3
  v_add_u32 v45, 4294868992, v44
  v_min_u32 v4, v44, v45
  s_waitcnt vmcnt(7)
  s_barrier
  buffer_load_dwordx4 v[64:67], v4, s[8:11], s58 offen offset:0 nt
  v_mfma_f32_16x16x32_bf16 v[28:31], v[16:19], v[68:71], v[28:31]
  v_mov_b32_dpp v13, v14 row_newbcast:3 row_mask:0xf bank_mask:0x3
  v_mov_b32_dpp v13, v14 row_newbcast:11 row_mask:0xf bank_mask:0xc
  v_and_b32 v16, v8, v13
  v_and_b32 v17, v9, v13
  v_and_b32 v18, v10, v13
  v_and_b32 v19, v11, v13
  s_nop 1
  s_waitcnt lgkmcnt(0)
  v_mfma_f32_16x16x32_bf16 v[20:23], v[16:19], v[80:83], v[20:23]
  v_mfma_f32_16x16x32_bf16 v[24:27], v[16:19], v[84:87], v[24:27]
  v_mfma_f32_16x16x32_bf16 v[28:31], v[16:19], v[88:91], v[28:31]
  v_mov_b32_dpp v13, v14 row_newbcast:4 row_mask:0xf bank_mask:0x3
  v_mov_b32_dpp v13, v14 row_newbcast:12 row_mask:0xf bank_mask:0xc
  v_and_b32 v16, v8, v13
  v_and_b32 v17, v9, v13
  v_and_b32 v18, v10, v13
  v_and_b32 v19, v11, v13
  s_nop 1
  s_waitcnt vmcnt(7)
  buffer_load_dwordx4 v[68:71], v4, s[8:11], s58 offen offset:128 nt
  v_mfma_f32_16x16x32_bf16 v[20:23], v[16:19], v[72:75], v[20:23]
  s_waitcnt vmcnt(6)
  buffer_load_dwordx4 v[72:75], v4, s[8:11], s58 offen offset:256 nt
  v_mfma_f32_16x16x32_bf16 v[24:27], v[16:19], v[76:79], v[24:27]
  v_readlane_b32 s64, v0, 9
  s_add_u32 s58, s91, 884736
  s_bfe_u32 s65, s64, 0x30004
  s_mulk_i32 s65, 12288
  v_add_u32 v44, s65, v3
  v_add_u32 v45, 4294868992, v44
  v_min_u32 v4, v44, v45
  s_waitcnt vmcnt(6)
  s_barrier
  buffer_load_dwordx4 v[76:79], v4, s[8:11], s58 offen offset:0 nt
  v_mfma_f32_16x16x32_bf16 v[28:31], v[16:19], v[48:51], v[28:31]
  ds_read_b128 v[80:83], v6 offset:6144
  ds_read_b128 v[84:87], v6 offset:7168
  ds_read_b128 v[88:91], v6 offset:8192
  v_mov_b32_dpp v13, v14 row_newbcast:5 row_mask:0xf bank_mask:0x3
  v_mov_b32_dpp v13, v14 row_newbcast:13 row_mask:0xf bank_mask:0xc
  v_and_b32 v16, v8, v13
  v_and_b32 v17, v9, v13
  v_and_b32 v18, v10, v13
  v_and_b32 v19, v11, v13
  s_nop 1
  s_waitcnt vmcnt(6)
  buffer_load_dwordx4 v[48:51], v4, s[8:11], s58 offen offset:128 nt
  v_mfma_f32_16x16x32_bf16 v[20:23], v[16:19], v[52:55], v[20:23]
  s_waitcnt vmcnt(6)
  buffer_load_dwordx4 v[52:55], v4, s[8:11], s58 offen offset:256 nt
  v_mfma_f32_16x16x32_bf16 v[24:27], v[16:19], v[56:59], v[24:27]
  v_readlane_b32 s64, v0, 10
  s_add_u32 s58, s91, 983040
  s_bfe_u32 s65, s64, 0x30004
  s_mulk_i32 s65, 12288
  v_add_u32 v44, s65, v3
  v_add_u32 v45, 4294868992, v44
  v_min_u32 v4, v44, v45
  s_waitcnt vmcnt(6)
  s_barrier
  buffer_load_dwordx4 v[56:59], v4, s[8:11], s58 offen offset:0 nt
  v_mfma_f32_16x16x32_bf16 v[28:31], v[16:19], v[60:63], v[28:31]
  s_add_u32 s88, s88, 1
  v_mov_b32 v44, s88
  s_cmp_eq_u32 s3, 0
  s_cselect_b32 s77, s99, 0x80000000
  v_lshl_or_b32 v45, v1, 2, s77
  s_lshl_b32 s77, s2, 7
  s_add_u32 s77, s77, 2621440
  s_mov_b32 exec_hi, 0
  buffer_store_dword v44, v45, s[28:31], s77 offen sc1 nt
  s_mov_b64 exec, -1
  v_mov_b32_dpp v13, v14 row_newbcast:6 row_mask:0xf bank_mask:0x3
  v_mov_b32_dpp v13, v14 row_newbcast:14 row_mask:0xf bank_mask:0xc
  v_and_b32 v16, v8, v13
  v_and_b32 v17, v9, v13
  v_and_b32 v18, v10, v13
  v_and_b32 v19, v11, v13
  s_nop 1
  s_waitcnt lgkmcnt(0)
  v_mfma_f32_16x16x32_bf16 v[20:23], v[16:19], v[80:83], v[20:23]
  v_mfma_f32_16x16x32_bf16 v[24:27], v[16:19], v[84:87], v[24:27]
  v_mfma_f32_16x16x32_bf16 v[28:31], v[16:19], v[88:91], v[28:31]
  v_mov_b32_dpp v13, v14 row_newbcast:7 row_mask:0xf bank_mask:0x3
  v_mov_b32_dpp v13, v14 row_newbcast:15 row_mask:0xf bank_mask:0xc
  v_and_b32 v16, v8, v13
  v_and_b32 v17, v9, v13
  v_and_b32 v18, v10, v13
  v_and_b32 v19, v11, v13
  s_nop 1
  s_waitcnt vmcnt(7)
  buffer_load_dwordx4 v[60:63], v4, s[8:11], s58 offen offset:128 nt
  v_mfma_f32_16x16x32_bf16 v[20:23], v[16:19], v[64:67], v[20:23]
  s_waitcnt vmcnt(7)
  buffer_load_dwordx4 v[64:67], v4, s[8:11], s58 offen offset:256 nt
  v_mfma_f32_16x16x32_bf16 v[24:27], v[16:19], v[68:71], v[24:27]
  v_readlane_b32 s64, v0, 12
  s_add_u32 s58, s91, 1179648
  s_bfe_u32 s65, s64, 0x30004
  s_mulk_i32 s65, 12288
  v_add_u32 v44, s65, v3
  v_add_u32 v45, 4294868992, v44
  v_min_u32 v4, v44, v45
  s_waitcnt vmcnt(7)
  s_barrier
  buffer_load_dwordx4 v[68:71], v4, s[8:11], s58 offen offset:0 nt
  v_mfma_f32_16x16x32_bf16 v[28:31], v[16:19], v[72:75], v[28:31]
  v_and_b32 v14, 0xffff0000, v32
  v_cmp_lt_f32 vcc, s60, v14
  s_cbranch_vccz L_nr_616
  s_call_b64 s[52:53], L_rescale
L_nr_616:
  v_subrev_f32 v14, s60, v14
  v_mul_f32 v14, s85, v14
  v_exp_f32 v14, v14
  s_nop 0
  v_add_f32 v15, v15, v14
  v_cvt_pk_bf16_f32 v14, v14, v14
  s_nop 1
  ds_read_b128 v[80:83], v6 offset:9216
  ds_read_b128 v[84:87], v6 offset:10240
  ds_read_b128 v[88:91], v6 offset:11264
  v_mov_b32_dpp v13, v14 row_newbcast:1 row_mask:0xf bank_mask:0x3
  v_mov_b32_dpp v13, v14 row_newbcast:9 row_mask:0xf bank_mask:0xc
  v_and_b32 v16, v8, v13
  v_and_b32 v17, v9, v13
  v_and_b32 v18, v10, v13
  v_and_b32 v19, v11, v13
  s_nop 1
  s_waitcnt vmcnt(7)
  buffer_load_dwordx4 v[72:75], v4, s[8:11], s58 offen offset:128 nt
  v_mfma_f32_16x16x32_bf16 v[20:23], v[16:19], v[76:79], v[20:23]
  s_waitcnt vmcnt(7)
  buffer_load_dwordx4 v[76:79], v4, s[8:11], s58 offen offset:256 nt
  v_mfma_f32_16x16x32_bf16 v[24:27], v[16:19], v[48:51], v[24:27]
  v_readlane_b32 s64, v0, 13
  s_add_u32 s58, s91, 1277952
  s_bfe_u32 s65, s64, 0x30004
  s_mulk_i32 s65, 12288
  v_add_u32 v44, s65, v3
  v_add_u32 v45, 4294868992, v44
  v_min_u32 v4, v44, v45
  s_waitcnt vmcnt(7)
  s_barrier
  buffer_load_dwordx4 v[48:51], v4, s[8:11], s58 offen offset:0 nt
  v_mfma_f32_16x16x32_bf16 v[28:31], v[16:19], v[52:55], v[28:31]
  v_mov_b32_dpp v13, v14 row_newbcast:0 row_mask:0xf bank_mask:0x3
  v_mov_b32_dpp v13, v14 row_newbcast:8 row_mask:0xf bank_mask:0xc
  v_and_b32 v16, v8, v13
  v_and_b32 v17, v9, v13
  v_and_b32 v18, v10, v13
  v_and_b32 v19, v11, v13
  s_nop 1
  s_waitcnt lgkmcnt(0)
  v_mfma_f32_16x16x32_bf16 v[20:23], v[16:19], v[80:83], v[20:23]
  v_mfma_f32_16x16x32_bf16 v[24:27], v[16:19], v[84:87], v[24:27]
  v_mfma_f32_16x16x32_bf16 v[28:31], v[16:19], v[88:91], v[28:31]
  ds_read_b128 v[80:83], v6 offset:12288
  ds_read_b128 v[84:87], v6 offset:13312
  ds_read_b128 v[88:91], v6 offset:14336
  v_mov_b32_dpp v13, v14 row_newbcast:2 row_mask:0xf bank_mask:0x3
  v_mov_b32_dpp v13, v14 row_newbcast:10 row_mask:0xf bank_mask:0xc
  v_and_b32 v16, v8, v13
  v_and_b32 v17, v9, v13
  v_and_b32 v18, v10, v13
  v_and_b32 v19, v11, v13
  s_nop 1
  s_waitcnt vmcnt(7)
  buffer_load_dwordx4 v[52:55], v4, s[8:11], s58 offen offset:128 nt
  v_mfma_f32_16x16x32_bf16 v[20:23], v[16:19], v[56:59], v[20:23]
  s_waitcnt vmcnt(6)
  buffer_load_dwordx4 v[56:59], v4, s[8:11], s58 offen offset:256 nt
  v_mfma_f32_16x16x32_bf16 v[24:27], v[16:19], v[60:63], v[24:27]
  v_readlane_b32 s64, v0, 15
  s_add_u32 s58, s91, 1474560
  s_bfe_u32 s65, s64, 0x30004
  s_mulk_i32 s65, 12288
  v_add_u32 v44, s65, v3
  v_add_u32 v45, 4294868992, v44
  v_min_u32 v4, v44, v45
  s_waitcnt vmcnt(6)
  s_barrier
  buffer_load_dwordx4 v[60:63], v4, s[8:11], s58 offen offset:0 nt
  v_mfma_f32_16x16x32_bf16 v[28:31], v[16:19], v[64:67], v[28:31]
  v_mov_b32_dpp v13, v14 row_newbcast:3 row_mask:0xf bank_mask:0x3
  v_mov_b32_dpp v13, v14 row_newbcast:11 row_mask:0xf bank_mask:0xc
  v_and_b32 v16, v8, v13
  v_and_b32 v17, v9, v13
  v_and_b32 v18, v10, v13
  v_and_b32 v19, v11, v13
  s_nop 1
  s_waitcnt lgkmcnt(0)
  v_mfma_f32_16x16x32_bf16 v[20:23], v[16:19], v[80:83], v[20:23]
  v_mfma_f32_16x16x32_bf16 v[24:27], v[16:19], v[84:87], v[24:27]
  v_mfma_f32_16x16x32_bf16 v[28:31], v[16:19], v[88:91], v[28:31]
  v_mov_b32_dpp v13, v14 row_newbcast:4 row_mask:0xf bank_mask:0x3
  v_mov_b32_dpp v13, v14 row_newbcast:12 row_mask:0xf bank_mask:0xc
  v_and_b32 v16, v8, v13
  v_and_b32 v17, v9, v13
  v_and_b32 v18, v10, v13
  v_and_b32 v19, v11, v13
  s_nop 1
  s_waitcnt vmcnt(6)
  buffer_load_dwordx4 v[64:67], v4, s[8:11], s58 offen offset:128 nt
  v_mfma_f32_16x16x32_bf16 v[20:23], v[16:19], v[68:71], v[20:23]
  s_waitcnt vmcnt(6)
  buffer_load_dwordx4 v[68:71], v4, s[8:11], s58 offen offset:256 nt
  v_mfma_f32_16x16x32_bf16 v[24:27], v[16:19], v[72:75], v[24:27]
  v_readlane_b32 s64, v0, 17
  s_add_u32 s58, s91, 1671168
  s_bfe_u32 s65, s64, 0x30004
  s_mulk_i32 s65, 12288
  v_add_u32 v44, s65, v3
  v_add_u32 v45, 4294868992, v44
  v_min_u32 v4, v44, v45
  s_waitcnt vmcnt(6)
  s_barrier
  buffer_load_dwordx4 v[72:75], v4, s[8:11], s58 offen offset:0 nt
  v_mfma_f32_16x16x32_bf16 v[28:31], v[16:19], v[76:79], v[28:31]
  ds_read_b128 v[80:83], v6 offset:15360
  ds_read_b128 v[84:87], v6 offset:16384
  ds_read_b128 v[88:91], v6 offset:17408
  v_mov_b32_dpp v13, v14 row_newbcast:5 row_mask:0xf bank_mask:0x3
  v_mov_b32_dpp v13, v14 row_newbcast:13 row_mask:0xf bank_mask:0xc
  v_and_b32 v16, v8, v13
  v_and_b32 v17, v9, v13
  v_and_b32 v18, v10, v13
  v_and_b32 v19, v11, v13
  s_nop 1
  s_waitcnt vmcnt(6)
  buffer_load_dwordx4 v[76:79], v4, s[8:11], s58 offen offset:128 nt
  v_mfma_f32_16x16x32_bf16 v[20:23], v[16:19], v[48:51], v[20:23]
  s_waitcnt vmcnt(6)
  buffer_load_dwordx4 v[48:51], v4, s[8:11], s58 offen offset:256 nt
  v_mfma_f32_16x16x32_bf16 v[24:27], v[16:19], v[52:55], v[24:27]
  v_readlane_b32 s64, v0, 18
  s_add_u32 s58, s91, 1769472
  s_bfe_u32 s65, s64, 0x30004
  s_mulk_i32 s65, 12288
  v_add_u32 v44, s65, v3
  v_add_u32 v45, 4294868992, v44
  v_min_u32 v4, v44, v45
  s_waitcnt vmcnt(6)
  s_barrier
  buffer_load_dwordx4 v[52:55], v4, s[8:11], s58 offen offset:0 nt
  v_mfma_f32_16x16x32_bf16 v[28:31], v[16:19], v[56:59], v[28:31]
  v_mov_b32_dpp v13, v14 row_newbcast:6 row_mask:0xf bank_mask:0x3
  v_mov_b32_dpp v13, v14 row_newbcast:14 row_mask:0xf bank_mask:0xc
  v_and_b32 v16, v8, v13
  v_and_b32 v17, v9, v13
  v_and_b32 v18, v10, v13
  v_and_b32 v19, v11, v13
  s_nop 1
  s_waitcnt lgkmcnt(0)
  v_mfma_f32_16x16x32_bf16 v[20:23], v[16:19], v[80:83], v[20:23]
  v_mfma_f32_16x16x32_bf16 v[24:27], v[16:19], v[84:87], v[24:27]
  v_mfma_f32_16x16x32_bf16 v[28:31], v[16:19], v[88:91], v[28:31]
  v_mov_b32_dpp v13, v14 row_newbcast:7 row_mask:0xf bank_mask:0x3
  v_mov_b32_dpp v13, v14 row_newbcast:15 row_mask:0xf bank_mask:0xc
  v_and_b32 v16, v8, v13
  v_and_b32 v17, v9, v13
  v_and_b32 v18, v10, v13
  v_and_b32 v19, v11, v13
  s_nop 1
  s_waitcnt vmcnt(6)
  buffer_load_dwordx4 v[56:59], v4, s[8:11], s58 offen offset:128 nt
  v_mfma_f32_16x16x32_bf16 v[20:23], v[16:19], v[60:63], v[20:23]
  s_waitcnt vmcnt(6)
  buffer_load_dwordx4 v[60:63], v4, s[8:11], s58 offen offset:256 nt
  v_mfma_f32_16x16x32_bf16 v[24:27], v[16:19], v[64:67], v[24:27]
  v_readlane_b32 s64, v0, 20
  s_add_u32 s58, s91, 1966080
  s_bfe_u32 s65, s64, 0x30004
  s_mulk_i32 s65, 12288
  v_add_u32 v44, s65, v3
  v_add_u32 v45, 4294868992, v44
  v_min_u32 v4, v44, v45
  s_waitcnt vmcnt(6)
  s_barrier
  buffer_load_dwordx4 v[64:67], v4, s[8:11], s58 offen offset:0 nt
  v_mfma_f32_16x16x32_bf16 v[28:31], v[16:19], v[68:71], v[28:31]
  v_lshlrev_b32 v14, 16, v33
  v_cmp_lt_f32 vcc, s60, v14
  s_cbranch_vccz L_nr_617
  s_call_b64 s[52:53], L_rescale
L_nr_617:
  v_subrev_f32 v14, s60, v14
  v_mul_f32 v14, s85, v14
  v_exp_f32 v14, v14
  s_nop 0
  v_add_f32 v15, v15, v14
  v_cvt_pk_bf16_f32 v14, v14, v14
  s_nop 1
  ds_read_b128 v[80:83], v6 offset:18432
  ds_read_b128 v[84:87], v6 offset:19456
  ds_read_b128 v[88:91], v6 offset:20480
  v_mov_b32_dpp v13, v14 row_newbcast:1 row_mask:0xf bank_mask:0x3
  v_mov_b32_dpp v13, v14 row_newbcast:9 row_mask:0xf bank_mask:0xc
  v_and_b32 v16, v8, v13
  v_and_b32 v17, v9, v13
  v_and_b32 v18, v10, v13
  v_and_b32 v19, v11, v13
  s_nop 1
  s_waitcnt vmcnt(6)
  buffer_load_dwordx4 v[68:71], v4, s[8:11], s58 offen offset:128 nt
  v_mfma_f32_16x16x32_bf16 v[20:23], v[16:19], v[72:75], v[20:23]
  s_waitcnt vmcnt(6)
  buffer_load_dwordx4 v[72:75], v4, s[8:11], s58 offen offset:256 nt
  v_mfma_f32_16x16x32_bf16 v[24:27], v[16:19], v[76:79], v[24:27]
  v_readlane_b32 s64, v0, 21
  s_add_u32 s58, s91, 2064384
  s_bfe_u32 s65, s64, 0x30004
  s_mulk_i32 s65, 12288
  v_add_u32 v44, s65, v3
  v_add_u32 v45, 4294868992, v44
  v_min_u32 v4, v44, v45
  s_waitcnt vmcnt(6)
  s_barrier
  buffer_load_dwordx4 v[76:79], v4, s[8:11], s58 offen offset:0 nt
  v_mfma_f32_16x16x32_bf16 v[28:31], v[16:19], v[48:51], v[28:31]
  v_mov_b32_dpp v13, v14 row_newbcast:0 row_mask:0xf bank_mask:0x3
  v_mov_b32_dpp v13, v14 row_newbcast:8 row_mask:0xf bank_mask:0xc
  v_and_b32 v16, v8, v13
  v_and_b32 v17, v9, v13
  v_and_b32 v18, v10, v13
  v_and_b32 v19, v11, v13
  s_nop 1
  s_waitcnt lgkmcnt(0)
  v_mfma_f32_16x16x32_bf16 v[20:23], v[16:19], v[80:83], v[20:23]
  v_mfma_f32_16x16x32_bf16 v[24:27], v[16:19], v[84:87], v[24:27]
  v_mfma_f32_16x16x32_bf16 v[28:31], v[16:19], v[88:91], v[28:31]
  ds_read_b128 v[80:83], v6 offset:21504
  ds_read_b128 v[84:87], v6 offset:22528
  ds_read_b128 v[88:91], v6 offset:23552
  v_mov_b32_dpp v13, v14 row_newbcast:2 row_mask:0xf bank_mask:0x3
  v_mov_b32_dpp v13, v14 row_newbcast:10 row_mask:0xf bank_mask:0xc
  v_and_b32 v16, v8, v13
  v_and_b32 v17, v9, v13
  v_and_b32 v18, v10, v13
  v_and_b32 v19, v11, v13
  s_nop 1
  s_waitcnt vmcnt(6)
  buffer_load_dwordx4 v[48:51], v4, s[8:11], s58 offen offset:128 nt
  v_mfma_f32_16x16x32_bf16 v[20:23], v[16:19], v[52:55], v[20:23]
  s_waitcnt vmcnt(6)
  buffer_load_dwordx4 v[52:55], v4, s[8:11], s58 offen offset:256 nt
  v_mfma_f32_16x16x32_bf16 v[24:27], v[16:19], v[56:59], v[24:27]
  v_readlane_b32 s64, v0, 23
  s_add_u32 s58, s91, 2260992
  s_bfe_u32 s65, s64, 0x30004
  s_mulk_i32 s65, 12288
  v_add_u32 v44, s65, v3
  v_add_u32 v45, 4294868992, v44
  v_min_u32 v4, v44, v45
  s_waitcnt vmcnt(6)
  s_barrier
  buffer_load_dwordx4 v[56:59], v4, s[8:11], s58 offen offset:0 nt
  v_mfma_f32_16x16x32_bf16 v[28:31], v[16:19], v[60:63], v[28:31]
  v_mov_b32_dpp v13, v14 row_newbcast:3 row_mask:0xf bank_mask:0x3
  v_mov_b32_dpp v13, v14 row_newbcast:11 row_mask:0xf bank_mask:0xc
  v_and_b32 v16, v8, v13
  v_and_b32 v17, v9, v13
  v_and_b32 v18, v10, v13
  v_and_b32 v19, v11, v13
  s_nop 1
  s_waitcnt lgkmcnt(0)
  v_mfma_f32_16x16x32_bf16 v[20:23], v[16:19], v[80:83], v[20:23]
  v_mfma_f32_16x16x32_bf16 v[24:27], v[16:19], v[84:87], v[24:27]
  v_mfma_f32_16x16x32_bf16 v[28:31], v[16:19], v[88:91], v[28:31]
  v_mov_b32_dpp v13, v14 row_newbcast:4 row_mask:0xf bank_mask:0x3
  v_mov_b32_dpp v13, v14 row_newbcast:12 row_mask:0xf bank_mask:0xc
  v_and_b32 v16, v8, v13
  v_and_b32 v17, v9, v13
  v_and_b32 v18, v10, v13
  v_and_b32 v19, v11, v13
  s_nop 1
  s_waitcnt vmcnt(6)
  buffer_load_dwordx4 v[60:63], v4, s[8:11], s58 offen offset:128 nt
  v_mfma_f32_16x16x32_bf16 v[20:23], v[16:19], v[64:67], v[20:23]
  s_waitcnt vmcnt(6)
  buffer_load_dwordx4 v[64:67], v4, s[8:11], s58 offen offset:256 nt
  v_mfma_f32_16x16x32_bf16 v[24:27], v[16:19], v[68:71], v[24:27]
  v_readlane_b32 s64, v0, 25
  s_add_u32 s58, s91, 2457600
  s_bfe_u32 s65, s64, 0x30004
  s_mulk_i32 s65, 12288
  v_add_u32 v44, s65, v3
  v_add_u32 v45, 4294868992, v44
  v_min_u32 v4, v44, v45
  s_waitcnt vmcnt(6)
  s_barrier
  buffer_load_dwordx4 v[68:71], v4, s[8:11], s58 offen offset:0 nt
  v_mfma_f32_16x16x32_bf16 v[28:31], v[16:19], v[72:75], v[28:31]
  ds_read_b128 v[80:83], v6 offset:24576
  ds_read_b128 v[84:87], v6 offset:25600
  ds_read_b128 v[88:91], v6 offset:26624
  v_mov_b32_dpp v13, v14 row_newbcast:5 row_mask:0xf bank_mask:0x3
  v_mov_b32_dpp v13, v14 row_newbcast:13 row_mask:0xf bank_mask:0xc
  v_and_b32 v16, v8, v13
  v_and_b32 v17, v9, v13
  v_and_b32 v18, v10, v13
  v_and_b32 v19, v11, v13
  s_nop 1
  s_waitcnt vmcnt(6)
  buffer_load_dwordx4 v[72:75], v4, s[8:11], s58 offen offset:128 nt
  v_mfma_f32_16x16x32_bf16 v[20:23], v[16:19], v[76:79], v[20:23]
  s_waitcnt vmcnt(6)
  buffer_load_dwordx4 v[76:79], v4, s[8:11], s58 offen offset:256 nt
  v_mfma_f32_16x16x32_bf16 v[24:27], v[16:19], v[48:51], v[24:27]
  v_readlane_b32 s64, v0, 26
  s_add_u32 s58, s91, 2555904
  s_bfe_u32 s65, s64, 0x30004
  s_mulk_i32 s65, 12288
  v_add_u32 v44, s65, v3
  v_add_u32 v45, 4294868992, v44
  v_min_u32 v4, v44, v45
  s_waitcnt vmcnt(6)
  s_barrier
  buffer_load_dwordx4 v[48:51], v4, s[8:11], s58 offen offset:0 nt
  v_mfma_f32_16x16x32_bf16 v[28:31], v[16:19], v[52:55], v[28:31]
  v_mov_b32_dpp v13, v14 row_newbcast:6 row_mask:0xf bank_mask:0x3
  v_mov_b32_dpp v13, v14 row_newbcast:14 row_mask:0xf bank_mask:0xc
  v_and_b32 v16, v8, v13
  v_and_b32 v17, v9, v13
  v_and_b32 v18, v10, v13
  v_and_b32 v19, v11, v13
  s_nop 1
  s_waitcnt lgkmcnt(0)
  v_mfma_f32_16x16x32_bf16 v[20:23], v[16:19], v[80:83], v[20:23]
  v_mfma_f32_16x16x32_bf16 v[24:27], v[16:19], v[84:87], v[24:27]
  v_mfma_f32_16x16x32_bf16 v[28:31], v[16:19], v[88:91], v[28:31]
  v_mov_b32_dpp v13, v14 row_newbcast:7 row_mask:0xf bank_mask:0x3
  v_mov_b32_dpp v13, v14 row_newbcast:15 row_mask:0xf bank_mask:0xc
  v_and_b32 v16, v8, v13
  v_and_b32 v17, v9, v13
  v_and_b32 v18, v10, v13
  v_and_b32 v19, v11, v13
  s_nop 1
  s_waitcnt vmcnt(6)
  buffer_load_dwordx4 v[52:55], v4, s[8:11], s58 offen offset:128 nt
  v_mfma_f32_16x16x32_bf16 v[20:23], v[16:19], v[56:59], v[20:23]
  s_waitcnt vmcnt(6)
  buffer_load_dwordx4 v[56:59], v4, s[8:11], s58 offen offset:256 nt
  v_mfma_f32_16x16x32_bf16 v[24:27], v[16:19], v[60:63], v[24:27]
  v_readlane_b32 s64, v0, 28
  s_add_u32 s58, s91, 2752512
  s_bfe_u32 s65, s64, 0x30004
  s_mulk_i32 s65, 12288
  v_add_u32 v44, s65, v3
  v_add_u32 v45, 4294868992, v44
  v_min_u32 v4, v44, v45
  s_waitcnt vmcnt(6)
  s_barrier
  buffer_load_dwordx4 v[60:63], v4, s[8:11], s58 offen offset:0 nt
  v_mfma_f32_16x16x32_bf16 v[28:31], v[16:19], v[64:67], v[28:31]
  v_and_b32 v14, 0xffff0000, v33
  v_cmp_lt_f32 vcc, s60, v14
  s_cbranch_vccz L_nr_618
  s_call_b64 s[52:53], L_rescale
L_nr_618:
  v_subrev_f32 v14, s60, v14
  v_mul_f32 v14, s85, v14
  v_exp_f32 v14, v14
  s_nop 0
  v_add_f32 v15, v15, v14
  v_cvt_pk_bf16_f32 v14, v14, v14
  s_nop 1
  ds_read_b128 v[80:83], v6 offset:27648
  ds_read_b128 v[84:87], v6 offset:28672
  ds_read_b128 v[88:91], v6 offset:29696
  v_mov_b32_dpp v13, v14 row_newbcast:1 row_mask:0xf bank_mask:0x3
  v_mov_b32_dpp v13, v14 row_newbcast:9 row_mask:0xf bank_mask:0xc
  v_and_b32 v16, v8, v13
  v_and_b32 v17, v9, v13
  v_and_b32 v18, v10, v13
  v_and_b32 v19, v11, v13
  s_nop 1
  s_waitcnt vmcnt(6)
  buffer_load_dwordx4 v[64:67], v4, s[8:11], s58 offen offset:128 nt
  v_mfma_f32_16x16x32_bf16 v[20:23], v[16:19], v[68:71], v[20:23]
  s_waitcnt vmcnt(6)
  buffer_load_dwordx4 v[68:71], v4, s[8:11], s58 offen offset:256 nt
  v_mfma_f32_16x16x32_bf16 v[24:27], v[16:19], v[72:75], v[24:27]
  v_readlane_b32 s64, v0, 29
  s_add_u32 s58, s91, 2850816
  s_bfe_u32 s65, s64, 0x30004
  s_mulk_i32 s65, 12288
  v_add_u32 v44, s65, v3
  v_add_u32 v45, 4294868992, v44
  v_min_u32 v4, v44, v45
  s_waitcnt vmcnt(6)
  s_barrier
  buffer_load_dwordx4 v[72:75], v4, s[8:11], s58 offen offset:0 nt
  v_mfma_f32_16x16x32_bf16 v[28:31], v[16:19], v[76:79], v[28:31]
  v_mov_b32_dpp v13, v14 row_newbcast:0 row_mask:0xf bank_mask:0x3
  v_mov_b32_dpp v13, v14 row_newbcast:8 row_mask:0xf bank_mask:0xc
  v_and_b32 v16, v8, v13
  v_and_b32 v17, v9, v13
  v_and_b32 v18, v10, v13
  v_and_b32 v19, v11, v13
  s_nop 1
  s_waitcnt lgkmcnt(0)
  v_mfma_f32_16x16x32_bf16 v[20:23], v[16:19], v[80:83], v[20:23]
  v_mfma_f32_16x16x32_bf16 v[24:27], v[16:19], v[84:87], v[24:27]
  v_mfma_f32_16x16x32_bf16 v[28:31], v[16:19], v[88:91], v[28:31]
  ds_read_b128 v[80:83], v6 offset:30720
  ds_read_b128 v[84:87], v6 offset:31744
  ds_read_b128 v[88:91], v6 offset:32768
  v_mov_b32_dpp v13, v14 row_newbcast:2 row_mask:0xf bank_mask:0x3
  v_mov_b32_dpp v13, v14 row_newbcast:10 row_mask:0xf bank_mask:0xc
  v_and_b32 v16, v8, v13
  v_and_b32 v17, v9, v13
  v_and_b32 v18, v10, v13
  v_and_b32 v19, v11, v13
  s_nop 1
  s_waitcnt vmcnt(6)
  buffer_load_dwordx4 v[76:79], v4, s[8:11], s58 offen offset:128 nt
  v_mfma_f32_16x16x32_bf16 v[20:23], v[16:19], v[48:51], v[20:23]
  s_waitcnt vmcnt(6)
  buffer_load_dwordx4 v[48:51], v4, s[8:11], s58 offen offset:256 nt
  v_mfma_f32_16x16x32_bf16 v[24:27], v[16:19], v[52:55], v[24:27]
  v_readlane_b32 s64, v0, 31
  s_add_u32 s58, s91, 3047424
  s_bfe_u32 s65, s64, 0x30004
  s_mulk_i32 s65, 12288
  v_add_u32 v44, s65, v3
  v_add_u32 v45, 4294868992, v44
  v_min_u32 v4, v44, v45
  s_waitcnt vmcnt(6)
  s_barrier
  buffer_load_dwordx4 v[52:55], v4, s[8:11], s58 offen offset:0 nt
  v_mfma_f32_16x16x32_bf16 v[28:31], v[16:19], v[56:59], v[28:31]
  v_mov_b32_dpp v13, v14 row_newbcast:3 row_mask:0xf bank_mask:0x3
  v_mov_b32_dpp v13, v14 row_newbcast:11 row_mask:0xf bank_mask:0xc
  v_and_b32 v16, v8, v13
  v_and_b32 v17, v9, v13
  v_and_b32 v18, v10, v13
  v_and_b32 v19, v11, v13
  s_nop 1
  s_waitcnt lgkmcnt(0)
  v_mfma_f32_16x16x32_bf16 v[20:23], v[16:19], v[80:83], v[20:23]
  v_mfma_f32_16x16x32_bf16 v[24:27], v[16:19], v[84:87], v[24:27]
  v_mfma_f32_16x16x32_bf16 v[28:31], v[16:19], v[88:91], v[28:31]
  v_mov_b32_dpp v13, v14 row_newbcast:4 row_mask:0xf bank_mask:0x3
  v_mov_b32_dpp v13, v14 row_newbcast:12 row_mask:0xf bank_mask:0xc
  v_and_b32 v16, v8, v13
  v_and_b32 v17, v9, v13
  v_and_b32 v18, v10, v13
  v_and_b32 v19, v11, v13
  s_nop 1
  s_waitcnt vmcnt(6)
  buffer_load_dwordx4 v[56:59], v4, s[8:11], s58 offen offset:128 nt
  v_mfma_f32_16x16x32_bf16 v[20:23], v[16:19], v[60:63], v[20:23]
  s_waitcnt vmcnt(6)
  buffer_load_dwordx4 v[60:63], v4, s[8:11], s58 offen offset:256 nt
  v_mfma_f32_16x16x32_bf16 v[24:27], v[16:19], v[64:67], v[24:27]
  v_readlane_b32 s64, v0, 33
  s_add_u32 s58, s91, 3244032
  s_bfe_u32 s65, s64, 0x30004
  s_mulk_i32 s65, 12288
  v_add_u32 v44, s65, v3
  v_add_u32 v45, 4294868992, v44
  v_min_u32 v4, v44, v45
  s_waitcnt vmcnt(6)
  s_barrier
  buffer_load_dwordx4 v[64:67], v4, s[8:11], s58 offen offset:0 nt
  v_mfma_f32_16x16x32_bf16 v[28:31], v[16:19], v[68:71], v[28:31]
  ds_read_b128 v[80:83], v6 offset:33792
  ds_read_b128 v[84:87], v6 offset:34816
  ds_read_b128 v[88:91], v6 offset:35840
  v_mov_b32_dpp v13, v14 row_newbcast:5 row_mask:0xf bank_mask:0x3
  v_mov_b32_dpp v13, v14 row_newbcast:13 row_mask:0xf bank_mask:0xc
  v_and_b32 v16, v8, v13
  v_and_b32 v17, v9, v13
  v_and_b32 v18, v10, v13
  v_and_b32 v19, v11, v13
  s_nop 1
  s_waitcnt vmcnt(6)
  buffer_load_dwordx4 v[68:71], v4, s[8:11], s58 offen offset:128 nt
  v_mfma_f32_16x16x32_bf16 v[20:23], v[16:19], v[72:75], v[20:23]
  s_waitcnt vmcnt(6)
  buffer_load_dwordx4 v[72:75], v4, s[8:11], s58 offen offset:256 nt
  v_mfma_f32_16x16x32_bf16 v[24:27], v[16:19], v[76:79], v[24:27]
  v_readlane_b32 s64, v0, 34
  s_add_u32 s58, s91, 3342336
  s_bfe_u32 s65, s64, 0x30004
  s_mulk_i32 s65, 12288
  v_add_u32 v44, s65, v3
  v_add_u32 v45, 4294868992, v44
  v_min_u32 v4, v44, v45
  s_waitcnt vmcnt(6)
  s_barrier
  buffer_load_dwordx4 v[76:79], v4, s[8:11], s58 offen offset:0 nt
  v_mfma_f32_16x16x32_bf16 v[28:31], v[16:19], v[48:51], v[28:31]
  v_mov_b32_dpp v13, v14 row_newbcast:6 row_mask:0xf bank_mask:0x3
  v_mov_b32_dpp v13, v14 row_newbcast:14 row_mask:0xf bank_mask:0xc
  v_and_b32 v16, v8, v13
  v_and_b32 v17, v9, v13
  v_and_b32 v18, v10, v13
  v_and_b32 v19, v11, v13
  s_nop 1
  s_waitcnt lgkmcnt(0)
  v_mfma_f32_16x16x32_bf16 v[20:23], v[16:19], v[80:83], v[20:23]
  v_mfma_f32_16x16x32_bf16 v[24:27], v[16:19], v[84:87], v[24:27]
  v_mfma_f32_16x16x32_bf16 v[28:31], v[16:19], v[88:91], v[28:31]
  v_mov_b32_dpp v13, v14 row_newbcast:7 row_mask:0xf bank_mask:0x3
  v_mov_b32_dpp v13, v14 row_newbcast:15 row_mask:0xf bank_mask:0xc
  v_and_b32 v16, v8, v13
  v_and_b32 v17, v9, v13
  v_and_b32 v18, v10, v13
  v_and_b32 v19, v11, v13
  s_nop 1
  s_waitcnt vmcnt(6)
  buffer_load_dwordx4 v[48:51], v4, s[8:11], s58 offen offset:128 nt
  v_mfma_f32_16x16x32_bf16 v[20:23], v[16:19], v[52:55], v[20:23]
  s_waitcnt vmcnt(6)
  buffer_load_dwordx4 v[52:55], v4, s[8:11], s58 offen offset:256 nt
  v_mfma_f32_16x16x32_bf16 v[24:27], v[16:19], v[56:59], v[24:27]
  v_readlane_b32 s64, v0, 36
  s_add_u32 s58, s91, 3538944
  s_bfe_u32 s65, s64, 0x30004
  s_mulk_i32 s65, 12288
  v_add_u32 v44, s65, v3
  v_add_u32 v45, 4294868992, v44
  v_min_u32 v4, v44, v45
  s_waitcnt vmcnt(6)
  s_barrier
  buffer_load_dwordx4 v[56:59], v4, s[8:11], s58 offen offset:0 nt
  v_mfma_f32_16x16x32_bf16 v[28:31], v[16:19], v[60:63], v[28:31]
  v_lshlrev_b32 v14, 16, v34
  v_cmp_lt_f32 vcc, s60, v14
  s_cbranch_vccz L_nr_619
  s_call_b64 s[52:53], L_rescale
L_nr_619:
  v_subrev_f32 v14, s60, v14
  v_mul_f32 v14, s85, v14
  v_exp_f32 v14, v14
  s_nop 0
  v_add_f32 v15, v15, v14
  v_cvt_pk_bf16_f32 v14, v14, v14
  s_nop 1
  v_mov_b32_dpp v13, v14 row_newbcast:1 row_mask:0xf bank_mask:0x3
  v_mov_b32_dpp v13, v14 row_newbcast:9 row_mask:0xf bank_mask:0xc
  v_and_b32 v16, v8, v13
  v_and_b32 v17, v9, v13
  v_and_b32 v18, v10, v13
  v_and_b32 v19, v11, v13
  s_nop 1
  s_waitcnt vmcnt(6)
  buffer_load_dwordx4 v[60:63], v4, s[8:11], s58 offen offset:128 nt
  v_mfma_f32_16x16x32_bf16 v[20:23], v[16:19], v[64:67], v[20:23]
  s_waitcnt vmcnt(6)
  buffer_load_dwordx4 v[64:67], v4, s[8:11], s58 offen offset:256 nt
  v_mfma_f32_16x16x32_bf16 v[24:27], v[16:19], v[68:71], v[24:27]
  v_readlane_b32 s64, v0, 37
  s_add_u32 s58, s91, 3637248
  s_bfe_u32 s65, s64, 0x30004
  s_mulk_i32 s65, 12288
  v_add_u32 v44, s65, v3
  v_add_u32 v45, 4294868992, v44
  v_min_u32 v4, v44, v45
  s_waitcnt vmcnt(6)
  s_barrier
  buffer_load_dwordx4 v[68:71], v4, s[8:11], s58 offen offset:0 nt
  v_mfma_f32_16x16x32_bf16 v[28:31], v[16:19], v[72:75], v[28:31]
  v_mov_b32_dpp v13, v14 row_newbcast:0 row_mask:0xf bank_mask:0x3
  v_mov_b32_dpp v13, v14 row_newbcast:8 row_mask:0xf bank_mask:0xc
  v_and_b32 v16, v8, v13
  v_and_b32 v17, v9, v13
  v_and_b32 v18, v10, v13
  v_and_b32 v19, v11, v13
  s_nop 1
  v_mfma_f32_16x16x32_bf16 v[20:23], v[16:19], a[0:3], v[20:23]
  v_mfma_f32_16x16x32_bf16 v[24:27], v[16:19], a[4:7], v[24:27]
  v_mfma_f32_16x16x32_bf16 v[28:31], v[16:19], a[8:11], v[28:31]
  v_mov_b32_dpp v13, v14 row_newbcast:2 row_mask:0xf bank_mask:0x3
  v_mov_b32_dpp v13, v14 row_newbcast:10 row_mask:0xf bank_mask:0xc
  v_and_b32 v16, v8, v13
  v_and_b32 v17, v9, v13
  v_and_b32 v18, v10, v13
  v_and_b32 v19, v11, v13
  s_nop 1
  s_waitcnt vmcnt(6)
  buffer_load_dwordx4 v[72:75], v4, s[8:11], s58 offen offset:128 nt
  v_mfma_f32_16x16x32_bf16 v[20:23], v[16:19], v[76:79], v[20:23]
  s_waitcnt vmcnt(6)
  buffer_load_dwordx4 v[76:79], v4, s[8:11], s58 offen offset:256 nt
  v_mfma_f32_16x16x32_bf16 v[24:27], v[16:19], v[48:51], v[24:27]
  v_readlane_b32 s64, v0, 39
  s_add_u32 s58, s91, 3833856
  s_bfe_u32 s65, s64, 0x30004
  s_mulk_i32 s65, 12288
  v_add_u32 v44, s65, v3
  v_add_u32 v45, 4294868992, v44
  v_min_u32 v4, v44, v45
  s_waitcnt vmcnt(6)
  s_barrier
  buffer_load_dwordx4 v[48:51], v4, s[8:11], s58 offen offset:0 nt
  v_mfma_f32_16x16x32_bf16 v[28:31], v[16:19], v[52:55], v[28:31]
  v_mov_b32_dpp v13, v14 row_newbcast:3 row_mask:0xf bank_mask:0x3
  v_mov_b32_dpp v13, v14 row_newbcast:11 row_mask:0xf bank_mask:0xc
  v_and_b32 v16, v8, v13
  v_and_b32 v17, v9, v13
  v_and_b32 v18, v10, v13
  v_and_b32 v19, v11, v13
  s_nop 1
  v_mfma_f32_16x16x32_bf16 v[20:23], v[16:19], a[12:15], v[20:23]
  v_mfma_f32_16x16x32_bf16 v[24:27], v[16:19], a[16:19], v[24:27]
  v_mfma_f32_16x16x32_bf16 v[28:31], v[16:19], a[20:23], v[28:31]
  v_mov_b32_dpp v13, v14 row_newbcast:4 row_mask:0xf bank_mask:0x3
  v_mov_b32_dpp v13, v14 row_newbcast:12 row_mask:0xf bank_mask:0xc
  v_and_b32 v16, v8, v13
  v_and_b32 v17, v9, v13
  v_and_b32 v18, v10, v13
  v_and_b32 v19, v11, v13
  s_nop 1
  s_waitcnt vmcnt(6)
  buffer_load_dwordx4 v[52:55], v4, s[8:11], s58 offen offset:128 nt
  v_mfma_f32_16x16x32_bf16 v[20:23], v[16:19], v[56:59], v[20:23]
  s_waitcnt vmcnt(6)
  buffer_load_dwordx4 v[56:59], v4, s[8:11], s58 offen offset:256 nt
  v_mfma_f32_16x16x32_bf16 v[24:27], v[16:19], v[60:63], v[24:27]
  v_readlane_b32 s64, v0, 41
  s_add_u32 s58, s91, 4030464
  s_bfe_u32 s65, s64, 0x30004
  s_mulk_i32 s65, 12288
  v_add_u32 v44, s65, v3
  v_add_u32 v45, 4294868992, v44
  v_min_u32 v4, v44, v45
  s_waitcnt vmcnt(6)
  s_barrier
  buffer_load_dwordx4 v[60:63], v4, s[8:11], s58 offen offset:0 nt
  v_mfma_f32_16x16x32_bf16 v[28:31], v[16:19], v[64:67], v[28:31]
  v_mov_b32_dpp v13, v14 row_newbcast:5 row_mask:0xf bank_mask:0x3
  v_mov_b32_dpp v13, v14 row_newbcast:13 row_mask:0xf bank_mask:0xc
  v_and_b32 v16, v8, v13
  v_and_b32 v17, v9, v13
  v_and_b32 v18, v10, v13
  v_and_b32 v19, v11, v13
  s_nop 1
  s_waitcnt vmcnt(6)
  buffer_load_dwordx4 v[64:67], v4, s[8:11], s58 offen offset:128 nt
  v_mfma_f32_16x16x32_bf16 v[20:23], v[16:19], v[68:71], v[20:23]
  s_waitcnt vmcnt(6)
  buffer_load_dwordx4 v[68:71], v4, s[8:11], s58 offen offset:256 nt
  v_mfma_f32_16x16x32_bf16 v[24:27], v[16:19], v[72:75], v[24:27]
  v_readlane_b32 s64, v0, 42
  s_add_u32 s58, s91, 4128768
  s_bfe_u32 s65, s64, 0x30004
  s_mulk_i32 s65, 12288
  v_add_u32 v44, s65, v3
  v_add_u32 v45, 4294868992, v44
  v_min_u32 v4, v44, v45
  s_waitcnt vmcnt(6)
  s_barrier
  buffer_load_dwordx4 v[72:75], v4, s[8:11], s58 offen offset:0 nt
  v_mfma_f32_16x16x32_bf16 v[28:31], v[16:19], v[76:79], v[28:31]
  v_mov_b32_dpp v13, v14 row_newbcast:6 row_mask:0xf bank_mask:0x3
  v_mov_b32_dpp v13, v14 row_newbcast:14 row_mask:0xf bank_mask:0xc
  v_and_b32 v16, v8, v13
  v_and_b32 v17, v9, v13
  v_and_b32 v18, v10, v13
  v_and_b32 v19, v11, v13
  s_nop 1
  v_mfma_f32_16x16x32_bf16 v[20:23], v[16:19], a[24:27], v[20:23]
  v_mfma_f32_16x16x32_bf16 v[24:27], v[16:19], a[28:31], v[24:27]
  v_mfma_f32_16x16x32_bf16 v[28:31], v[16:19], a[32:35], v[28:31]
  v_mov_b32_dpp v13, v14 row_newbcast:7 row_mask:0xf bank_mask:0x3
  v_mov_b32_dpp v13, v14 row_newbcast:15 row_mask:0xf bank_mask:0xc
  v_and_b32 v16, v8, v13
  v_and_b32 v17, v9, v13
  v_and_b32 v18, v10, v13
  v_and_b32 v19, v11, v13
  s_nop 1
  s_waitcnt vmcnt(6)
  buffer_load_dwordx4 v[76:79], v4, s[8:11], s58 offen offset:128 nt
  v_mfma_f32_16x16x32_bf16 v[20:23], v[16:19], v[48:51], v[20:23]
  s_waitcnt vmcnt(6)
  buffer_load_dwordx4 v[48:51], v4, s[8:11], s58 offen offset:256 nt
  v_mfma_f32_16x16x32_bf16 v[24:27], v[16:19], v[52:55], v[24:27]
  v_readlane_b32 s64, v0, 44
  s_add_u32 s58, s91, 4325376
  s_bfe_u32 s65, s64, 0x30004
  s_mulk_i32 s65, 12288
  v_add_u32 v44, s65, v3
  v_add_u32 v45, 4294868992, v44
  v_min_u32 v4, v44, v45
  s_waitcnt vmcnt(6)
  s_barrier
  buffer_load_dwordx4 v[52:55], v4, s[8:11], s58 offen offset:0 nt
  v_mfma_f32_16x16x32_bf16 v[28:31], v[16:19], v[56:59], v[28:31]
  s_cmp_lg_u32 s94, 5
  s_cbranch_scc1 L_nf_620
  s_mov_b32 s78, 0
  s_call_b64 s[52:53], L_flush
L_nf_620:
  v_and_b32 v14, 0xffff0000, v34
  v_cmp_lt_f32 vcc, s60, v14
  s_cbranch_vccz L_nr_621
  s_call_b64 s[52:53], L_rescale
L_nr_621:
  v_subrev_f32 v14, s60, v14
  v_mul_f32 v14, s85, v14
  v_exp_f32 v14, v14
  s_nop 0
  v_add_f32 v15, v15, v14
  v_cvt_pk_bf16_f32 v14, v14, v14
  s_nop 1
  v_mov_b32_dpp v13, v14 row_newbcast:1 row_mask:0xf bank_mask:0x3
  v_mov_b32_dpp v13, v14 row_newbcast:9 row_mask:0xf bank_mask:0xc
  v_and_b32 v16, v8, v13
  v_and_b32 v17, v9, v13
  v_and_b32 v18, v10, v13
  v_and_b32 v19, v11, v13
  s_nop 1
  s_waitcnt vmcnt(6)
  buffer_load_dwordx4 v[56:59], v4, s[8:11], s58 offen offset:128 nt
  v_mfma_f32_16x16x32_bf16 v[20:23], v[16:19], v[60:63], v[20:23]
  s_waitcnt vmcnt(6)
  buffer_load_dwordx4 v[60:63], v4, s[8:11], s58 offen offset:256 nt
  v_mfma_f32_16x16x32_bf16 v[24:27], v[16:19], v[64:67], v[24:27]
  v_readlane_b32 s64, v0, 45
  s_add_u32 s58, s91, 4423680
  s_bfe_u32 s65, s64, 0x30004
  s_mulk_i32 s65, 12288
  v_add_u32 v44, s65, v3
  v_add_u32 v45, 4294868992, v44
  v_min_u32 v4, v44, v45
  s_waitcnt vmcnt(6)
  s_barrier
  buffer_load_dwordx4 v[64:67], v4, s[8:11], s58 offen offset:0 nt
  v_mfma_f32_16x16x32_bf16 v[28:31], v[16:19], v[68:71], v[28:31]
  v_mov_b32_dpp v13, v14 row_newbcast:0 row_mask:0xf bank_mask:0x3
  v_mov_b32_dpp v13, v14 row_newbcast:8 row_mask:0xf bank_mask:0xc
  v_and_b32 v16, v8, v13
  v_and_b32 v17, v9, v13
  v_and_b32 v18, v10, v13
  v_and_b32 v19, v11, v13
  s_nop 1
  v_mfma_f32_16x16x32_bf16 v[20:23], v[16:19], a[36:39], v[20:23]
  v_mfma_f32_16x16x32_bf16 v[24:27], v[16:19], a[40:43], v[24:27]
  v_mfma_f32_16x16x32_bf16 v[28:31], v[16:19], a[44:47], v[28:31]
  v_mov_b32_dpp v13, v14 row_newbcast:2 row_mask:0xf bank_mask:0x3
  v_mov_b32_dpp v13, v14 row_newbcast:10 row_mask:0xf bank_mask:0xc
  v_and_b32 v16, v8, v13
  v_and_b32 v17, v9, v13
  v_and_b32 v18, v10, v13
  v_and_b32 v19, v11, v13
  s_nop 1
  s_waitcnt vmcnt(6)
  buffer_load_dwordx4 v[68:71], v4, s[8:11], s58 offen offset:128 nt
  v_mfma_f32_16x16x32_bf16 v[20:23], v[16:19], v[72:75], v[20:23]
  s_waitcnt vmcnt(6)
  buffer_load_dwordx4 v[72:75], v4, s[8:11], s58 offen offset:256 nt
  v_mfma_f32_16x16x32_bf16 v[24:27], v[16:19], v[76:79], v[24:27]
  v_readlane_b32 s64, v0, 47
  s_add_u32 s58, s91, 4620288
  s_bfe_u32 s65, s64, 0x30004
  s_mulk_i32 s65, 12288
  v_add_u32 v44, s65, v3
  v_add_u32 v45, 4294868992, v44
  v_min_u32 v4, v44, v45
  s_waitcnt vmcnt(6)
  s_barrier
  buffer_load_dwordx4 v[76:79], v4, s[8:11], s58 offen offset:0 nt
  v_mfma_f32_16x16x32_bf16 v[28:31], v[16:19], v[48:51], v[28:31]
  v_mov_b32_dpp v13, v14 row_newbcast:3 row_mask:0xf bank_mask:0x3
  v_mov_b32_dpp v13, v14 row_newbcast:11 row_mask:0xf bank_mask:0xc
  v_and_b32 v16, v8, v13
  v_and_b32 v17, v9, v13
  v_and_b32 v18, v10, v13
  v_and_b32 v19, v11, v13
  s_nop 1
  v_mfma_f32_16x16x32_bf16 v[20:23], v[16:19], a[48:51], v[20:23]
  v_mfma_f32_16x16x32_bf16 v[24:27], v[16:19], a[52:55], v[24:27]
  v_mfma_f32_16x16x32_bf16 v[28:31], v[16:19], a[56:59], v[28:31]
  v_mov_b32_dpp v13, v14 row_newbcast:4 row_mask:0xf bank_mask:0x3
  v_mov_b32_dpp v13, v14 row_newbcast:12 row_mask:0xf bank_mask:0xc
  v_and_b32 v16, v8, v13
  v_and_b32 v17, v9, v13
  v_and_b32 v18, v10, v13
  v_and_b32 v19, v11, v13
  s_nop 1
  s_waitcnt vmcnt(6)
  buffer_load_dwordx4 v[48:51], v4, s[8:11], s58 offen offset:128 nt
  v_mfma_f32_16x16x32_bf16 v[20:23], v[16:19], v[52:55], v[20:23]
  s_waitcnt vmcnt(6)
  buffer_load_dwordx4 v[52:55], v4, s[8:11], s58 offen offset:256 nt
  v_mfma_f32_16x16x32_bf16 v[24:27], v[16:19], v[56:59], v[24:27]
  v_readlane_b32 s64, v0, 49
  s_add_u32 s58, s91, 4816896
  s_bfe_u32 s65, s64, 0x30004
  s_mulk_i32 s65, 12288
  v_add_u32 v44, s65, v3
  v_add_u32 v45, 4294868992, v44
  v_min_u32 v4, v44, v45
  s_waitcnt vmcnt(6)
  s_barrier
  buffer_load_dwordx4 v[56:59], v4, s[8:11], s58 offen offset:0 nt
  v_mfma_f32_16x16x32_bf16 v[28:31], v[16:19], v[60:63], v[28:31]
  v_mov_b32_dpp v13, v14 row_newbcast:5 row_mask:0xf bank_mask:0x3
  v_mov_b32_dpp v13, v14 row_newbcast:13 row_mask:0xf bank_mask:0xc
  v_and_b32 v16, v8, v13
  v_and_b32 v17, v9, v13
  v_and_b32 v18, v10, v13
  v_and_b32 v19, v11, v13
  s_nop 1
  s_waitcnt vmcnt(6)
  buffer_load_dwordx4 v[60:63], v4, s[8:11], s58 offen offset:128 nt
  v_mfma_f32_16x16x32_bf16 v[20:23], v[16:19], v[64:67], v[20:23]
  s_waitcnt vmcnt(6)
  buffer_load_dwordx4 v[64:67], v4, s[8:11], s58 offen offset:256 nt
  v_mfma_f32_16x16x32_bf16 v[24:27], v[16:19], v[68:71], v[24:27]
  v_readlane_b32 s64, v0, 50
  s_add_u32 s58, s91, 4915200
  s_bfe_u32 s65, s64, 0x30004
  s_mulk_i32 s65, 12288
  v_add_u32 v44, s65, v3
  v_add_u32 v45, 4294868992, v44
  v_min_u32 v4, v44, v45
  s_waitcnt vmcnt(6)
  s_barrier
  buffer_load_dwordx4 v[68:71], v4, s[8:11], s58 offen offset:0 nt
  v_mfma_f32_16x16x32_bf16 v[28:31], v[16:19], v[72:75], v[28:31]
  v_mov_b32_dpp v13, v14 row_newbcast:6 row_mask:0xf bank_mask:0x3
  v_mov_b32_dpp v13, v14 row_newbcast:14 row_mask:0xf bank_mask:0xc
  v_and_b32 v16, v8, v13
  v_and_b32 v17, v9, v13
  v_and_b32 v18, v10, v13
  v_and_b32 v19, v11, v13
  s_nop 1
  v_mfma_f32_16x16x32_bf16 v[20:23], v[16:19], a[60:63], v[20:23]
  v_mfma_f32_16x16x32_bf16 v[24:27], v[16:19], a[64:67], v[24:27]
  v_mfma_f32_16x16x32_bf16 v[28:31], v[16:19], a[68:71], v[28:31]
  v_mov_b32_dpp v13, v14 row_newbcast:7 row_mask:0xf bank_mask:0x3
  v_mov_b32_dpp v13, v14 row_newbcast:15 row_mask:0xf bank_mask:0xc
  v_and_b32 v16, v8, v13
  v_and_b32 v17, v9, v13
  v_and_b32 v18, v10, v13
  v_and_b32 v19, v11, v13
  s_nop 1
  s_waitcnt vmcnt(6)
  buffer_load_dwordx4 v[72:75], v4, s[8:11], s58 offen offset:128 nt
  v_mfma_f32_16x16x32_bf16 v[20:23], v[16:19], v[76:79], v[20:23]
  s_waitcnt vmcnt(6)
  buffer_load_dwordx4 v[76:79], v4, s[8:11], s58 offen offset:256 nt
  v_mfma_f32_16x16x32_bf16 v[24:27], v[16:19], v[48:51], v[24:27]
  v_readlane_b32 s64, v0, 52
  s_add_u32 s58, s91, 5111808
  s_bfe_u32 s65, s64, 0x30004
  s_mulk_i32 s65, 12288
  v_add_u32 v44, s65, v3
  v_add_u32 v45, 4294868992, v44
  v_min_u32 v4, v44, v45
  s_waitcnt vmcnt(6)
  s_barrier
  buffer_load_dwordx4 v[48:51], v4, s[8:11], s58 offen offset:0 nt
  v_mfma_f32_16x16x32_bf16 v[28:31], v[16:19], v[52:55], v[28:31]
  s_cmp_lg_u32 s94, 6
  s_cbranch_scc1 L_nf_622
  s_mov_b32 s78, 0
  s_call_b64 s[52:53], L_flush
L_nf_622:
  v_lshlrev_b32 v14, 16, v35
  v_cmp_lt_f32 vcc, s60, v14
  s_cbranch_vccz L_nr_623
  s_call_b64 s[52:53], L_rescale
L_nr_623:
  v_subrev_f32 v14, s60, v14
  v_mul_f32 v14, s85, v14
  v_exp_f32 v14, v14
  s_nop 0
  v_add_f32 v15, v15, v14
  v_cvt_pk_bf16_f32 v14, v14, v14
  s_nop 1
  v_mov_b32_dpp v13, v14 row_newbcast:1 row_mask:0xf bank_mask:0x3
  v_mov_b32_dpp v13, v14 row_newbcast:9 row_mask:0xf bank_mask:0xc
  v_and_b32 v16, v8, v13
  v_and_b32 v17, v9, v13
  v_and_b32 v18, v10, v13
  v_and_b32 v19, v11, v13
  s_nop 1
  s_waitcnt vmcnt(6)
  buffer_load_dwordx4 v[52:55], v4, s[8:11], s58 offen offset:128 nt
  v_mfma_f32_16x16x32_bf16 v[20:23], v[16:19], v[56:59], v[20:23]
  s_waitcnt vmcnt(6)
  buffer_load_dwordx4 v[56:59], v4, s[8:11], s58 offen offset:256 nt
  v_mfma_f32_16x16x32_bf16 v[24:27], v[16:19], v[60:63], v[24:27]
  v_readlane_b32 s64, v0, 53
  s_add_u32 s58, s91, 5210112
  s_bfe_u32 s65, s64, 0x30004
  s_mulk_i32 s65, 12288
  v_add_u32 v44, s65, v3
  v_add_u32 v45, 4294868992, v44
  v_min_u32 v4, v44, v45
  s_waitcnt vmcnt(6)
  s_barrier
  buffer_load_dwordx4 v[60:63], v4, s[8:11], s58 offen offset:0 nt
  v_mfma_f32_16x16x32_bf16 v[28:31], v[16:19], v[64:67], v[28:31]
  v_mov_b32_dpp v13, v14 row_newbcast:0 row_mask:0xf bank_mask:0x3
  v_mov_b32_dpp v13, v14 row_newbcast:8 row_mask:0xf bank_mask:0xc
  v_and_b32 v16, v8, v13
  v_and_b32 v17, v9, v13
  v_and_b32 v18, v10, v13
  v_and_b32 v19, v11, v13
  s_nop 1
  v_mfma_f32_16x16x32_bf16 v[20:23], v[16:19], a[72:75], v[20:23]
  v_mfma_f32_16x16x32_bf16 v[24:27], v[16:19], a[76:79], v[24:27]
  v_mfma_f32_16x16x32_bf16 v[28:31], v[16:19], a[80:83], v[28:31]
  v_mov_b32_dpp v13, v14 row_newbcast:2 row_mask:0xf bank_mask:0x3
  v_mov_b32_dpp v13, v14 row_newbcast:10 row_mask:0xf bank_mask:0xc
  v_and_b32 v16, v8, v13
  v_and_b32 v17, v9, v13
  v_and_b32 v18, v10, v13
  v_and_b32 v19, v11, v13
  s_nop 1
  s_waitcnt vmcnt(6)
  buffer_load_dwordx4 v[64:67], v4, s[8:11], s58 offen offset:128 nt
  v_mfma_f32_16x16x32_bf16 v[20:23], v[16:19], v[68:71], v[20:23]
  s_waitcnt vmcnt(6)
  buffer_load_dwordx4 v[68:71], v4, s[8:11], s58 offen offset:256 nt
  v_mfma_f32_16x16x32_bf16 v[24:27], v[16:19], v[72:75], v[24:27]
  v_readlane_b32 s64, v0, 55
  s_add_u32 s58, s91, 5406720
  s_bfe_u32 s65, s64, 0x30004
  s_mulk_i32 s65, 12288
  v_add_u32 v44, s65, v3
  v_add_u32 v45, 4294868992, v44
  v_min_u32 v4, v44, v45
  s_waitcnt vmcnt(6)
  s_barrier
  buffer_load_dwordx4 v[72:75], v4, s[8:11], s58 offen offset:0 nt
  v_mfma_f32_16x16x32_bf16 v[28:31], v[16:19], v[76:79], v[28:31]
  v_mov_b32_dpp v13, v14 row_newbcast:3 row_mask:0xf bank_mask:0x3
  v_mov_b32_dpp v13, v14 row_newbcast:11 row_mask:0xf bank_mask:0xc
  v_and_b32 v16, v8, v13
  v_and_b32 v17, v9, v13
  v_and_b32 v18, v10, v13
  v_and_b32 v19, v11, v13
  s_nop 1
  v_mfma_f32_16x16x32_bf16 v[20:23], v[16:19], a[84:87], v[20:23]
  v_mfma_f32_16x16x32_bf16 v[24:27], v[16:19], a[88:91], v[24:27]
  v_mfma_f32_16x16x32_bf16 v[28:31], v[16:19], a[92:95], v[28:31]
  s_xor_b32 s71, s2, 4
  s_lshl_b32 s71, s71, 7
  s_add_u32 s71, s71, 2621440
  v_mov_b32 v47, s99
  buffer_load_dword v47, v47, s[28:31], s71 offen sc1 nt
  v_mov_b32_dpp v13, v14 row_newbcast:4 row_mask:0xf bank_mask:0x3
  v_mov_b32_dpp v13, v14 row_newbcast:12 row_mask:0xf bank_mask:0xc
  v_and_b32 v16, v8, v13
  v_and_b32 v17, v9, v13
  v_and_b32 v18, v10, v13
  v_and_b32 v19, v11, v13
  s_nop 1
  s_waitcnt vmcnt(7)
  buffer_load_dwordx4 v[76:79], v4, s[8:11], s58 offen offset:128 nt
  v_mfma_f32_16x16x32_bf16 v[20:23], v[16:19], v[48:51], v[20:23]
  s_waitcnt vmcnt(7)
  buffer_load_dwordx4 v[48:51], v4, s[8:11], s58 offen offset:256 nt
  v_mfma_f32_16x16x32_bf16 v[24:27], v[16:19], v[52:55], v[24:27]
  v_readlane_b32 s64, v0, 57
  s_add_u32 s58, s91, 5603328
  s_bfe_u32 s65, s64, 0x30004
  s_mulk_i32 s65, 12288
  v_add_u32 v44, s65, v3
  v_add_u32 v45, 4294868992, v44
  v_min_u32 v4, v44, v45
  s_waitcnt vmcnt(7)
  s_barrier
  buffer_load_dwordx4 v[52:55], v4, s[8:11], s58 offen offset:0 nt
  v_mfma_f32_16x16x32_bf16 v[28:31], v[16:19], v[56:59], v[28:31]
  v_mov_b32_dpp v13, v14 row_newbcast:5 row_mask:0xf bank_mask:0x3
  v_mov_b32_dpp v13, v14 row_newbcast:13 row_mask:0xf bank_mask:0xc
  v_and_b32 v16, v8, v13
  v_and_b32 v17, v9, v13
  v_and_b32 v18, v10, v13
  v_and_b32 v19, v11, v13
  s_nop 1
  s_waitcnt vmcnt(7)
  buffer_load_dwordx4 v[56:59], v4, s[8:11], s58 offen offset:128 nt
  v_mfma_f32_16x16x32_bf16 v[20:23], v[16:19], v[60:63], v[20:23]
  s_waitcnt vmcnt(7)
  buffer_load_dwordx4 v[60:63], v4, s[8:11], s58 offen offset:256 nt
  v_mfma_f32_16x16x32_bf16 v[24:27], v[16:19], v[64:67], v[24:27]
  v_readlane_b32 s64, v0, 58
  s_add_u32 s58, s91, 5701632
  s_bfe_u32 s65, s64, 0x30004
  s_mulk_i32 s65, 12288
  v_add_u32 v44, s65, v3
  v_add_u32 v45, 4294868992, v44
  v_min_u32 v4, v44, v45
  s_waitcnt vmcnt(7)
  s_barrier
  buffer_load_dwordx4 v[64:67], v4, s[8:11], s58 offen offset:0 nt
  v_mfma_f32_16x16x32_bf16 v[28:31], v[16:19], v[68:71], v[28:31]
  v_mov_b32_dpp v13, v14 row_newbcast:6 row_mask:0xf bank_mask:0x3
  v_mov_b32_dpp v13, v14 row_newbcast:14 row_mask:0xf bank_mask:0xc
  v_and_b32 v16, v8, v13
  v_and_b32 v17, v9, v13
  v_and_b32 v18, v10, v13
  v_and_b32 v19, v11, v13
  s_nop 1
  v_mfma_f32_16x16x32_bf16 v[20:23], v[16:19], a[96:99], v[20:23]
  v_mfma_f32_16x16x32_bf16 v[24:27], v[16:19], a[100:103], v[24:27]
  v_mfma_f32_16x16x32_bf16 v[28:31], v[16:19], a[104:107], v[28:31]
  v_mov_b32_dpp v13, v14 row_newbcast:7 row_mask:0xf bank_mask:0x3
  v_mov_b32_dpp v13, v14 row_newbcast:15 row_mask:0xf bank_mask:0xc
  v_and_b32 v16, v8, v13
  v_and_b32 v17, v9, v13
  v_and_b32 v18, v10, v13
  v_and_b32 v19, v11, v13
  s_nop 1
  s_waitcnt vmcnt(7)
  buffer_load_dwordx4 v[68:71], v4, s[8:11], s58 offen offset:128 nt
  v_mfma_f32_16x16x32_bf16 v[20:23], v[16:19], v[72:75], v[20:23]
  s_waitcnt vmcnt(6)
  buffer_load_dwordx4 v[72:75], v4, s[8:11], s58 offen offset:256 nt
  v_mfma_f32_16x16x32_bf16 v[24:27], v[16:19], v[76:79], v[24:27]
  v_readlane_b32 s64, v0, 60
  s_add_u32 s58, s91, 5898240
  s_bfe_u32 s65, s64, 0x30004
  s_mulk_i32 s65, 12288
  v_add_u32 v44, s65, v3
  v_add_u32 v45, 4294868992, v44
  v_min_u32 v4, v44, v45
  s_waitcnt vmcnt(6)
  s_barrier
  buffer_load_dwordx4 v[76:79], v4, s[8:11], s58 offen offset:0 nt
  v_mfma_f32_16x16x32_bf16 v[28:31], v[16:19], v[48:51], v[28:31]
  v_and_b32 v14, 0xffff0000, v35
  v_readfirstlane_b32 s77, v47
  s_or_b32 s78, s88, s99
  s_cmp_lt_i32 s77, s78
  s_cbranch_scc1 L_fs_624
L_fk_625:
  v_lshl_or_b32 v46, v1, 4, s99
  s_xor_b32 s77, s87, 0x8000
  buffer_load_dwordx4 v[40:43], v46, s[28:31], s77 offen offset:1024 sc1 nt
  v_cmp_lt_f32 vcc, s60, v14
  s_cbranch_vccz L_nr_626
  s_call_b64 s[52:53], L_rescale
L_nr_626:
  v_subrev_f32 v14, s60, v14
  v_mul_f32 v14, s85, v14
  v_exp_f32 v14, v14
  s_nop 0
  v_add_f32 v15, v15, v14
  v_cvt_pk_bf16_f32 v14, v14, v14
  s_nop 1
  v_mov_b32_dpp v13, v14 row_newbcast:1 row_mask:0xf bank_mask:0x3
  v_mov_b32_dpp v13, v14 row_newbcast:9 row_mask:0xf bank_mask:0xc
  v_and_b32 v16, v8, v13
  v_and_b32 v17, v9, v13
  v_and_b32 v18, v10, v13
  v_and_b32 v19, v11, v13
  s_nop 1
  s_waitcnt vmcnt(7)
  buffer_load_dwordx4 v[48:51], v4, s[8:11], s58 offen offset:128 nt
  v_mfma_f32_16x16x32_bf16 v[20:23], v[16:19], v[52:55], v[20:23]
  s_waitcnt vmcnt(7)
  buffer_load_dwordx4 v[52:55], v4, s[8:11], s58 offen offset:256 nt
  v_mfma_f32_16x16x32_bf16 v[24:27], v[16:19], v[56:59], v[24:27]
  v_readlane_b32 s64, v0, 61
  s_add_u32 s58, s91, 5996544
  s_bfe_u32 s65, s64, 0x30004
  s_mulk_i32 s65, 12288
  v_add_u32 v44, s65, v3
  v_add_u32 v45, 4294868992, v44
  v_min_u32 v4, v44, v45
  s_waitcnt vmcnt(7)
  s_barrier
  buffer_load_dwordx4 v[56:59], v4, s[8:11], s58 offen offset:0 nt
  v_mfma_f32_16x16x32_bf16 v[28:31], v[16:19], v[60:63], v[28:31]
  v_mov_b32_dpp v13, v14 row_newbcast:0 row_mask:0xf bank_mask:0x3
  v_mov_b32_dpp v13, v14 row_newbcast:8 row_mask:0xf bank_mask:0xc
  v_and_b32 v16, v8, v13
  v_and_b32 v17, v9, v13
  v_and_b32 v18, v10, v13
  v_and_b32 v19, v11, v13
  s_nop 1
  v_mfma_f32_16x16x32_bf16 v[20:23], v[16:19], a[108:111], v[20:23]
  v_mfma_f32_16x16x32_bf16 v[24:27], v[16:19], a[112:115], v[24:27]
  v_mfma_f32_16x16x32_bf16 v[28:31], v[16:19], a[116:119], v[28:31]
  v_mov_b32_dpp v13, v14 row_newbcast:2 row_mask:0xf bank_mask:0x3
  v_mov_b32_dpp v13, v14 row_newbcast:10 row_mask:0xf bank_mask:0xc
  v_and_b32 v16, v8, v13
  v_and_b32 v17, v9, v13
  v_and_b32 v18, v10, v13
  v_and_b32 v19, v11, v13
  s_nop 1
  s_waitcnt vmcnt(7)
  buffer_load_dwordx4 v[60:63], v4, s[8:11], s58 offen offset:128 nt
  v_mfma_f32_16x16x32_bf16 v[20:23], v[16:19], v[64:67], v[20:23]
  s_waitcnt vmcnt(7)
  buffer_load_dwordx4 v[64:67], v4, s[8:11], s58 offen offset:256 nt
  v_mfma_f32_16x16x32_bf16 v[24:27], v[16:19], v[68:71], v[24:27]
  v_readlane_b32 s64, v0, 63
  s_add_u32 s58, s91, 6193152
  s_bfe_u32 s65, s64, 0x30004
  s_mulk_i32 s65, 12288
  v_add_u32 v44, s65, v3
  v_add_u32 v45, 4294868992, v44
  v_min_u32 v4, v44, v45
  s_waitcnt vmcnt(7)
  s_barrier
  buffer_load_dwordx4 v[68:71], v4, s[8:11], s58 offen offset:0 nt
  v_mfma_f32_16x16x32_bf16 v[28:31], v[16:19], v[72:75], v[28:31]
  v_mov_b32_dpp v13, v14 row_newbcast:3 row_mask:0xf bank_mask:0x3
  v_mov_b32_dpp v13, v14 row_newbcast:11 row_mask:0xf bank_mask:0xc
  v_and_b32 v16, v8, v13
  v_and_b32 v17, v9, v13
  v_and_b32 v18, v10, v13
  v_and_b32 v19, v11, v13
  s_nop 1
  v_mfma_f32_16x16x32_bf16 v[20:23], v[16:19], a[120:123], v[20:23]
  v_mfma_f32_16x16x32_bf16 v[24:27], v[16:19], a[124:127], v[24:27]
  v_mfma_f32_16x16x32_bf16 v[28:31], v[16:19], a[128:131], v[28:31]
  v_mov_b32_dpp v13, v14 row_newbcast:4 row_mask:0xf bank_mask:0x3
  v_mov_b32_dpp v13, v14 row_newbcast:12 row_mask:0xf bank_mask:0xc
  v_and_b32 v16, v8, v13
  v_and_b32 v17, v9, v13
  v_and_b32 v18, v10, v13
  v_and_b32 v19, v11, v13
  s_nop 1
  s_waitcnt vmcnt(7)
  buffer_load_dwordx4 v[72:75], v4, s[8:11], s58 offen offset:128 nt
  v_mfma_f32_16x16x32_bf16 v[20:23], v[16:19], v[76:79], v[20:23]
  s_waitcnt vmcnt(6)
  buffer_load_dwordx4 v[76:79], v4, s[8:11], s58 offen offset:256 nt
  v_mfma_f32_16x16x32_bf16 v[24:27], v[16:19], v[48:51], v[24:27]
  v_readlane_b32 s64, v0, 1
  s_add_u32 s58, s91, 6389760
  s_bfe_u32 s65, s64, 0x3000c
  s_mulk_i32 s65, 12288
  v_add_u32 v44, s65, v3
  v_add_u32 v45, 4294868992, v44
  v_min_u32 v4, v44, v45
  s_waitcnt vmcnt(6)
  s_barrier
  buffer_load_dwordx4 v[48:51], v4, s[8:11], s58 offen offset:0 nt
  v_mfma_f32_16x16x32_bf16 v[28:31], v[16:19], v[52:55], v[28:31]
  v_mov_b32_dpp v13, v14 row_newbcast:5 row_mask:0xf bank_mask:0x3
  v_mov_b32_dpp v13, v14 row_newbcast:13 row_mask:0xf bank_mask:0xc
  v_and_b32 v16, v8, v13
  v_and_b32 v17, v9, v13
  v_and_b32 v18, v10, v13
  v_and_b32 v19, v11, v13
  s_nop 1
  s_waitcnt vmcnt(6)
  buffer_load_dwordx4 v[52:55], v4, s[8:11], s58 offen offset:128 nt
  v_mfma_f32_16x16x32_bf16 v[20:23], v[16:19], v[56:59], v[20:23]
  s_waitcnt vmcnt(6)
  buffer_load_dwordx4 v[56:59], v4, s[8:11], s58 offen offset:256 nt
  v_mfma_f32_16x16x32_bf16 v[24:27], v[16:19], v[60:63], v[24:27]
  v_readlane_b32 s64, v0, 2
  s_add_u32 s58, s91, 6488064
  s_bfe_u32 s65, s64, 0x3000c
  s_mulk_i32 s65, 12288
  v_add_u32 v44, s65, v3
  v_add_u32 v45, 4294868992, v44
  v_min_u32 v4, v44, v45
  s_waitcnt vmcnt(6)
  s_barrier
  buffer_load_dwordx4 v[60:63], v4, s[8:11], s58 offen offset:0 nt
  v_mfma_f32_16x16x32_bf16 v[28:31], v[16:19], v[64:67], v[28:31]
  v_mov_b32_dpp v13, v14 row_newbcast:6 row_mask:0xf bank_mask:0x3
  v_mov_b32_dpp v13, v14 row_newbcast:14 row_mask:0xf bank_mask:0xc
  v_and_b32 v16, v8, v13
  v_and_b32 v17, v9, v13
  v_and_b32 v18, v10, v13
  v_and_b32 v19, v11, v13
  s_nop 1
  v_mfma_f32_16x16x32_bf16 v[20:23], v[16:19], a[132:135], v[20:23]
  v_mfma_f32_16x16x32_bf16 v[24:27], v[16:19], a[136:139], v[24:27]
  v_mfma_f32_16x16x32_bf16 v[28:31], v[16:19], a[140:143], v[28:31]
  v_mov_b32_dpp v13, v14 row_newbcast:7 row_mask:0xf bank_mask:0x3
  v_mov_b32_dpp v13, v14 row_newbcast:15 row_mask:0xf bank_mask:0xc
  v_and_b32 v16, v8, v13
  v_and_b32 v17, v9, v13
  v_and_b32 v18, v10, v13
  v_and_b32 v19, v11, v13
  s_nop 1
  s_waitcnt vmcnt(6)
  buffer_load_dwordx4 v[64:67], v4, s[8:11], s58 offen offset:128 nt
  v_mfma_f32_16x16x32_bf16 v[20:23], v[16:19], v[68:71], v[20:23]
  s_waitcnt vmcnt(6)
  buffer_load_dwordx4 v[68:71], v4, s[8:11], s58 offen offset:256 nt
  v_mfma_f32_16x16x32_bf16 v[24:27], v[16:19], v[72:75], v[24:27]
  v_readlane_b32 s64, v0, 4
  s_add_u32 s58, s91, 6684672
  s_bfe_u32 s65, s64, 0x3000c
  s_mulk_i32 s65, 12288
  v_add_u32 v44, s65, v3
  v_add_u32 v45, 4294868992, v44
  v_min_u32 v4, v44, v45
  s_waitcnt vmcnt(6)
  s_barrier
  buffer_load_dwordx4 v[72:75], v4, s[8:11], s58 offen offset:0 nt
  v_mfma_f32_16x16x32_bf16 v[28:31], v[16:19], v[76:79], v[28:31]
  v_and_b32 v46, 7, v1
  s_xor_b32 s77, s46, s50
  v_lshrrev_b32 v44, v46, s77
  v_bfe_i32 v45, v44, 0, 1
  v_bfe_i32 v13, v44, 8, 1
  v_alignbit_b32 v45, v13, v45, 16
  v_bfi_b32 v36, v45, v40, v36
  v_bfe_i32 v45, v44, 16, 1
  v_bfe_i32 v13, v44, 24, 1
  v_alignbit_b32 v45, v13, v45, 16
  v_bfi_b32 v37, v45, v41, v37
  s_xor_b32 s77, s47, s51
  v_lshrrev_b32 v44, v46, s77
  v_bfe_i32 v45, v44, 0, 1
  v_bfe_i32 v13, v44, 8, 1
  v_alignbit_b32 v45, v13, v45, 16
  v_bfi_b32 v38, v45, v42, v38
  v_bfe_i32 v45, v44, 16, 1
  v_bfe_i32 v13, v44, 24, 1
  v_alignbit_b32 v45, v13, v45, 16
  v_bfi_b32 v39, v45, v43, v39
  v_lshlrev_b32 v14, 16, v36
  v_cmp_lt_f32 vcc, s60, v14
  s_cbranch_vccz L_nr_627
  s_call_b64 s[52:53], L_rescale
L_nr_627:
  v_subrev_f32 v14, s60, v14
  v_mul_f32 v14, s85, v14
  v_exp_f32 v14, v14
  s_nop 0
  v_add_f32 v15, v15, v14
  v_cvt_pk_bf16_f32 v14, v14, v14
  s_nop 1
  v_mov_b32_dpp v13, v14 row_newbcast:1 row_mask:0xf bank_mask:0x3
  v_mov_b32_dpp v13, v14 row_newbcast:9 row_mask:0xf bank_mask:0xc
  v_and_b32 v16, v8, v13
  v_and_b32 v17, v9, v13
  v_and_b32 v18, v10, v13
  v_and_b32 v19, v11, v13
  s_nop 1
  s_waitcnt vmcnt(6)
  buffer_load_dwordx4 v[76:79], v4, s[8:11], s58 offen offset:128 nt
  v_mfma_f32_16x16x32_bf16 v[20:23], v[16:19], v[48:51], v[20:23]
  s_waitcnt vmcnt(6)
  buffer_load_dwordx4 v[48:51], v4, s[8:11], s58 offen offset:256 nt
  v_mfma_f32_16x16x32_bf16 v[24:27], v[16:19], v[52:55], v[24:27]
  v_readlane_b32 s64, v0, 5
  s_add_u32 s58, s91, 6782976
  s_bfe_u32 s65, s64, 0x3000c
  s_mulk_i32 s65, 12288
  v_add_u32 v44, s65, v3
  v_add_u32 v45, 4294868992, v44
  v_min_u32 v4, v44, v45
  s_waitcnt vmcnt(6)
  s_barrier
  buffer_load_dwordx4 v[52:55], v4, s[8:11], s58 offen offset:0 nt
  v_mfma_f32_16x16x32_bf16 v[28:31], v[16:19], v[56:59], v[28:31]
  v_mov_b32_dpp v13, v14 row_newbcast:0 row_mask:0xf bank_mask:0x3
  v_mov_b32_dpp v13, v14 row_newbcast:8 row_mask:0xf bank_mask:0xc
  v_and_b32 v16, v8, v13
  v_and_b32 v17, v9, v13
  v_and_b32 v18, v10, v13
  v_and_b32 v19, v11, v13
  s_nop 1
  v_mfma_f32_16x16x32_bf16 v[20:23], v[16:19], a[144:147], v[20:23]
  v_mfma_f32_16x16x32_bf16 v[24:27], v[16:19], a[148:151], v[24:27]
  v_mfma_f32_16x16x32_bf16 v[28:31], v[16:19], a[152:155], v[28:31]
  v_mov_b32_dpp v13, v14 row_newbcast:2 row_mask:0xf bank_mask:0x3
  v_mov_b32_dpp v13, v14 row_newbcast:10 row_mask:0xf bank_mask:0xc
  v_and_b32 v16, v8, v13
  v_and_b32 v17, v9, v13
  v_and_b32 v18, v10, v13
  v_and_b32 v19, v11, v13
  s_nop 1
  s_waitcnt vmcnt(6)
  buffer_load_dwordx4 v[56:59], v4, s[8:11], s58 offen offset:128 nt
  v_mfma_f32_16x16x32_bf16 v[20:23], v[16:19], v[60:63], v[20:23]
  s_waitcnt vmcnt(6)
  buffer_load_dwordx4 v[60:63], v4, s[8:11], s58 offen offset:256 nt
  v_mfma_f32_16x16x32_bf16 v[24:27], v[16:19], v[64:67], v[24:27]
  v_readlane_b32 s64, v0, 7
  s_add_u32 s58, s91, 6979584
  s_bfe_u32 s65, s64, 0x3000c
  s_mulk_i32 s65, 12288
  v_add_u32 v44, s65, v3
  v_add_u32 v45, 4294868992, v44
  v_min_u32 v4, v44, v45
  s_waitcnt vmcnt(6)
  s_barrier
  buffer_load_dwordx4 v[64:67], v4, s[8:11], s58 offen offset:0 nt
  v_mfma_f32_16x16x32_bf16 v[28:31], v[16:19], v[68:71], v[28:31]
  v_mov_b32_dpp v13, v14 row_newbcast:3 row_mask:0xf bank_mask:0x3
  v_mov_b32_dpp v13, v14 row_newbcast:11 row_mask:0xf bank_mask:0xc
  v_and_b32 v16, v8, v13
  v_and_b32 v17, v9, v13
  v_and_b32 v18, v10, v13
  v_and_b32 v19, v11, v13
  s_nop 1
  v_mfma_f32_16x16x32_bf16 v[20:23], v[16:19], a[156:159], v[20:23]
  v_mfma_f32_16x16x32_bf16 v[24:27], v[16:19], a[160:163], v[24:27]
  v_mfma_f32_16x16x32_bf16 v[28:31], v[16:19], a[164:167], v[28:31]
  v_mov_b32_dpp v13, v14 row_newbcast:4 row_mask:0xf bank_mask:0x3
  v_mov_b32_dpp v13, v14 row_newbcast:12 row_mask:0xf bank_mask:0xc
  v_and_b32 v16, v8, v13
  v_and_b32 v17, v9, v13
  v_and_b32 v18, v10, v13
  v_and_b32 v19, v11, v13
  s_nop 1
  s_waitcnt vmcnt(6)
  buffer_load_dwordx4 v[68:71], v4, s[8:11], s58 offen offset:128 nt
  v_mfma_f32_16x16x32_bf16 v[20:23], v[16:19], v[72:75], v[20:23]
  s_waitcnt vmcnt(6)
  buffer_load_dwordx4 v[72:75], v4, s[8:11], s58 offen offset:256 nt
  v_mfma_f32_16x16x32_bf16 v[24:27], v[16:19], v[76:79], v[24:27]
  v_readlane_b32 s64, v0, 9
  s_add_u32 s58, s91, 7176192
  s_bfe_u32 s65, s64, 0x3000c
  s_mulk_i32 s65, 12288
  v_add_u32 v44, s65, v3
  v_add_u32 v45, 4294868992, v44
  v_min_u32 v4, v44, v45
  s_waitcnt vmcnt(6)
  s_barrier
  buffer_load_dwordx4 v[76:79], v4, s[8:11], s58 offen offset:0 nt
  v_mfma_f32_16x16x32_bf16 v[28:31], v[16:19], v[48:51], v[28:31]
  v_mov_b32_dpp v13, v14 row_newbcast:5 row_mask:0xf bank_mask:0x3
  v_mov_b32_dpp v13, v14 row_newbcast:13 row_mask:0xf bank_mask:0xc
  v_and_b32 v16, v8, v13
  v_and_b32 v17, v9, v13
  v_and_b32 v18, v10, v13
  v_and_b32 v19, v11, v13
  s_nop 1
  s_waitcnt vmcnt(6)
  buffer_load_dwordx4 v[48:51], v4, s[8:11], s58 offen offset:128 nt
  v_mfma_f32_16x16x32_bf16 v[20:23], v[16:19], v[52:55], v[20:23]
  s_waitcnt vmcnt(6)
  buffer_load_dwordx4 v[52:55], v4, s[8:11], s58 offen offset:256 nt
  v_mfma_f32_16x16x32_bf16 v[24:27], v[16:19], v[56:59], v[24:27]
  v_readlane_b32 s64, v0, 10
  s_add_u32 s58, s91, 7274496
  s_bfe_u32 s65, s64, 0x3000c
  s_mulk_i32 s65, 12288
  v_add_u32 v44, s65, v3
  v_add_u32 v45, 4294868992, v44
  v_min_u32 v4, v44, v45
  s_waitcnt vmcnt(6)
  s_barrier
  buffer_load_dwordx4 v[56:59], v4, s[8:11], s58 offen offset:0 nt
  v_mfma_f32_16x16x32_bf16 v[28:31], v[16:19], v[60:63], v[28:31]
  v_mov_b32_dpp v13, v14 row_newbcast:6 row_mask:0xf bank_mask:0x3
  v_mov_b32_dpp v13, v14 row_newbcast:14 row_mask:0xf bank_mask:0xc
  v_and_b32 v16, v8, v13
  v_and_b32 v17, v9, v13
  v_and_b32 v18, v10, v13
  v_and_b32 v19, v11, v13
  s_nop 1
  v_mfma_f32_16x16x32_bf16 v[20:23], v[16:19], a[168:171], v[20:23]
  v_mfma_f32_16x16x32_bf16 v[24:27], v[16:19], a[172:175], v[24:27]
  v_mfma_f32_16x16x32_bf16 v[28:31], v[16:19], a[176:179], v[28:31]
  v_mov_b32_dpp v13, v14 row_newbcast:7 row_mask:0xf bank_mask:0x3
  v_mov_b32_dpp v13, v14 row_newbcast:15 row_mask:0xf bank_mask:0xc
  v_and_b32 v16, v8, v13
  v_and_b32 v17, v9, v13
  v_and_b32 v18, v10, v13
  v_and_b32 v19, v11, v13
  s_nop 1
  s_waitcnt vmcnt(6)
  buffer_load_dwordx4 v[60:63], v4, s[8:11], s58 offen offset:128 nt
  v_mfma_f32_16x16x32_bf16 v[20:23], v[16:19], v[64:67], v[20:23]
  s_waitcnt vmcnt(6)
  buffer_load_dwordx4 v[64:67], v4, s[8:11], s58 offen offset:256 nt
  v_mfma_f32_16x16x32_bf16 v[24:27], v[16:19], v[68:71], v[24:27]
  v_readlane_b32 s64, v0, 12
  s_add_u32 s58, s91, 7471104
  s_bfe_u32 s65, s64, 0x3000c
  s_mulk_i32 s65, 12288
  v_add_u32 v44, s65, v3
  v_add_u32 v45, 4294868992, v44
  v_min_u32 v4, v44, v45
  s_waitcnt vmcnt(6)
  s_barrier
  buffer_load_dwordx4 v[68:71], v4, s[8:11], s58 offen offset:0 nt
  v_mfma_f32_16x16x32_bf16 v[28:31], v[16:19], v[72:75], v[28:31]
  v_and_b32 v14, 0xffff0000, v36
  v_cmp_lt_f32 vcc, s60, v14
  s_cbranch_vccz L_nr_628
  s_call_b64 s[52:53], L_rescale
L_nr_628:
  v_subrev_f32 v14, s60, v14
  v_mul_f32 v14, s85, v14
  v_exp_f32 v14, v14
  s_nop 0
  v_add_f32 v15, v15, v14
  v_cvt_pk_bf16_f32 v14, v14, v14
  s_nop 1
  v_mov_b32_dpp v13, v14 row_newbcast:1 row_mask:0xf bank_mask:0x3
  v_mov_b32_dpp v13, v14 row_newbcast:9 row_mask:0xf bank_mask:0xc
  v_and_b32 v16, v8, v13
  v_and_b32 v17, v9, v13
  v_and_b32 v18, v10, v13
  v_and_b32 v19, v11, v13
  s_nop 1
  s_waitcnt vmcnt(6)
  buffer_load_dwordx4 v[72:75], v4, s[8:11], s58 offen offset:128 nt
  v_mfma_f32_16x16x32_bf16 v[20:23], v[16:19], v[76:79], v[20:23]
  s_waitcnt vmcnt(6)
  buffer_load_dwordx4 v[76:79], v4, s[8:11], s58 offen offset:256 nt
  v_mfma_f32_16x16x32_bf16 v[24:27], v[16:19], v[48:51], v[24:27]
  v_readlane_b32 s64, v0, 13
  s_add_u32 s58, s91, 7569408
  s_bfe_u32 s65, s64, 0x3000c
  s_mulk_i32 s65, 12288
  v_add_u32 v44, s65, v3
  v_add_u32 v45, 4294868992, v44
  v_min_u32 v4, v44, v45
  s_waitcnt vmcnt(6)
  s_barrier
  buffer_load_dwordx4 v[48:51], v4, s[8:11], s58 offen offset:0 nt
  v_mfma_f32_16x16x32_bf16 v[28:31], v[16:19], v[52:55], v[28:31]
  v_mov_b32_dpp v13, v14 row_newbcast:0 row_mask:0xf bank_mask:0x3
  v_mov_b32_dpp v13, v14 row_newbcast:8 row_mask:0xf bank_mask:0xc
  v_and_b32 v16, v8, v13
  v_and_b32 v17, v9, v13
  v_and_b32 v18, v10, v13
  v_and_b32 v19, v11, v13
  s_nop 1
  v_mfma_f32_16x16x32_bf16 v[20:23], v[16:19], a[180:183], v[20:23]
  v_mfma_f32_16x16x32_bf16 v[24:27], v[16:19], a[184:187], v[24:27]
  v_mfma_f32_16x16x32_bf16 v[28:31], v[16:19], a[188:191], v[28:31]
  v_mov_b32_dpp v13, v14 row_newbcast:2 row_mask:0xf bank_mask:0x3
  v_mov_b32_dpp v13, v14 row_newbcast:10 row_mask:0xf bank_mask:0xc
  v_and_b32 v16, v8, v13
  v_and_b32 v17, v9, v13
  v_and_b32 v18, v10, v13
  v_and_b32 v19, v11, v13
  s_nop 1
  s_waitcnt vmcnt(6)
  buffer_load_dwordx4 v[52:55], v4, s[8:11], s58 offen offset:128 nt
  v_mfma_f32_16x16x32_bf16 v[20:23], v[16:19], v[56:59], v[20:23]
  s_waitcnt vmcnt(6)
  buffer_load_dwordx4 v[56:59], v4, s[8:11], s58 offen offset:256 nt
  v_mfma_f32_16x16x32_bf16 v[24:27], v[16:19], v[60:63], v[24:27]
  v_readlane_b32 s64, v0, 15
  s_add_u32 s58, s91, 7766016
  s_bfe_u32 s65, s64, 0x3000c
  s_mulk_i32 s65, 12288
  v_add_u32 v44, s65, v3
  v_add_u32 v45, 4294868992, v44
  v_min_u32 v4, v44, v45
  s_waitcnt vmcnt(6)
  s_barrier
  buffer_load_dwordx4 v[60:63], v4, s[8:11], s58 offen offset:0 nt
  v_mfma_f32_16x16x32_bf16 v[28:31], v[16:19], v[64:67], v[28:31]
  v_mov_b32_dpp v13, v14 row_newbcast:3 row_mask:0xf bank_mask:0x3
  v_mov_b32_dpp v13, v14 row_newbcast:11 row_mask:0xf bank_mask:0xc
  v_and_b32 v16, v8, v13
  v_and_b32 v17, v9, v13
  v_and_b32 v18, v10, v13
  v_and_b32 v19, v11, v13
  s_nop 1
  v_mfma_f32_16x16x32_bf16 v[20:23], v[16:19], a[192:195], v[20:23]
  v_mfma_f32_16x16x32_bf16 v[24:27], v[16:19], a[196:199], v[24:27]
  v_mfma_f32_16x16x32_bf16 v[28:31], v[16:19], a[200:203], v[28:31]
  v_mov_b32_dpp v13, v14 row_newbcast:4 row_mask:0xf bank_mask:0x3
  v_mov_b32_dpp v13, v14 row_newbcast:12 row_mask:0xf bank_mask:0xc
  v_and_b32 v16, v8, v13
  v_and_b32 v17, v9, v13
  v_and_b32 v18, v10, v13
  v_and_b32 v19, v11, v13
  s_nop 1
  s_waitcnt vmcnt(6)
  buffer_load_dwordx4 v[64:67], v4, s[8:11], s58 offen offset:128 nt
  v_mfma_f32_16x16x32_bf16 v[20:23], v[16:19], v[68:71], v[20:23]
  s_waitcnt vmcnt(6)
  buffer_load_dwordx4 v[68:71], v4, s[8:11], s58 offen offset:256 nt
  v_mfma_f32_16x16x32_bf16 v[24:27], v[16:19], v[72:75], v[24:27]
  v_readlane_b32 s64, v0, 17
  s_add_u32 s58, s93, 7962624
  s_bfe_u32 s65, s64, 0x3000c
  s_mulk_i32 s65, 12288
  v_add_u32 v44, s65, v3
  v_add_u32 v45, 4294868992, v44
  v_min_u32 v4, v44, v45
  s_waitcnt vmcnt(6)
  s_barrier
  buffer_load_dwordx4 v[72:75], v4, s[8:11], s58 offen offset:0 nt
  v_mfma_f32_16x16x32_bf16 v[28:31], v[16:19], v[76:79], v[28:31]
  v_mov_b32_dpp v13, v14 row_newbcast:5 row_mask:0xf bank_mask:0x3
  v_mov_b32_dpp v13, v14 row_newbcast:13 row_mask:0xf bank_mask:0xc
  v_and_b32 v16, v8, v13
  v_and_b32 v17, v9, v13
  v_and_b32 v18, v10, v13
  v_and_b32 v19, v11, v13
  s_nop 1
  s_waitcnt vmcnt(6)
  buffer_load_dwordx4 v[76:79], v4, s[8:11], s58 offen offset:128 nt
  v_mfma_f32_16x16x32_bf16 v[20:23], v[16:19], v[48:51], v[20:23]
  s_waitcnt vmcnt(6)
  buffer_load_dwordx4 v[48:51], v4, s[8:11], s58 offen offset:256 nt
  v_mfma_f32_16x16x32_bf16 v[24:27], v[16:19], v[52:55], v[24:27]
  v_readlane_b32 s64, v0, 18
  s_add_u32 s58, s93, 8060928
  s_bfe_u32 s65, s64, 0x3000c
  s_mulk_i32 s65, 12288
  v_add_u32 v44, s65, v3
  v_add_u32 v45, 4294868992, v44
  v_min_u32 v4, v44, v45
  s_waitcnt vmcnt(6)
  s_barrier
  buffer_load_dwordx4 v[52:55], v4, s[8:11], s58 offen offset:0 nt
  v_mfma_f32_16x16x32_bf16 v[28:31], v[16:19], v[56:59], v[28:31]
  v_mov_b32_dpp v13, v14 row_newbcast:6 row_mask:0xf bank_mask:0x3
  v_mov_b32_dpp v13, v14 row_newbcast:14 row_mask:0xf bank_mask:0xc
  v_and_b32 v16, v8, v13
  v_and_b32 v17, v9, v13
  v_and_b32 v18, v10, v13
  v_and_b32 v19, v11, v13
  s_nop 1
  v_mfma_f32_16x16x32_bf16 v[20:23], v[16:19], a[204:207], v[20:23]
  v_mfma_f32_16x16x32_bf16 v[24:27], v[16:19], a[208:211], v[24:27]
  v_mfma_f32_16x16x32_bf16 v[28:31], v[16:19], a[212:215], v[28:31]
  v_mov_b32_dpp v13, v14 row_newbcast:7 row_mask:0xf bank_mask:0x3
  v_mov_b32_dpp v13, v14 row_newbcast:15 row_mask:0xf bank_mask:0xc
  v_and_b32 v16, v8, v13
  v_and_b32 v17, v9, v13
  v_and_b32 v18, v10, v13
  v_and_b32 v19, v11, v13
  s_nop 1
  s_waitcnt vmcnt(6)
  buffer_load_dwordx4 v[56:59], v4, s[8:11], s58 offen offset:128 nt
  v_mfma_f32_16x16x32_bf16 v[20:23], v[16:19], v[60:63], v[20:23]
  s_waitcnt vmcnt(6)
  buffer_load_dwordx4 v[60:63], v4, s[8:11], s58 offen offset:256 nt
  v_mfma_f32_16x16x32_bf16 v[24:27], v[16:19], v[64:67], v[24:27]
  v_readlane_b32 s64, v0, 20
  s_add_u32 s58, s93, 8257536
  s_bfe_u32 s65, s64, 0x3000c
  s_mulk_i32 s65, 12288
  v_add_u32 v44, s65, v3
  v_add_u32 v45, 4294868992, v44
  v_min_u32 v4, v44, v45
  s_waitcnt vmcnt(6)
  s_barrier
  buffer_load_dwordx4 v[64:67], v4, s[8:11], s58 offen offset:0 nt
  v_mfma_f32_16x16x32_bf16 v[28:31], v[16:19], v[68:71], v[28:31]
  s_cmp_lg_u32 s95, 10
  s_cbranch_scc1 L_nf_629
  s_mov_b32 s78, 1
  s_call_b64 s[52:53], L_flush
L_nf_629:
  v_lshlrev_b32 v14, 16, v37
  v_cmp_lt_f32 vcc, s60, v14
  s_cbranch_vccz L_nr_630
  s_call_b64 s[52:53], L_rescale
L_nr_630:
  v_subrev_f32 v14, s60, v14
  v_mul_f32 v14, s85, v14
  v_exp_f32 v14, v14
  s_nop 0
  v_add_f32 v15, v15, v14
  v_cvt_pk_bf16_f32 v14, v14, v14
  s_nop 1
  v_mov_b32_dpp v13, v14 row_newbcast:1 row_mask:0xf bank_mask:0x3
  v_mov_b32_dpp v13, v14 row_newbcast:9 row_mask:0xf bank_mask:0xc
  v_and_b32 v16, v8, v13
  v_and_b32 v17, v9, v13
  v_and_b32 v18, v10, v13
  v_and_b32 v19, v11, v13
  s_nop 1
  s_waitcnt vmcnt(6)
  buffer_load_dwordx4 v[68:71], v4, s[8:11], s58 offen offset:128 nt
  v_mfma_f32_16x16x32_bf16 v[20:23], v[16:19], v[72:75], v[20:23]
  s_waitcnt vmcnt(6)
  buffer_load_dwordx4 v[72:75], v4, s[8:11], s58 offen offset:256 nt
  v_mfma_f32_16x16x32_bf16 v[24:27], v[16:19], v[76:79], v[24:27]
  v_readlane_b32 s64, v0, 21
  s_add_u32 s58, s93, 8355840
  s_bfe_u32 s65, s64, 0x3000c
  s_mulk_i32 s65, 12288
  v_add_u32 v44, s65, v3
  v_add_u32 v45, 4294868992, v44
  v_min_u32 v4, v44, v45
  s_waitcnt vmcnt(6)
  s_barrier
  buffer_load_dwordx4 v[76:79], v4, s[8:11], s58 offen offset:0 nt
  v_mfma_f32_16x16x32_bf16 v[28:31], v[16:19], v[48:51], v[28:31]
  v_mov_b32_dpp v13, v14 row_newbcast:0 row_mask:0xf bank_mask:0x3
  v_mov_b32_dpp v13, v14 row_newbcast:8 row_mask:0xf bank_mask:0xc
  v_and_b32 v16, v8, v13
  v_and_b32 v17, v9, v13
  v_and_b32 v18, v10, v13
  v_and_b32 v19, v11, v13
  s_nop 1
  v_mfma_f32_16x16x32_bf16 v[20:23], v[16:19], a[216:219], v[20:23]
  v_mfma_f32_16x16x32_bf16 v[24:27], v[16:19], a[220:223], v[24:27]
  v_mfma_f32_16x16x32_bf16 v[28:31], v[16:19], a[224:227], v[28:31]
  v_mov_b32_dpp v13, v14 row_newbcast:2 row_mask:0xf bank_mask:0x3
  v_mov_b32_dpp v13, v14 row_newbcast:10 row_mask:0xf bank_mask:0xc
  v_and_b32 v16, v8, v13
  v_and_b32 v17, v9, v13
  v_and_b32 v18, v10, v13
  v_and_b32 v19, v11, v13
  s_nop 1
  s_waitcnt vmcnt(6)
  buffer_load_dwordx4 v[48:51], v4, s[8:11], s58 offen offset:128 nt
  v_mfma_f32_16x16x32_bf16 v[20:23], v[16:19], v[52:55], v[20:23]
  s_waitcnt vmcnt(6)
  buffer_load_dwordx4 v[52:55], v4, s[8:11], s58 offen offset:256 nt
  v_mfma_f32_16x16x32_bf16 v[24:27], v[16:19], v[56:59], v[24:27]
  v_readlane_b32 s64, v0, 23
  s_add_u32 s58, s93, 8552448
  s_bfe_u32 s65, s64, 0x3000c
  s_mulk_i32 s65, 12288
  v_add_u32 v44, s65, v3
  v_add_u32 v45, 4294868992, v44
  v_min_u32 v4, v44, v45
  s_waitcnt vmcnt(6)
  s_barrier
  buffer_load_dwordx4 v[56:59], v4, s[8:11], s58 offen offset:0 nt
  v_mfma_f32_16x16x32_bf16 v[28:31], v[16:19], v[60:63], v[28:31]
  v_mov_b32_dpp v13, v14 row_newbcast:3 row_mask:0xf bank_mask:0x3
  v_mov_b32_dpp v13, v14 row_newbcast:11 row_mask:0xf bank_mask:0xc
  v_and_b32 v16, v8, v13
  v_and_b32 v17, v9, v13
  v_and_b32 v18, v10, v13
  v_and_b32 v19, v11, v13
  s_nop 1
  v_mfma_f32_16x16x32_bf16 v[20:23], v[16:19], a[228:231], v[20:23]
  v_mfma_f32_16x16x32_bf16 v[24:27], v[16:19], a[232:235], v[24:27]
  v_mfma_f32_16x16x32_bf16 v[28:31], v[16:19], a[236:239], v[28:31]
  v_mov_b32_dpp v13, v14 row_newbcast:4 row_mask:0xf bank_mask:0x3
  v_mov_b32_dpp v13, v14 row_newbcast:12 row_mask:0xf bank_mask:0xc
  v_and_b32 v16, v8, v13
  v_and_b32 v17, v9, v13
  v_and_b32 v18, v10, v13
  v_and_b32 v19, v11, v13
  s_nop 1
  s_waitcnt vmcnt(6)
  buffer_load_dwordx4 v[60:63], v4, s[8:11], s58 offen offset:128 nt
  v_mfma_f32_16x16x32_bf16 v[20:23], v[16:19], v[64:67], v[20:23]
  s_waitcnt vmcnt(6)
  buffer_load_dwordx4 v[64:67], v4, s[8:11], s58 offen offset:256 nt
  v_mfma_f32_16x16x32_bf16 v[24:27], v[16:19], v[68:71], v[24:27]
  v_readlane_b32 s64, v0, 25
  s_add_u32 s58, s92, 8749056
  s_bfe_u32 s65, s64, 0x3000c
  s_mulk_i32 s65, 12288
  v_add_u32 v44, s65, v3
  v_add_u32 v45, 4294868992, v44
  v_min_u32 v4, v44, v45
  s_waitcnt vmcnt(6)
  s_barrier
  buffer_load_dwordx4 v[68:71], v4, s[8:11], s58 offen offset:0 nt
  v_mfma_f32_16x16x32_bf16 v[28:31], v[16:19], v[72:75], v[28:31]
  v_mov_b32_dpp v13, v14 row_newbcast:5 row_mask:0xf bank_mask:0x3
  v_mov_b32_dpp v13, v14 row_newbcast:13 row_mask:0xf bank_mask:0xc
  v_and_b32 v16, v8, v13
  v_and_b32 v17, v9, v13
  v_and_b32 v18, v10, v13
  v_and_b32 v19, v11, v13
  s_nop 1
  s_waitcnt vmcnt(6)
  buffer_load_dwordx4 v[72:75], v4, s[8:11], s58 offen offset:128 nt
  v_mfma_f32_16x16x32_bf16 v[20:23], v[16:19], v[76:79], v[20:23]
  s_waitcnt vmcnt(6)
  buffer_load_dwordx4 v[76:79], v4, s[8:11], s58 offen offset:256 nt
  v_mfma_f32_16x16x32_bf16 v[24:27], v[16:19], v[48:51], v[24:27]
  v_readlane_b32 s64, v0, 26
  s_add_u32 s58, s92, 8847360
  s_bfe_u32 s65, s64, 0x3000c
  s_mulk_i32 s65, 12288
  v_add_u32 v44, s65, v3
  v_add_u32 v45, 4294868992, v44
  v_min_u32 v4, v44, v45
  s_waitcnt vmcnt(6)
  s_barrier
  buffer_load_dwordx4 v[48:51], v4, s[8:11], s58 offen offset:0 nt
  v_mfma_f32_16x16x32_bf16 v[28:31], v[16:19], v[52:55], v[28:31]
  v_mov_b32_dpp v13, v14 row_newbcast:6 row_mask:0xf bank_mask:0x3
  v_mov_b32_dpp v13, v14 row_newbcast:14 row_mask:0xf bank_mask:0xc
  v_and_b32 v16, v8, v13
  v_and_b32 v17, v9, v13
  v_and_b32 v18, v10, v13
  v_and_b32 v19, v11, v13
  s_nop 1
  v_mfma_f32_16x16x32_bf16 v[20:23], v[16:19], a[240:243], v[20:23]
  v_mfma_f32_16x16x32_bf16 v[24:27], v[16:19], a[244:247], v[24:27]
  v_mfma_f32_16x16x32_bf16 v[28:31], v[16:19], a[248:251], v[28:31]
  v_mov_b32_dpp v13, v14 row_newbcast:7 row_mask:0xf bank_mask:0x3
  v_mov_b32_dpp v13, v14 row_newbcast:15 row_mask:0xf bank_mask:0xc
  v_and_b32 v16, v8, v13
  v_and_b32 v17, v9, v13
  v_and_b32 v18, v10, v13
  v_and_b32 v19, v11, v13
  s_nop 1
  s_waitcnt vmcnt(6)
  buffer_load_dwordx4 v[52:55], v4, s[8:11], s58 offen offset:128 nt
  v_mfma_f32_16x16x32_bf16 v[20:23], v[16:19], v[56:59], v[20:23]
  s_waitcnt vmcnt(6)
  buffer_load_dwordx4 v[56:59], v4, s[8:11], s58 offen offset:256 nt
  v_mfma_f32_16x16x32_bf16 v[24:27], v[16:19], v[60:63], v[24:27]
  v_readlane_b32 s64, v0, 28
  s_add_u32 s58, s92, 9043968
  s_bfe_u32 s65, s64, 0x3000c
  s_mulk_i32 s65, 12288
  v_add_u32 v44, s65, v3
  v_add_u32 v45, 4294868992, v44
  v_min_u32 v4, v44, v45
  s_waitcnt vmcnt(6)
  s_barrier
  buffer_load_dwordx4 v[60:63], v4, s[8:11], s58 offen offset:0 nt
  v_mfma_f32_16x16x32_bf16 v[28:31], v[16:19], v[64:67], v[28:31]
  s_cmp_lg_u32 s95, 11
  s_cbranch_scc1 L_nf_631
  s_mov_b32 s78, 1
  s_call_b64 s[52:53], L_flush
L_nf_631:
  v_and_b32 v14, 0xffff0000, v37
  v_cmp_lt_f32 vcc, s60, v14
  s_cbranch_vccz L_nr_632
  s_call_b64 s[52:53], L_rescale
L_nr_632:
  v_subrev_f32 v14, s60, v14
  v_mul_f32 v14, s85, v14
  v_exp_f32 v14, v14
  s_nop 0
  v_add_f32 v15, v15, v14
  v_cvt_pk_bf16_f32 v14, v14, v14
  s_nop 1
  v_mov_b32_dpp v13, v14 row_newbcast:1 row_mask:0xf bank_mask:0x3
  v_mov_b32_dpp v13, v14 row_newbcast:9 row_mask:0xf bank_mask:0xc
  v_and_b32 v16, v8, v13
  v_and_b32 v17, v9, v13
  v_and_b32 v18, v10, v13
  v_and_b32 v19, v11, v13
  s_nop 1
  s_waitcnt vmcnt(6)
  buffer_load_dwordx4 v[64:67], v4, s[8:11], s58 offen offset:128 nt
  v_mfma_f32_16x16x32_bf16 v[20:23], v[16:19], v[68:71], v[20:23]
  s_waitcnt vmcnt(6)
  buffer_load_dwordx4 v[68:71], v4, s[8:11], s58 offen offset:256 nt
  v_mfma_f32_16x16x32_bf16 v[24:27], v[16:19], v[72:75], v[24:27]
  v_readlane_b32 s64, v0, 29
  s_add_u32 s58, s92, 9142272
  s_bfe_u32 s65, s64, 0x3000c
  s_mulk_i32 s65, 12288
  v_add_u32 v44, s65, v3
  v_add_u32 v45, 4294868992, v44
  v_min_u32 v4, v44, v45
  s_waitcnt vmcnt(6)
  s_barrier
  buffer_load_dwordx4 v[72:75], v4, s[8:11], s58 offen offset:0 nt
  v_mfma_f32_16x16x32_bf16 v[28:31], v[16:19], v[76:79], v[28:31]
  v_mov_b32_dpp v13, v14 row_newbcast:0 row_mask:0xf bank_mask:0x3
  v_mov_b32_dpp v13, v14 row_newbcast:8 row_mask:0xf bank_mask:0xc
  v_and_b32 v16, v8, v13
  v_and_b32 v17, v9, v13
  v_and_b32 v18, v10, v13
  v_and_b32 v19, v11, v13
  s_nop 1
  v_mfma_f32_16x16x32_bf16 v[20:23], v[16:19], a[252:255], v[20:23]
  v_mfma_f32_16x16x32_bf16 v[24:27], v[16:19], v[92:95], v[24:27]
  v_mfma_f32_16x16x32_bf16 v[28:31], v[16:19], v[96:99], v[28:31]
  v_mov_b32_dpp v13, v14 row_newbcast:2 row_mask:0xf bank_mask:0x3
  v_mov_b32_dpp v13, v14 row_newbcast:10 row_mask:0xf bank_mask:0xc
  v_and_b32 v16, v8, v13
  v_and_b32 v17, v9, v13
  v_and_b32 v18, v10, v13
  v_and_b32 v19, v11, v13
  s_nop 1
  s_waitcnt vmcnt(6)
  buffer_load_dwordx4 v[76:79], v4, s[8:11], s58 offen offset:128 nt
  v_mfma_f32_16x16x32_bf16 v[20:23], v[16:19], v[48:51], v[20:23]
  s_waitcnt vmcnt(6)
  buffer_load_dwordx4 v[48:51], v4, s[8:11], s58 offen offset:256 nt
  v_mfma_f32_16x16x32_bf16 v[24:27], v[16:19], v[52:55], v[24:27]
  v_readlane_b32 s64, v0, 31
  s_add_u32 s58, s92, 9338880
  s_bfe_u32 s65, s64, 0x3000c
  s_mulk_i32 s65, 12288
  v_add_u32 v44, s65, v3
  v_add_u32 v45, 4294868992, v44
  v_min_u32 v4, v44, v45
  s_waitcnt vmcnt(6)
  s_barrier
  buffer_load_dwordx4 v[52:55], v4, s[8:11], s58 offen offset:0 nt
  v_mfma_f32_16x16x32_bf16 v[28:31], v[16:19], v[56:59], v[28:31]
  v_mov_b32_dpp v13, v14 row_newbcast:3 row_mask:0xf bank_mask:0x3
  v_mov_b32_dpp v13, v14 row_newbcast:11 row_mask:0xf bank_mask:0xc
  v_and_b32 v16, v8, v13
  v_and_b32 v17, v9, v13
  v_and_b32 v18, v10, v13
  v_and_b32 v19, v11, v13
  s_nop 1
  v_mfma_f32_16x16x32_bf16 v[20:23], v[16:19], v[100:103], v[20:23]
  v_mfma_f32_16x16x32_bf16 v[24:27], v[16:19], v[104:107], v[24:27]
  v_mfma_f32_16x16x32_bf16 v[28:31], v[16:19], v[108:111], v[28:31]
  v_mov_b32_dpp v13, v14 row_newbcast:4 row_mask:0xf bank_mask:0x3
  v_mov_b32_dpp v13, v14 row_newbcast:12 row_mask:0xf bank_mask:0xc
  v_and_b32 v16, v8, v13
  v_and_b32 v17, v9, v13
  v_and_b32 v18, v10, v13
  v_and_b32 v19, v11, v13
  s_nop 1
  s_waitcnt vmcnt(6)
  buffer_load_dwordx4 v[56:59], v4, s[8:11], s58 offen offset:128 nt
  v_mfma_f32_16x16x32_bf16 v[20:23], v[16:19], v[60:63], v[20:23]
  s_waitcnt vmcnt(6)
  buffer_load_dwordx4 v[60:63], v4, s[8:11], s58 offen offset:256 nt
  v_mfma_f32_16x16x32_bf16 v[24:27], v[16:19], v[64:67], v[24:27]
  v_readlane_b32 s64, v0, 33
  s_add_u32 s58, s92, 9535488
  s_bfe_u32 s65, s64, 0x3000c
  s_mulk_i32 s65, 12288
  v_add_u32 v44, s65, v3
  v_add_u32 v45, 4294868992, v44
  v_min_u32 v4, v44, v45
  s_waitcnt vmcnt(6)
  s_barrier
  buffer_load_dwordx4 v[64:67], v4, s[8:11], s58 offen offset:0 nt
  v_mfma_f32_16x16x32_bf16 v[28:31], v[16:19], v[68:71], v[28:31]
  v_mov_b32_dpp v13, v14 row_newbcast:5 row_mask:0xf bank_mask:0x3
  v_mov_b32_dpp v13, v14 row_newbcast:13 row_mask:0xf bank_mask:0xc
  v_and_b32 v16, v8, v13
  v_and_b32 v17, v9, v13
  v_and_b32 v18, v10, v13
  v_and_b32 v19, v11, v13
  s_nop 1
  s_waitcnt vmcnt(6)
  buffer_load_dwordx4 v[68:71], v4, s[8:11], s58 offen offset:128 nt
  v_mfma_f32_16x16x32_bf16 v[20:23], v[16:19], v[72:75], v[20:23]
  s_waitcnt vmcnt(6)
  buffer_load_dwordx4 v[72:75], v4, s[8:11], s58 offen offset:256 nt
  v_mfma_f32_16x16x32_bf16 v[24:27], v[16:19], v[76:79], v[24:27]
  v_readlane_b32 s64, v0, 34
  s_add_u32 s58, s92, 9633792
  s_bfe_u32 s65, s64, 0x3000c
  s_mulk_i32 s65, 12288
  v_add_u32 v44, s65, v3
  v_add_u32 v45, 4294868992, v44
  v_min_u32 v4, v44, v45
  s_waitcnt vmcnt(6)
  s_barrier
  buffer_load_dwordx4 v[76:79], v4, s[8:11], s58 offen offset:0 nt
  v_mfma_f32_16x16x32_bf16 v[28:31], v[16:19], v[48:51], v[28:31]
  v_mov_b32_dpp v13, v14 row_newbcast:6 row_mask:0xf bank_mask:0x3
  v_mov_b32_dpp v13, v14 row_newbcast:14 row_mask:0xf bank_mask:0xc
  v_and_b32 v16, v8, v13
  v_and_b32 v17, v9, v13
  v_and_b32 v18, v10, v13
  v_and_b32 v19, v11, v13
  s_nop 1
  v_mfma_f32_16x16x32_bf16 v[20:23], v[16:19], v[112:115], v[20:23]
  v_mfma_f32_16x16x32_bf16 v[24:27], v[16:19], v[116:119], v[24:27]
  v_mfma_f32_16x16x32_bf16 v[28:31], v[16:19], v[120:123], v[28:31]
  v_mov_b32_dpp v13, v14 row_newbcast:7 row_mask:0xf bank_mask:0x3
  v_mov_b32_dpp v13, v14 row_newbcast:15 row_mask:0xf bank_mask:0xc
  v_and_b32 v16, v8, v13
  v_and_b32 v17, v9, v13
  v_and_b32 v18, v10, v13
  v_and_b32 v19, v11, v13
  s_nop 1
  s_waitcnt vmcnt(6)
  buffer_load_dwordx4 v[48:51], v4, s[8:11], s58 offen offset:128 nt
  v_mfma_f32_16x16x32_bf16 v[20:23], v[16:19], v[52:55], v[20:23]
  s_waitcnt vmcnt(6)
  buffer_load_dwordx4 v[52:55], v4, s[8:11], s58 offen offset:256 nt
  v_mfma_f32_16x16x32_bf16 v[24:27], v[16:19], v[56:59], v[24:27]
  v_readlane_b32 s64, v0, 36
  s_add_u32 s58, s92, 9830400
  s_bfe_u32 s65, s64, 0x3000c
  s_mulk_i32 s65, 12288
  v_add_u32 v44, s65, v3
  v_add_u32 v45, 4294868992, v44
  v_min_u32 v4, v44, v45
  s_waitcnt vmcnt(6)
  s_barrier
  buffer_load_dwordx4 v[56:59], v4, s[8:11], s58 offen offset:0 nt
  v_mfma_f32_16x16x32_bf16 v[28:31], v[16:19], v[60:63], v[28:31]
  v_lshlrev_b32 v14, 16, v38
  v_cmp_lt_f32 vcc, s60, v14
  s_cbranch_vccz L_nr_633
  s_call_b64 s[52:53], L_rescale
L_nr_633:
  v_subrev_f32 v14, s60, v14
  v_mul_f32 v14, s85, v14
  v_exp_f32 v14, v14
  s_nop 0
  v_add_f32 v15, v15, v14
  v_cvt_pk_bf16_f32 v14, v14, v14
  s_nop 1
  v_mov_b32_dpp v13, v14 row_newbcast:1 row_mask:0xf bank_mask:0x3
  v_mov_b32_dpp v13, v14 row_newbcast:9 row_mask:0xf bank_mask:0xc
  v_and_b32 v16, v8, v13
  v_and_b32 v17, v9, v13
  v_and_b32 v18, v10, v13
  v_and_b32 v19, v11, v13
  s_nop 1
  s_waitcnt vmcnt(6)
  buffer_load_dwordx4 v[60:63], v4, s[8:11], s58 offen offset:128 nt
  v_mfma_f32_16x16x32_bf16 v[20:23], v[16:19], v[64:67], v[20:23]
  s_waitcnt vmcnt(6)
  buffer_load_dwordx4 v[64:67], v4, s[8:11], s58 offen offset:256 nt
  v_mfma_f32_16x16x32_bf16 v[24:27], v[16:19], v[68:71], v[24:27]
  v_readlane_b32 s64, v0, 37
  s_add_u32 s58, s92, 9928704
  s_bfe_u32 s65, s64, 0x3000c
  s_mulk_i32 s65, 12288
  v_add_u32 v44, s65, v3
  v_add_u32 v45, 4294868992, v44
  v_min_u32 v4, v44, v45
  s_waitcnt vmcnt(6)
  s_barrier
  buffer_load_dwordx4 v[68:71], v4, s[8:11], s58 offen offset:0 nt
  v_mfma_f32_16x16x32_bf16 v[28:31], v[16:19], v[72:75], v[28:31]
  v_mov_b32_dpp v13, v14 row_newbcast:0 row_mask:0xf bank_mask:0x3
  v_mov_b32_dpp v13, v14 row_newbcast:8 row_mask:0xf bank_mask:0xc
  v_and_b32 v16, v8, v13
  v_and_b32 v17, v9, v13
  v_and_b32 v18, v10, v13
  v_and_b32 v19, v11, v13
  s_nop 1
  v_mfma_f32_16x16x32_bf16 v[20:23], v[16:19], v[124:127], v[20:23]
  v_mfma_f32_16x16x32_bf16 v[24:27], v[16:19], v[128:131], v[24:27]
  v_mfma_f32_16x16x32_bf16 v[28:31], v[16:19], v[132:135], v[28:31]
  v_mov_b32_dpp v13, v14 row_newbcast:2 row_mask:0xf bank_mask:0x3
  v_mov_b32_dpp v13, v14 row_newbcast:10 row_mask:0xf bank_mask:0xc
  v_and_b32 v16, v8, v13
  v_and_b32 v17, v9, v13
  v_and_b32 v18, v10, v13
  v_and_b32 v19, v11, v13
  s_nop 1
  s_waitcnt vmcnt(6)
  buffer_load_dwordx4 v[72:75], v4, s[8:11], s58 offen offset:128 nt
  v_mfma_f32_16x16x32_bf16 v[20:23], v[16:19], v[76:79], v[20:23]
  s_waitcnt vmcnt(6)
  buffer_load_dwordx4 v[76:79], v4, s[8:11], s58 offen offset:256 nt
  v_mfma_f32_16x16x32_bf16 v[24:27], v[16:19], v[48:51], v[24:27]
  v_readlane_b32 s64, v0, 39
  s_add_u32 s58, s92, 10125312
  s_bfe_u32 s65, s64, 0x3000c
  s_mulk_i32 s65, 12288
  v_add_u32 v44, s65, v3
  v_add_u32 v45, 4294868992, v44
  v_min_u32 v4, v44, v45
  s_waitcnt vmcnt(6)
  s_barrier
  buffer_load_dwordx4 v[48:51], v4, s[8:11], s58 offen offset:0 nt
  v_mfma_f32_16x16x32_bf16 v[28:31], v[16:19], v[52:55], v[28:31]
  v_mov_b32_dpp v13, v14 row_newbcast:3 row_mask:0xf bank_mask:0x3
  v_mov_b32_dpp v13, v14 row_newbcast:11 row_mask:0xf bank_mask:0xc
  v_and_b32 v16, v8, v13
  v_and_b32 v17, v9, v13
  v_and_b32 v18, v10, v13
  v_and_b32 v19, v11, v13
  s_nop 1
  v_mfma_f32_16x16x32_bf16 v[20:23], v[16:19], v[136:139], v[20:23]
  v_mfma_f32_16x16x32_bf16 v[24:27], v[16:19], v[140:143], v[24:27]
  v_mfma_f32_16x16x32_bf16 v[28:31], v[16:19], v[144:147], v[28:31]
  v_mov_b32_dpp v13, v14 row_newbcast:4 row_mask:0xf bank_mask:0x3
  v_mov_b32_dpp v13, v14 row_newbcast:12 row_mask:0xf bank_mask:0xc
  v_and_b32 v16, v8, v13
  v_and_b32 v17, v9, v13
  v_and_b32 v18, v10, v13
  v_and_b32 v19, v11, v13
  s_nop 1
  s_waitcnt vmcnt(6)
  buffer_load_dwordx4 v[52:55], v4, s[8:11], s58 offen offset:128 nt
  v_mfma_f32_16x16x32_bf16 v[20:23], v[16:19], v[56:59], v[20:23]
  s_waitcnt vmcnt(6)
  buffer_load_dwordx4 v[56:59], v4, s[8:11], s58 offen offset:256 nt
  v_mfma_f32_16x16x32_bf16 v[24:27], v[16:19], v[60:63], v[24:27]
  v_readlane_b32 s64, v0, 41
  s_add_u32 s58, s92, 10321920
  s_bfe_u32 s65, s64, 0x3000c
  s_mulk_i32 s65, 12288
  v_add_u32 v44, s65, v3
  v_add_u32 v45, 4294868992, v44
  v_min_u32 v4, v44, v45
  s_waitcnt vmcnt(6)
  s_barrier
  buffer_load_dwordx4 v[60:63], v4, s[8:11], s58 offen offset:0 nt
  v_mfma_f32_16x16x32_bf16 v[28:31], v[16:19], v[64:67], v[28:31]
  v_mov_b32_dpp v13, v14 row_newbcast:5 row_mask:0xf bank_mask:0x3
  v_mov_b32_dpp v13, v14 row_newbcast:13 row_mask:0xf bank_mask:0xc
  v_and_b32 v16, v8, v13
  v_and_b32 v17, v9, v13
  v_and_b32 v18, v10, v13
  v_and_b32 v19, v11, v13
  s_nop 1
  s_waitcnt vmcnt(6)
  buffer_load_dwordx4 v[64:67], v4, s[8:11], s58 offen offset:128 nt
  v_mfma_f32_16x16x32_bf16 v[20:23], v[16:19], v[68:71], v[20:23]
  s_waitcnt vmcnt(6)
  buffer_load_dwordx4 v[68:71], v4, s[8:11], s58 offen offset:256 nt
  v_mfma_f32_16x16x32_bf16 v[24:27], v[16:19], v[72:75], v[24:27]
  v_readlane_b32 s64, v0, 42
  s_add_u32 s58, s92, 10420224
  s_bfe_u32 s65, s64, 0x3000c
  s_mulk_i32 s65, 12288
  v_add_u32 v44, s65, v3
  v_add_u32 v45, 4294868992, v44
  v_min_u32 v4, v44, v45
  s_waitcnt vmcnt(6)
  s_barrier
  buffer_load_dwordx4 v[72:75], v4, s[8:11], s58 offen offset:0 nt
  v_mfma_f32_16x16x32_bf16 v[28:31], v[16:19], v[76:79], v[28:31]
  v_mov_b32_dpp v13, v14 row_newbcast:6 row_mask:0xf bank_mask:0x3
  v_mov_b32_dpp v13, v14 row_newbcast:14 row_mask:0xf bank_mask:0xc
  v_and_b32 v16, v8, v13
  v_and_b32 v17, v9, v13
  v_and_b32 v18, v10, v13
  v_and_b32 v19, v11, v13
  s_nop 1
  v_mfma_f32_16x16x32_bf16 v[20:23], v[16:19], v[148:151], v[20:23]
  v_mfma_f32_16x16x32_bf16 v[24:27], v[16:19], v[152:155], v[24:27]
  v_mfma_f32_16x16x32_bf16 v[28:31], v[16:19], v[156:159], v[28:31]
  v_mov_b32_dpp v13, v14 row_newbcast:7 row_mask:0xf bank_mask:0x3
  v_mov_b32_dpp v13, v14 row_newbcast:15 row_mask:0xf bank_mask:0xc
  v_and_b32 v16, v8, v13
  v_and_b32 v17, v9, v13
  v_and_b32 v18, v10, v13
  v_and_b32 v19, v11, v13
  s_nop 1
  s_waitcnt vmcnt(6)
  buffer_load_dwordx4 v[76:79], v4, s[8:11], s58 offen offset:128 nt
  v_mfma_f32_16x16x32_bf16 v[20:23], v[16:19], v[48:51], v[20:23]
  s_waitcnt vmcnt(6)
  buffer_load_dwordx4 v[48:51], v4, s[8:11], s58 offen offset:256 nt
  v_mfma_f32_16x16x32_bf16 v[24:27], v[16:19], v[52:55], v[24:27]
  v_readlane_b32 s64, v0, 44
  s_add_u32 s58, s92, 10616832
  s_bfe_u32 s65, s64, 0x3000c
  s_mulk_i32 s65, 12288
  v_add_u32 v44, s65, v3
  v_add_u32 v45, 4294868992, v44
  v_min_u32 v4, v44, v45
  s_waitcnt vmcnt(6)
  s_barrier
  buffer_load_dwordx4 v[52:55], v4, s[8:11], s58 offen offset:0 nt
  v_mfma_f32_16x16x32_bf16 v[28:31], v[16:19], v[56:59], v[28:31]
  v_and_b32 v14, 0xffff0000, v38
  v_cmp_lt_f32 vcc, s60, v14
  s_cbranch_vccz L_nr_634
  s_call_b64 s[52:53], L_rescale
L_nr_634:
  v_subrev_f32 v14, s60, v14
  v_mul_f32 v14, s85, v14
  v_exp_f32 v14, v14
  s_nop 0
  v_add_f32 v15, v15, v14
  v_cvt_pk_bf16_f32 v14, v14, v14
  s_nop 1
  v_mov_b32_dpp v13, v14 row_newbcast:1 row_mask:0xf bank_mask:0x3
  v_mov_b32_dpp v13, v14 row_newbcast:9 row_mask:0xf bank_mask:0xc
  v_and_b32 v16, v8, v13
  v_and_b32 v17, v9, v13
  v_and_b32 v18, v10, v13
  v_and_b32 v19, v11, v13
  s_nop 1
  s_waitcnt vmcnt(6)
  buffer_load_dwordx4 v[56:59], v4, s[8:11], s58 offen offset:128 nt
  v_mfma_f32_16x16x32_bf16 v[20:23], v[16:19], v[60:63], v[20:23]
  s_waitcnt vmcnt(6)
  buffer_load_dwordx4 v[60:63], v4, s[8:11], s58 offen offset:256 nt
  v_mfma_f32_16x16x32_bf16 v[24:27], v[16:19], v[64:67], v[24:27]
  v_readlane_b32 s64, v0, 45
  s_add_u32 s58, s92, 10715136
  s_bfe_u32 s65, s64, 0x3000c
  s_mulk_i32 s65, 12288
  v_add_u32 v44, s65, v3
  v_add_u32 v45, 4294868992, v44
  v_min_u32 v4, v44, v45
  s_waitcnt vmcnt(6)
  s_barrier
  buffer_load_dwordx4 v[64:67], v4, s[8:11], s58 offen offset:0 nt
  v_mfma_f32_16x16x32_bf16 v[28:31], v[16:19], v[68:71], v[28:31]
  v_mov_b32_dpp v13, v14 row_newbcast:0 row_mask:0xf bank_mask:0x3
  v_mov_b32_dpp v13, v14 row_newbcast:8 row_mask:0xf bank_mask:0xc
  v_and_b32 v16, v8, v13
  v_and_b32 v17, v9, v13
  v_and_b32 v18, v10, v13
  v_and_b32 v19, v11, v13
  s_nop 1
  v_mfma_f32_16x16x32_bf16 v[20:23], v[16:19], v[160:163], v[20:23]
  v_mfma_f32_16x16x32_bf16 v[24:27], v[16:19], v[164:167], v[24:27]
  v_mfma_f32_16x16x32_bf16 v[28:31], v[16:19], v[168:171], v[28:31]
  v_mov_b32_dpp v13, v14 row_newbcast:2 row_mask:0xf bank_mask:0x3
  v_mov_b32_dpp v13, v14 row_newbcast:10 row_mask:0xf bank_mask:0xc
  v_and_b32 v16, v8, v13
  v_and_b32 v17, v9, v13
  v_and_b32 v18, v10, v13
  v_and_b32 v19, v11, v13
  s_nop 1
  s_waitcnt vmcnt(6)
  buffer_load_dwordx4 v[68:71], v4, s[8:11], s58 offen offset:128 nt
  v_mfma_f32_16x16x32_bf16 v[20:23], v[16:19], v[72:75], v[20:23]
  s_waitcnt vmcnt(6)
  buffer_load_dwordx4 v[72:75], v4, s[8:11], s58 offen offset:256 nt
  v_mfma_f32_16x16x32_bf16 v[24:27], v[16:19], v[76:79], v[24:27]
  v_readlane_b32 s64, v0, 47
  s_add_u32 s58, s92, 10911744
  s_bfe_u32 s65, s64, 0x3000c
  s_mulk_i32 s65, 12288
  v_add_u32 v44, s65, v3
  v_add_u32 v45, 4294868992, v44
  v_min_u32 v4, v44, v45
  s_waitcnt vmcnt(6)
  s_barrier
  buffer_load_dwordx4 v[76:79], v4, s[8:11], s58 offen offset:0 nt
  v_mfma_f32_16x16x32_bf16 v[28:31], v[16:19], v[48:51], v[28:31]
  v_mov_b32_dpp v13, v14 row_newbcast:3 row_mask:0xf bank_mask:0x3
  v_mov_b32_dpp v13, v14 row_newbcast:11 row_mask:0xf bank_mask:0xc
  v_and_b32 v16, v8, v13
  v_and_b32 v17, v9, v13
  v_and_b32 v18, v10, v13
  v_and_b32 v19, v11, v13
  s_nop 1
  v_mfma_f32_16x16x32_bf16 v[20:23], v[16:19], v[172:175], v[20:23]
  v_mfma_f32_16x16x32_bf16 v[24:27], v[16:19], v[176:179], v[24:27]
  v_mfma_f32_16x16x32_bf16 v[28:31], v[16:19], v[180:183], v[28:31]
  v_mov_b32_dpp v13, v14 row_newbcast:4 row_mask:0xf bank_mask:0x3
  v_mov_b32_dpp v13, v14 row_newbcast:12 row_mask:0xf bank_mask:0xc
  v_and_b32 v16, v8, v13
  v_and_b32 v17, v9, v13
  v_and_b32 v18, v10, v13
  v_and_b32 v19, v11, v13
  s_nop 1
  s_waitcnt vmcnt(6)
  buffer_load_dwordx4 v[48:51], v4, s[8:11], s58 offen offset:128 nt
  v_mfma_f32_16x16x32_bf16 v[20:23], v[16:19], v[52:55], v[20:23]
  s_waitcnt vmcnt(6)
  buffer_load_dwordx4 v[52:55], v4, s[8:11], s58 offen offset:256 nt
  v_mfma_f32_16x16x32_bf16 v[24:27], v[16:19], v[56:59], v[24:27]
  v_readlane_b32 s64, v0, 49
  s_add_u32 s58, s92, 11108352
  s_bfe_u32 s65, s64, 0x3000c
  s_mulk_i32 s65, 12288
  v_add_u32 v44, s65, v3
  v_add_u32 v45, 4294868992, v44
  v_min_u32 v4, v44, v45
  s_waitcnt vmcnt(6)
  s_barrier
  buffer_load_dwordx4 v[56:59], v4, s[8:11], s58 offen offset:0 nt
  v_mfma_f32_16x16x32_bf16 v[28:31], v[16:19], v[60:63], v[28:31]
  v_mov_b32_dpp v13, v14 row_newbcast:5 row_mask:0xf bank_mask:0x3
  v_mov_b32_dpp v13, v14 row_newbcast:13 row_mask:0xf bank_mask:0xc
  v_and_b32 v16, v8, v13
  v_and_b32 v17, v9, v13
  v_and_b32 v18, v10, v13
  v_and_b32 v19, v11, v13
  s_nop 1
  s_waitcnt vmcnt(6)
  buffer_load_dwordx4 v[60:63], v4, s[8:11], s58 offen offset:128 nt
  v_mfma_f32_16x16x32_bf16 v[20:23], v[16:19], v[64:67], v[20:23]
  s_waitcnt vmcnt(6)
  buffer_load_dwordx4 v[64:67], v4, s[8:11], s58 offen offset:256 nt
  v_mfma_f32_16x16x32_bf16 v[24:27], v[16:19], v[68:71], v[24:27]
  v_readlane_b32 s64, v0, 50
  s_add_u32 s58, s92, 11206656
  s_bfe_u32 s65, s64, 0x3000c
  s_mulk_i32 s65, 12288
  v_add_u32 v44, s65, v3
  v_add_u32 v45, 4294868992, v44
  v_min_u32 v4, v44, v45
  s_waitcnt vmcnt(6)
  s_barrier
  buffer_load_dwordx4 v[68:71], v4, s[8:11], s58 offen offset:0 nt
  v_mfma_f32_16x16x32_bf16 v[28:31], v[16:19], v[72:75], v[28:31]
  v_mov_b32_dpp v13, v14 row_newbcast:6 row_mask:0xf bank_mask:0x3
  v_mov_b32_dpp v13, v14 row_newbcast:14 row_mask:0xf bank_mask:0xc
  v_and_b32 v16, v8, v13
  v_and_b32 v17, v9, v13
  v_and_b32 v18, v10, v13
  v_and_b32 v19, v11, v13
  s_nop 1
  v_mfma_f32_16x16x32_bf16 v[20:23], v[16:19], v[184:187], v[20:23]
  v_mfma_f32_16x16x32_bf16 v[24:27], v[16:19], v[188:191], v[24:27]
  v_mfma_f32_16x16x32_bf16 v[28:31], v[16:19], v[192:195], v[28:31]
  v_mov_b32_dpp v13, v14 row_newbcast:7 row_mask:0xf bank_mask:0x3
  v_mov_b32_dpp v13, v14 row_newbcast:15 row_mask:0xf bank_mask:0xc
  v_and_b32 v16, v8, v13
  v_and_b32 v17, v9, v13
  v_and_b32 v18, v10, v13
  v_and_b32 v19, v11, v13
  s_nop 1
  s_waitcnt vmcnt(6)
  buffer_load_dwordx4 v[72:75], v4, s[8:11], s58 offen offset:128 nt
  v_mfma_f32_16x16x32_bf16 v[20:23], v[16:19], v[76:79], v[20:23]
  s_waitcnt vmcnt(6)
  buffer_load_dwordx4 v[76:79], v4, s[8:11], s58 offen offset:256 nt
  v_mfma_f32_16x16x32_bf16 v[24:27], v[16:19], v[48:51], v[24:27]
  v_readlane_b32 s64, v0, 52
  s_add_u32 s58, s92, 11403264
  s_bfe_u32 s65, s64, 0x3000c
  s_mulk_i32 s65, 12288
  v_add_u32 v44, s65, v3
  v_add_u32 v45, 4294868992, v44
  v_min_u32 v4, v44, v45
  s_waitcnt vmcnt(6)
  s_barrier
  buffer_load_dwordx4 v[48:51], v4, s[8:11], s58 offen offset:0 nt
  v_mfma_f32_16x16x32_bf16 v[28:31], v[16:19], v[52:55], v[28:31]
  v_lshlrev_b32 v14, 16, v39
  v_cmp_lt_f32 vcc, s60, v14
  s_cbranch_vccz L_nr_635
  s_call_b64 s[52:53], L_rescale
L_nr_635:
  v_subrev_f32 v14, s60, v14
  v_mul_f32 v14, s85, v14
  v_exp_f32 v14, v14
  s_nop 0
  v_add_f32 v15, v15, v14
  v_cvt_pk_bf16_f32 v14, v14, v14
  s_nop 1
  v_mov_b32_dpp v13, v14 row_newbcast:1 row_mask:0xf bank_mask:0x3
  v_mov_b32_dpp v13, v14 row_newbcast:9 row_mask:0xf bank_mask:0xc
  v_and_b32 v16, v8, v13
  v_and_b32 v17, v9, v13
  v_and_b32 v18, v10, v13
  v_and_b32 v19, v11, v13
  s_nop 1
  s_waitcnt vmcnt(6)
  buffer_load_dwordx4 v[52:55], v4, s[8:11], s58 offen offset:128 nt
  v_mfma_f32_16x16x32_bf16 v[20:23], v[16:19], v[56:59], v[20:23]
  s_waitcnt vmcnt(6)
  buffer_load_dwordx4 v[56:59], v4, s[8:11], s58 offen offset:256 nt
  v_mfma_f32_16x16x32_bf16 v[24:27], v[16:19], v[60:63], v[24:27]
  v_readlane_b32 s64, v0, 53
  s_add_u32 s58, s92, 11501568
  s_bfe_u32 s65, s64, 0x3000c
  s_mulk_i32 s65, 12288
  v_add_u32 v44, s65, v3
  v_add_u32 v45, 4294868992, v44
  v_min_u32 v4, v44, v45
  s_waitcnt vmcnt(6)
  s_barrier
  buffer_load_dwordx4 v[60:63], v4, s[8:11], s58 offen offset:0 nt
  v_mfma_f32_16x16x32_bf16 v[28:31], v[16:19], v[64:67], v[28:31]
  v_mov_b32_dpp v13, v14 row_newbcast:0 row_mask:0xf bank_mask:0x3
  v_mov_b32_dpp v13, v14 row_newbcast:8 row_mask:0xf bank_mask:0xc
  v_and_b32 v16, v8, v13
  v_and_b32 v17, v9, v13
  v_and_b32 v18, v10, v13
  v_and_b32 v19, v11, v13
  s_nop 1
  v_mfma_f32_16x16x32_bf16 v[20:23], v[16:19], v[196:199], v[20:23]
  v_mfma_f32_16x16x32_bf16 v[24:27], v[16:19], v[200:203], v[24:27]
  v_mfma_f32_16x16x32_bf16 v[28:31], v[16:19], v[204:207], v[28:31]
  v_mov_b32_dpp v13, v14 row_newbcast:2 row_mask:0xf bank_mask:0x3
  v_mov_b32_dpp v13, v14 row_newbcast:10 row_mask:0xf bank_mask:0xc
  v_and_b32 v16, v8, v13
  v_and_b32 v17, v9, v13
  v_and_b32 v18, v10, v13
  v_and_b32 v19, v11, v13
  s_nop 1
  s_waitcnt vmcnt(6)
  buffer_load_dwordx4 v[64:67], v4, s[8:11], s58 offen offset:128 nt
  v_mfma_f32_16x16x32_bf16 v[20:23], v[16:19], v[68:71], v[20:23]
  s_waitcnt vmcnt(6)
  buffer_load_dwordx4 v[68:71], v4, s[8:11], s58 offen offset:256 nt
  v_mfma_f32_16x16x32_bf16 v[24:27], v[16:19], v[72:75], v[24:27]
  v_readlane_b32 s64, v0, 55
  s_add_u32 s58, s92, 11698176
  s_bfe_u32 s65, s64, 0x3000c
  s_mulk_i32 s65, 12288
  v_add_u32 v44, s65, v3
  v_add_u32 v45, 4294868992, v44
  v_min_u32 v4, v44, v45
  s_waitcnt vmcnt(6)
  s_barrier
  buffer_load_dwordx4 v[72:75], v4, s[8:11], s58 offen offset:0 nt
  v_mfma_f32_16x16x32_bf16 v[28:31], v[16:19], v[76:79], v[28:31]
  v_mov_b32_dpp v13, v14 row_newbcast:3 row_mask:0xf bank_mask:0x3
  v_mov_b32_dpp v13, v14 row_newbcast:11 row_mask:0xf bank_mask:0xc
  v_and_b32 v16, v8, v13
  v_and_b32 v17, v9, v13
  v_and_b32 v18, v10, v13
  v_and_b32 v19, v11, v13
  s_nop 1
  v_mfma_f32_16x16x32_bf16 v[20:23], v[16:19], v[208:211], v[20:23]
  v_mfma_f32_16x16x32_bf16 v[24:27], v[16:19], v[212:215], v[24:27]
  v_mfma_f32_16x16x32_bf16 v[28:31], v[16:19], v[216:219], v[28:31]
  v_mov_b32_dpp v13, v14 row_newbcast:4 row_mask:0xf bank_mask:0x3
  v_mov_b32_dpp v13, v14 row_newbcast:12 row_mask:0xf bank_mask:0xc
  v_and_b32 v16, v8, v13
  v_and_b32 v17, v9, v13
  v_and_b32 v18, v10, v13
  v_and_b32 v19, v11, v13
  s_nop 1
  s_waitcnt vmcnt(6)
  buffer_load_dwordx4 v[76:79], v4, s[8:11], s58 offen offset:128 nt
  v_mfma_f32_16x16x32_bf16 v[20:23], v[16:19], v[48:51], v[20:23]
  s_waitcnt vmcnt(6)
  buffer_load_dwordx4 v[48:51], v4, s[8:11], s58 offen offset:256 nt
  v_mfma_f32_16x16x32_bf16 v[24:27], v[16:19], v[52:55], v[24:27]
  v_readlane_b32 s64, v0, 57
  s_add_u32 s58, s92, 11894784
  s_bfe_u32 s65, s64, 0x3000c
  s_mulk_i32 s65, 12288
  v_add_u32 v44, s65, v3
  v_add_u32 v45, 4294868992, v44
  v_min_u32 v4, v44, v45
  s_waitcnt vmcnt(6)
  s_barrier
  buffer_load_dwordx4 v[52:55], v4, s[8:11], s58 offen offset:0 nt
  v_mfma_f32_16x16x32_bf16 v[28:31], v[16:19], v[56:59], v[28:31]
  v_mov_b32_dpp v13, v14 row_newbcast:5 row_mask:0xf bank_mask:0x3
  v_mov_b32_dpp v13, v14 row_newbcast:13 row_mask:0xf bank_mask:0xc
  v_and_b32 v16, v8, v13
  v_and_b32 v17, v9, v13
  v_and_b32 v18, v10, v13
  v_and_b32 v19, v11, v13
  s_nop 1
  s_waitcnt vmcnt(6)
  buffer_load_dwordx4 v[56:59], v4, s[8:11], s58 offen offset:128 nt
  v_mfma_f32_16x16x32_bf16 v[20:23], v[16:19], v[60:63], v[20:23]
  s_waitcnt vmcnt(6)
  buffer_load_dwordx4 v[60:63], v4, s[8:11], s58 offen offset:256 nt
  v_mfma_f32_16x16x32_bf16 v[24:27], v[16:19], v[64:67], v[24:27]
  v_readlane_b32 s64, v0, 58
  s_add_u32 s58, s92, 11993088
  s_bfe_u32 s65, s64, 0x3000c
  s_mulk_i32 s65, 12288
  v_add_u32 v44, s65, v3
  v_add_u32 v45, 4294868992, v44
  v_min_u32 v4, v44, v45
  s_waitcnt vmcnt(6)
  s_barrier
  buffer_load_dwordx4 v[64:67], v4, s[8:11], s58 offen offset:0 nt
  v_mfma_f32_16x16x32_bf16 v[28:31], v[16:19], v[68:71], v[28:31]
  v_mov_b32_dpp v13, v14 row_newbcast:6 row_mask:0xf bank_mask:0x3
  v_mov_b32_dpp v13, v14 row_newbcast:14 row_mask:0xf bank_mask:0xc
  v_and_b32 v16, v8, v13
  v_and_b32 v17, v9, v13
  v_and_b32 v18, v10, v13
  v_and_b32 v19, v11, v13
  s_nop 1
  v_mfma_f32_16x16x32_bf16 v[20:23], v[16:19], v[220:223], v[20:23]
  v_mfma_f32_16x16x32_bf16 v[24:27], v[16:19], v[224:227], v[24:27]
  v_mfma_f32_16x16x32_bf16 v[28:31], v[16:19], v[228:231], v[28:31]
  v_mov_b32_dpp v13, v14 row_newbcast:7 row_mask:0xf bank_mask:0x3
  v_mov_b32_dpp v13, v14 row_newbcast:15 row_mask:0xf bank_mask:0xc
  v_and_b32 v16, v8, v13
  v_and_b32 v17, v9, v13
  v_and_b32 v18, v10, v13
  v_and_b32 v19, v11, v13
  s_nop 1
  s_waitcnt vmcnt(6)
  buffer_load_dwordx4 v[68:71], v4, s[8:11], s58 offen offset:128 nt
  v_mfma_f32_16x16x32_bf16 v[20:23], v[16:19], v[72:75], v[20:23]
  s_waitcnt vmcnt(6)
  buffer_load_dwordx4 v[72:75], v4, s[8:11], s58 offen offset:256 nt
  v_mfma_f32_16x16x32_bf16 v[24:27], v[16:19], v[76:79], v[24:27]
  v_readlane_b32 s64, v0, 60
  s_add_u32 s58, s92, 12189696
  s_bfe_u32 s65, s64, 0x3000c
  s_mulk_i32 s65, 12288
  v_add_u32 v44, s65, v3
  v_add_u32 v45, 4294868992, v44
  v_min_u32 v4, v44, v45
  s_waitcnt vmcnt(6)
  s_barrier
  buffer_load_dwordx4 v[76:79], v4, s[8:11], s58 offen offset:0 nt
  v_mfma_f32_16x16x32_bf16 v[28:31], v[16:19], v[48:51], v[28:31]
  v_and_b32 v14, 0xffff0000, v39
  v_cmp_lt_f32 vcc, s60, v14
  s_cbranch_vccz L_nr_636
  s_call_b64 s[52:53], L_rescale
L_nr_636:
  v_subrev_f32 v14, s60, v14
  v_mul_f32 v14, s85, v14
  v_exp_f32 v14, v14
  s_nop 0
  v_add_f32 v15, v15, v14
  v_cvt_pk_bf16_f32 v14, v14, v14
  s_nop 1
  v_lshrrev_b32 v84, 3, v1
  v_and_b32 v85, 7, v1
  v_mul_u32_u24 v84, 10240, v84
  v_lshl_add_u32 v84, v85, 4, v84
  v_or_b32 v85, s90, v84
  s_mul_i32 s78, s72, 192
  s_add_u32 s77, s89, s78
  s_mul_i32 s80, s77, 1280
  v_mov_b32_dpp v13, v14 row_newbcast:1 row_mask:0xf bank_mask:0x3
  v_mov_b32_dpp v13, v14 row_newbcast:9 row_mask:0xf bank_mask:0xc
  v_and_b32 v16, v8, v13
  v_and_b32 v17, v9, v13
  v_and_b32 v18, v10, v13
  v_and_b32 v19, v11, v13
  s_nop 1
  s_waitcnt vmcnt(6)
  buffer_load_dwordx4 v[48:51], v4, s[8:11], s58 offen offset:128 nt
  v_mfma_f32_16x16x32_bf16 v[20:23], v[16:19], v[52:55], v[20:23]
  s_mul_i32 s77, s84, 128
  s_add_u32 s77, s77, s80
  s_add_u32 s77, s77, 163840
  buffer_load_dwordx4 v[80:83], v85, s[16:19], s77 offen nt
  s_waitcnt vmcnt(7)
  buffer_load_dwordx4 v[52:55], v4, s[8:11], s58 offen offset:256 nt
  v_mfma_f32_16x16x32_bf16 v[24:27], v[16:19], v[56:59], v[24:27]
  v_readlane_b32 s64, v0, 61
  s_add_u32 s58, s92, 12288000
  s_bfe_u32 s65, s64, 0x3000c
  s_mulk_i32 s65, 12288
  v_add_u32 v44, s65, v3
  v_add_u32 v45, 4294868992, v44
  v_min_u32 v4, v44, v45
  s_waitcnt vmcnt(7)
  s_barrier
  buffer_load_dwordx4 v[56:59], v4, s[8:11], s58 offen offset:0 nt
  v_mfma_f32_16x16x32_bf16 v[28:31], v[16:19], v[60:63], v[28:31]
  v_mov_b32_dpp v13, v14 row_newbcast:0 row_mask:0xf bank_mask:0x3
  v_mov_b32_dpp v13, v14 row_newbcast:8 row_mask:0xf bank_mask:0xc
  v_and_b32 v16, v8, v13
  v_and_b32 v17, v9, v13
  v_and_b32 v18, v10, v13
  v_and_b32 v19, v11, v13
  s_nop 1
  v_mfma_f32_16x16x32_bf16 v[20:23], v[16:19], v[232:235], v[20:23]
  v_mfma_f32_16x16x32_bf16 v[24:27], v[16:19], v[236:239], v[24:27]
  v_mfma_f32_16x16x32_bf16 v[28:31], v[16:19], v[240:243], v[28:31]
  v_mov_b32_dpp v13, v14 row_newbcast:2 row_mask:0xf bank_mask:0x3
  v_mov_b32_dpp v13, v14 row_newbcast:10 row_mask:0xf bank_mask:0xc
  v_and_b32 v16, v8, v13
  v_and_b32 v17, v9, v13
  v_and_b32 v18, v10, v13
  v_and_b32 v19, v11, v13
  s_nop 1
  s_waitcnt vmcnt(7)
  buffer_load_dwordx4 v[60:63], v4, s[8:11], s58 offen offset:128 nt
  v_mfma_f32_16x16x32_bf16 v[20:23], v[16:19], v[64:67], v[20:23]
  s_waitcnt vmcnt(7)
  buffer_load_dwordx4 v[64:67], v4, s[8:11], s58 offen offset:256 nt
  v_mfma_f32_16x16x32_bf16 v[24:27], v[16:19], v[68:71], v[24:27]
  v_readlane_b32 s64, v0, 62
  s_add_u32 s58, s92, 12386304
  s_bfe_u32 s65, s64, 0x3000c
  s_mulk_i32 s65, 12288
  v_add_u32 v44, s65, v3
  v_add_u32 v45, 4294868992, v44
  v_min_u32 v4, v44, v45
  s_waitcnt vmcnt(7)
  s_barrier
  buffer_load_dwordx4 v[68:71], v4, s[8:11], s58 offen offset:0 nt
  v_mfma_f32_16x16x32_bf16 v[28:31], v[16:19], v[72:75], v[28:31]
  v_mov_b32_dpp v13, v14 row_newbcast:4 row_mask:0xf bank_mask:0x3
  v_mov_b32_dpp v13, v14 row_newbcast:12 row_mask:0xf bank_mask:0xc
  v_and_b32 v16, v8, v13
  v_and_b32 v17, v9, v13
  v_and_b32 v18, v10, v13
  v_and_b32 v19, v11, v13
  s_nop 1
  s_waitcnt vmcnt(7)
  buffer_load_dwordx4 v[72:75], v4, s[8:11], s58 offen offset:128 nt
  v_mfma_f32_16x16x32_bf16 v[20:23], v[16:19], v[76:79], v[20:23]
  s_waitcnt vmcnt(7)
  buffer_load_dwordx4 v[76:79], v4, s[8:11], s58 offen offset:256 nt
  v_mfma_f32_16x16x32_bf16 v[24:27], v[16:19], v[48:51], v[24:27]
  v_readlane_b32 s64, v0, 63
  s_add_u32 s58, s92, 12484608
  s_bfe_u32 s65, s64, 0x3000c
  s_mulk_i32 s65, 12288
  v_add_u32 v44, s65, v3
  v_add_u32 v45, 4294868992, v44
  v_min_u32 v4, v44, v45
  s_waitcnt vmcnt(6)
  s_barrier
  buffer_load_dwordx4 v[48:51], v4, s[8:11], s58 offen offset:0 nt
  v_mfma_f32_16x16x32_bf16 v[28:31], v[16:19], v[52:55], v[28:31]
  v_mov_b32_dpp v13, v14 row_newbcast:5 row_mask:0xf bank_mask:0x3
  v_mov_b32_dpp v13, v14 row_newbcast:13 row_mask:0xf bank_mask:0xc
  v_and_b32 v16, v8, v13
  v_and_b32 v17, v9, v13
  v_and_b32 v18, v10, v13
  v_and_b32 v19, v11, v13
  s_nop 1
  s_waitcnt vmcnt(6)
  buffer_load_dwordx4 v[52:55], v4, s[8:11], s58 offen offset:128 nt
  v_mfma_f32_16x16x32_bf16 v[20:23], v[16:19], v[56:59], v[20:23]
  s_waitcnt vmcnt(6)
  buffer_load_dwordx4 v[56:59], v4, s[8:11], s58 offen offset:256 nt
  v_mfma_f32_16x16x32_bf16 v[24:27], v[16:19], v[60:63], v[24:27]
  s_waitcnt vmcnt(6)
  s_barrier
  s_add_u32 s77, s3, 0
  s_mul_i32 s77, s77, 128
  s_add_u32 s77, s77, s80
  s_add_u32 s77, s77, 81920
  buffer_load_dwordx4 v[60:63], v84, s[16:19], s77 offen nt
  v_mfma_f32_16x16x32_bf16 v[28:31], v[16:19], v[64:67], v[28:31]
  v_mov_b32_dpp v13, v14 row_newbcast:3 row_mask:0xf bank_mask:0x3
  v_mov_b32_dpp v13, v14 row_newbcast:11 row_mask:0xf bank_mask:0xc
  v_and_b32 v16, v8, v13
  v_and_b32 v17, v9, v13
  v_and_b32 v18, v10, v13
  v_and_b32 v19, v11, v13
  s_nop 1
  v_mfma_f32_16x16x32_bf16 v[20:23], v[16:19], v[244:247], v[20:23]
  v_mfma_f32_16x16x32_bf16 v[24:27], v[16:19], v[248:251], v[24:27]
  v_mfma_f32_16x16x32_bf16 v[28:31], v[16:19], v[252:255], v[28:31]
  v_mov_b32_dpp v13, v14 row_newbcast:6 row_mask:0xf bank_mask:0x3
  v_mov_b32_dpp v13, v14 row_newbcast:14 row_mask:0xf bank_mask:0xc
  v_and_b32 v16, v8, v13
  v_and_b32 v17, v9, v13
  v_and_b32 v18, v10, v13
  v_and_b32 v19, v11, v13
  s_nop 1
  s_waitcnt vmcnt(6)
  s_add_u32 s77, s3, 4
  s_mul_i32 s77, s77, 128
  s_add_u32 s77, s77, s80
  s_add_u32 s77, s77, 81920
  buffer_load_dwordx4 v[64:67], v84, s[16:19], s77 offen nt
  v_mfma_f32_16x16x32_bf16 v[20:23], v[16:19], v[68:71], v[20:23]
  s_waitcnt vmcnt(6)
  s_mul_i32 s77, s84, 128
  s_add_u32 s77, s77, s80
  s_add_u32 s77, s77, 81920
  buffer_load_dwordx4 v[68:71], v85, s[16:19], s77 offen nt
  v_mfma_f32_16x16x32_bf16 v[24:27], v[16:19], v[72:75], v[24:27]
  s_waitcnt vmcnt(6)
  s_barrier
  s_add_u32 s77, s3, 0
  s_mul_i32 s77, s77, 128
  s_add_u32 s77, s77, s80
  s_add_u32 s77, s77, 163840
  buffer_load_dwordx4 v[72:75], v84, s[16:19], s77 offen nt
  v_mfma_f32_16x16x32_bf16 v[28:31], v[16:19], v[76:79], v[28:31]
  v_mov_b32_dpp v13, v14 row_newbcast:7 row_mask:0xf bank_mask:0x3
  v_mov_b32_dpp v13, v14 row_newbcast:15 row_mask:0xf bank_mask:0xc
  v_and_b32 v16, v8, v13
  v_and_b32 v17, v9, v13
  v_and_b32 v18, v10, v13
  v_and_b32 v19, v11, v13
  s_nop 1
  s_waitcnt vmcnt(6)
  s_add_u32 s77, s3, 4
  s_mul_i32 s77, s77, 128
  s_add_u32 s77, s77, s80
  s_add_u32 s77, s77, 163840
  buffer_load_dwordx4 v[76:79], v84, s[16:19], s77 offen nt
  v_mfma_f32_16x16x32_bf16 v[20:23], v[16:19], v[48:51], v[20:23]
  s_waitcnt vmcnt(6)
  s_add_u32 s77, s3, 0
  s_mul_i32 s77, s77, 128
  s_add_u32 s77, s77, s80
  buffer_load_dwordx4 v[48:51], v84, s[16:19], s77 offen nt
  v_mfma_f32_16x16x32_bf16 v[24:27], v[16:19], v[52:55], v[24:27]
  s_waitcnt vmcnt(6)
  s_barrier
  s_add_u32 s77, s3, 4
  s_mul_i32 s77, s77, 128
  s_add_u32 s77, s77, s80
  buffer_load_dwordx4 v[52:55], v84, s[16:19], s77 offen nt
  v_mfma_f32_16x16x32_bf16 v[28:31], v[16:19], v[56:59], v[28:31]
  s_mul_i32 s77, s84, 128
  s_add_u32 s77, s77, s80
  buffer_load_dwordx4 v[56:59], v85, s[16:19], s77 offen nt
L_passend:
  s_xor_b32 s74, s74, 1
  s_not_b32 s75, s75
  s_mov_b32 s78, 2
  s_nop 1
  v_add_f32_dpp v15, v15, v15 quad_perm:[1,0,3,2] row_mask:0xf bank_mask:0xf
  s_nop 1
  v_add_f32_dpp v15, v15, v15 quad_perm:[2,3,0,1] row_mask:0xf bank_mask:0xf
  s_nop 1
  v_add_f32_dpp v15, v15, v15 row_half_mirror row_mask:0xf bank_mask:0xf
  s_nop 1
  v_add_f32_dpp v15, v15, v15 row_mirror row_mask:0xf bank_mask:0xf
  s_nop 1
  v_mov_b32 v44, v15
  s_nop 1
  v_permlane16_swap_b32 v15, v44
  v_add_f32 v15, v15, v44
  v_mov_b32 v44, v15
  s_nop 1
  v_permlane32_swap_b32 v15, v44
  v_add_f32 v15, v15, v44
  v_permlane32_swap_b32 v20, v21
  v_permlane32_swap_b32 v22, v23
  v_permlane32_swap_b32 v24, v25
  v_permlane32_swap_b32 v26, v27
  v_permlane32_swap_b32 v28, v29
  v_permlane32_swap_b32 v30, v31
  s_nop 0
  v_add_f32_dpp v16, v21, v20 row_ror:8 row_mask:0xf bank_mask:0x3
  v_add_f32_dpp v16, v22, v23 row_ror:8 row_mask:0xf bank_mask:0xc
  v_add_f32_dpp v17, v25, v24 row_ror:8 row_mask:0xf bank_mask:0x3
  v_add_f32_dpp v17, v26, v27 row_ror:8 row_mask:0xf bank_mask:0xc
  v_add_f32_dpp v18, v29, v28 row_ror:8 row_mask:0xf bank_mask:0x3
  v_add_f32_dpp v18, v30, v31 row_ror:8 row_mask:0xf bank_mask:0xc
  s_lshl_b32 s78, s78, 2
  s_add_u32 s78, s78, s3
  s_lshl_b32 s77, s78, 10
  s_add_u32 s77, s77, 147456
  v_lshl_add_u32 v45, v1, 4, s77
  ds_write_b128 v45, v[16:19]
  s_lshl_b32 s77, s78, 3
  s_add_u32 s77, s77, 159744
  v_mov_b32 v44, s77
  v_mov_b32 v14, s60
  ds_write_b64 v44, v[14:15]
  s_waitcnt lgkmcnt(0)
  s_barrier
  s_cmp_eq_u32 s3, 3
  s_cbranch_scc1 L_apub_done
  s_lshl_b32 s77, s3, 5
  s_add_u32 s77, s77, 159744
  v_mov_b32 v44, s77
  s_lshl_b32 s77, s3, 12
  s_add_u32 s77, s77, 147456
  v_lshl_add_u32 v45, v1, 4, s77
  ds_read_b128 v[84:87], v44
  ds_read_b128 v[88:91], v44 offset:16
  ds_read_b128 v[16:19], v45
  ds_read_b128 v[20:23], v45 offset:1024
  ds_read_b128 v[24:27], v45 offset:2048
  ds_read_b128 v[28:31], v45 offset:3072
  v_lshrrev_b32 v46, 3, v1
  v_mul_u32_u24 v46, 3072, v46
  v_and_b32 v47, 7, v1
  v_lshl_add_u32 v46, v47, 4, v46
  s_mul_i32 s77, s96, 24576
  s_lshl_b32 s78, s97, 3
  s_add_u32 s78, s78, s73
  s_lshl_b32 s78, s78, 7
  s_add_u32 s77, s77, s78
  s_add_u32 s77, s77, 1835008
  s_waitcnt lgkmcnt(4)
  v_max3_f32 v44, v84, v86, v88
  v_max_f32 v44, v44, v90
  v_sub_f32 v84, v84, v44
  v_sub_f32 v86, v86, v44
  v_sub_f32 v88, v88, v44
  v_sub_f32 v90, v90, v44
  v_mul_f32 v84, s85, v84
  v_mul_f32 v86, s85, v86
  v_mul_f32 v88, s85, v88
  v_mul_f32 v90, s85, v90
  v_exp_f32 v84, v84
  v_exp_f32 v86, v86
  v_exp_f32 v88, v88
  v_exp_f32 v90, v90
  v_mul_f32 v45, v84, v85
  v_fmac_f32 v45, v86, v87
  v_fmac_f32 v45, v88, v89
  v_fmac_f32 v45, v90, v91
  v_rcp_f32 v47, v45
  v_log_f32 v45, v45
  s_waitcnt lgkmcnt(0)
  v_mul_f32 v16, v84, v16
  v_mul_f32 v17, v84, v17
  v_mul_f32 v18, v84, v18
  v_fmac_f32 v16, v86, v20
  v_fmac_f32 v17, v86, v21
  v_fmac_f32 v18, v86, v22
  v_fmac_f32 v16, v88, v24
  v_fmac_f32 v17, v88, v25
  v_fmac_f32 v18, v88, v26
  v_fmac_f32 v16, v90, v28
  v_fmac_f32 v17, v90, v29
  v_fmac_f32 v18, v90, v30
  v_mul_f32 v16, v47, v16
  v_mul_f32 v17, v47, v17
  v_mul_f32 v18, v47, v18
  v_fma_f32 v19, v44, s85, v45
  v_and_or_b32 v16, v16, -2, s74
  v_and_or_b32 v17, v17, -2, s74
  v_and_or_b32 v18, v18, -2, s74
  v_and_or_b32 v19, v19, -2, s74
  buffer_store_dwordx4 v[16:19], v46, s[28:31], s77 offen sc1
L_apub_done:
  s_lshr_b32 s77, s2, 5
  s_cmp_lg_u32 s77, 6
  s_cbranch_scc1 L_nores
  s_and_b32 s82, s2, 31
  v_and_b32 v44, 7, v1
  v_lshlrev_b32 v44, 4, v44
  s_cmp_lg_u32 s76, 0
  s_cbranch_scc1 L_res1
  s_lshr_b32 s77, s82, 3
  s_lshl_b32 s77, s77, 7
  s_and_b32 s78, s82, 3
  s_lshl_b32 s78, s78, 2
  s_add_u32 s77, s77, s78
  s_bfe_u32 s78, s82, 0x10002
  s_lshl_b32 s78, s78, 1
  s_add_u32 s77, s77, s78
  v_mov_b32 v88, 0
  v_mov_b32 v89, 0
  v_mov_b32 v90, 0
  v_add_u32 v44, s77, v44
  buffer_load_short_d16_hi v88, v44, s[32:35], 0 offen offset:0
  buffer_load_short_d16_hi v89, v44, s[32:35], 0 offen offset:512
  buffer_load_short_d16_hi v90, v44, s[32:35], 0 offen offset:1024
  s_branch L_nores
L_res1:
  s_lshl_b32 s77, s82, 7
  s_add_u32 s77, s77, 2686976
  buffer_load_dwordx4 v[88:91], v44, s[28:31], s77 offen sc1
L_nores:
  v_and_b32 v44, 7, v1
  v_lshlrev_b32 v44, 7, v44
  v_lshrrev_b32 v45, 3, v1
  v_lshl_add_u32 v44, v45, 4, v44
  s_lshl_b32 s77, s72, 3
  s_add_u32 s77, s77, s73
  s_mul_i32 s77, s77, 3072
  s_add_u32 s77, s77, 1835008
  s_mov_b32 s86, 200000
  buffer_load_dwordx4 v[84:87], v44, s[28:31], s77 offen offset:0 sc1
  buffer_load_dwordx4 v[20:23], v44, s[28:31], s77 offen offset:1024 sc1
  buffer_load_dwordx4 v[24:27], v44, s[28:31], s77 offen offset:2048 sc1
L_poll_637:
  s_waitcnt vmcnt(2)
  v_bitop3_b32 v45, v84, v85, s75 bitop3:0x7e
  v_bitop3_b32 v45, v45, v86, s75 bitop3:0xf6
  v_bitop3_b32 v45, v45, v87, s75 bitop3:0xf6
  v_and_b32 v45, 1, v45
  v_cmp_ne_u32 s[60:61], 0, v45
  s_waitcnt vmcnt(1)
  v_bitop3_b32 v45, v20, v21, s75 bitop3:0x7e
  v_bitop3_b32 v45, v45, v22, s75 bitop3:0xf6
  v_bitop3_b32 v45, v45, v23, s75 bitop3:0xf6
  v_and_b32 v45, 1, v45
  v_cmp_ne_u32 s[62:63], 0, v45
  s_waitcnt vmcnt(0)
  v_bitop3_b32 v45, v24, v25, s75 bitop3:0x7e
  v_bitop3_b32 v45, v45, v26, s75 bitop3:0xf6
  v_bitop3_b32 v45, v45, v27, s75 bitop3:0xf6
  v_and_b32 v45, 1, v45
  v_cmp_ne_u32 s[64:65], 0, v45
  s_or_b64 vcc, s[60:61], s[62:63]
  s_nop 0
  s_or_b64 vcc, vcc, s[64:65]
  s_cbranch_scc0 L_pollx_638
  s_mov_b64 exec, s[60:61]
  buffer_load_dwordx4 v[84:87], v44, s[28:31], s77 offen offset:0 sc1
  s_mov_b64 exec, s[62:63]
  buffer_load_dwordx4 v[20:23], v44, s[28:31], s77 offen offset:1024 sc1
  s_mov_b64 exec, s[64:65]
  buffer_load_dwordx4 v[24:27], v44, s[28:31], s77 offen offset:2048 sc1
  s_mov_b64 exec, -1
  s_sub_u32 s86, s86, 1
  s_cmp_lg_u32 s86, 0
  s_cbranch_scc1 L_poll_637
  s_waitcnt vmcnt(0)
L_pollx_638:
  v_max3_f32 v44, v87, v23, v27
  s_nop 1
  v_max_f32_dpp v44, v44, v44 quad_perm:[1,0,3,2] row_mask:0xf bank_mask:0xf
  s_nop 1
  v_max_f32_dpp v44, v44, v44 quad_perm:[2,3,0,1] row_mask:0xf bank_mask:0xf
  s_nop 1
  v_max_f32_dpp v44, v44, v44 row_half_mirror row_mask:0xf bank_mask:0xf
  v_sub_f32 v87, v87, v44
  v_sub_f32 v23, v23, v44
  v_sub_f32 v27, v27, v44
  v_exp_f32 v87, v87
  v_exp_f32 v23, v23
  v_exp_f32 v27, v27
  v_mul_f32 v84, v87, v84
  v_mul_f32 v85, v87, v85
  v_mul_f32 v86, v87, v86
  v_add_f32 v87, v87, v23
  v_fmac_f32 v84, v23, v20
  v_fmac_f32 v85, v23, v21
  v_fmac_f32 v86, v23, v22
  v_add_f32 v87, v87, v27
  v_fmac_f32 v84, v27, v24
  v_fmac_f32 v85, v27, v25
  v_fmac_f32 v86, v27, v26
  v_add_f32_dpp v87, v87, v87 quad_perm:[1,0,3,2] row_mask:0xf bank_mask:0xf
  v_add_f32_dpp v84, v84, v84 quad_perm:[1,0,3,2] row_mask:0xf bank_mask:0xf
  v_add_f32_dpp v85, v85, v85 quad_perm:[1,0,3,2] row_mask:0xf bank_mask:0xf
  v_add_f32_dpp v86, v86, v86 quad_perm:[1,0,3,2] row_mask:0xf bank_mask:0xf
  v_add_f32_dpp v87, v87, v87 quad_perm:[2,3,0,1] row_mask:0xf bank_mask:0xf
  v_add_f32_dpp v84, v84, v84 quad_perm:[2,3,0,1] row_mask:0xf bank_mask:0xf
  v_add_f32_dpp v85, v85, v85 quad_perm:[2,3,0,1] row_mask:0xf bank_mask:0xf
  v_add_f32_dpp v86, v86, v86 quad_perm:[2,3,0,1] row_mask:0xf bank_mask:0xf
  v_add_f32_dpp v87, v87, v87 row_half_mirror row_mask:0xf bank_mask:0xf
  v_add_f32_dpp v84, v84, v84 row_half_mirror row_mask:0xf bank_mask:0xf
  v_add_f32_dpp v85, v85, v85 row_half_mirror row_mask:0xf bank_mask:0xf
  v_add_f32_dpp v86, v86, v86 row_half_mirror row_mask:0xf bank_mask:0xf
  v_rcp_f32 v44, v87
  s_nop 0
  v_mul_f32 v84, v44, v84
  v_mul_f32 v85, v44, v85
  v_mul_f32 v86, v44, v86
  v_cvt_pk_bf16_f32 v84, v84, v84
  v_cvt_pk_bf16_f32 v85, v85, v85
  v_cvt_pk_bf16_f32 v86, v86, v86
  v_and_b32 v16, v8, v84
  v_and_b32 v17, v9, v84
  v_and_b32 v18, v10, v84
  v_and_b32 v19, v11, v84
  s_nop 1
  v_mfma_f32_16x16x32_bf16 v[20:23], v[16:19], v[48:51], 0
  v_mfma_f32_16x16x32_bf16 v[24:27], v[16:19], v[52:55], 0
  v_mfma_f32_16x16x32_bf16 v[28:31], v[16:19], v[56:59], 0
  v_and_b32 v16, v8, v85
  v_and_b32 v17, v9, v85
  v_and_b32 v18, v10, v85
  v_and_b32 v19, v11, v85
  s_nop 1
  v_mfma_f32_16x16x32_bf16 v[20:23], v[16:19], v[60:63], v[20:23]
  v_mfma_f32_16x16x32_bf16 v[24:27], v[16:19], v[64:67], v[24:27]
  v_mfma_f32_16x16x32_bf16 v[28:31], v[16:19], v[68:71], v[28:31]
  v_and_b32 v16, v8, v86
  v_and_b32 v17, v9, v86
  v_and_b32 v18, v10, v86
  v_and_b32 v19, v11, v86
  s_nop 1
  v_mfma_f32_16x16x32_bf16 v[20:23], v[16:19], v[72:75], v[20:23]
  v_mfma_f32_16x16x32_bf16 v[24:27], v[16:19], v[76:79], v[24:27]
  v_mfma_f32_16x16x32_bf16 v[28:31], v[16:19], v[80:83], v[28:31]
  v_lshrrev_b32 v46, 3, v1
  v_mul_u32_u24 v46, 32768, v46
  v_and_b32 v47, 7, v1
  v_lshl_add_u32 v46, v47, 4, v46
  s_mul_i32 s77, s3, 262144
  s_lshl_b32 s78, s2, 7
  s_add_u32 s77, s77, s78
  s_nop 2
  v_permlane32_swap_b32 v20, v21
  v_permlane32_swap_b32 v22, v23
  v_permlane32_swap_b32 v24, v25
  v_permlane32_swap_b32 v26, v27
  v_permlane32_swap_b32 v28, v29
  v_permlane32_swap_b32 v30, v31
  s_nop 0
  v_add_f32_dpp v16, v21, v20 row_ror:8 row_mask:0xf bank_mask:0x3
  v_add_f32_dpp v16, v22, v23 row_ror:8 row_mask:0xf bank_mask:0xc
  v_add_f32_dpp v17, v25, v24 row_ror:8 row_mask:0xf bank_mask:0x3
  v_add_f32_dpp v17, v26, v27 row_ror:8 row_mask:0xf bank_mask:0xc
  v_add_f32_dpp v18, v29, v28 row_ror:8 row_mask:0xf bank_mask:0x3
  v_add_f32_dpp v18, v30, v31 row_ror:8 row_mask:0xf bank_mask:0xc
  v_and_or_b32 v16, v16, -2, s74
  v_and_or_b32 v17, v17, -2, s74
  v_and_or_b32 v18, v18, -2, s74
  v_and_or_b32 v19, v19, -2, s74
  buffer_store_dwordx4 v[16:19], v46, s[28:31], s77 offen sc1
  s_lshr_b32 s77, s2, 5
  s_cmp_eq_u32 s77, 6
  s_cbranch_scc1 L_nowq
  s_barrier
  s_cmp_ge_u32 s2, 192
  s_cbranch_scc1 L_noffnw
  v_and_b32 v44, 7, v1
  v_bfe_u32 v45, v1, 3, 2
  v_lshlrev_b32 v44, 3, v44
  v_lshl_add_u32 v44, v45, 1, v44
  v_lshrrev_b32 v45, 5, v1
  v_add_u32 v44, v44, v45
  v_mul_u32_u24 v44, 3072, v44
  s_and_b32 s81, s2, 7
  s_mul_i32 s81, s81, 24
  s_add_u32 s81, s81, s72
  s_lshl_b32 s78, s81, 4
  s_add_u32 s77, s3, 0
  s_mul_i32 s77, s77, 196608
  s_add_u32 s77, s77, s78
  buffer_load_dwordx4 v[32:35], v44, s[20:23], s77 offen
  s_add_u32 s77, s3, 4
  s_mul_i32 s77, s77, 196608
  s_add_u32 s77, s77, s78
  buffer_load_dwordx4 v[36:39], v44, s[20:23], s77 offen
  s_mul_i32 s77, s84, 196608
  s_add_u32 s77, s77, s78
  v_or_b32 v44, s90, v44
  buffer_load_dwordx4 v[40:43], v44, s[20:23], s77 offen
  v_lshrrev_b32 v44, 3, v1
  v_and_b32 v45, 7, v1
  v_mul_u32_u24 v44, 1280, v44
  v_lshl_add_u32 v44, v45, 4, v44
  s_mul_i32 s78, s81, 10240
  s_add_u32 s77, s3, 0
  s_mul_i32 s77, s77, 128
  s_add_u32 s77, s77, s78
  buffer_load_dwordx4 v[72:75], v44, s[24:27], s77 offen nt
  s_add_u32 s77, s3, 4
  s_mul_i32 s77, s77, 128
  s_add_u32 s77, s77, s78
  buffer_load_dwordx4 v[76:79], v44, s[24:27], s77 offen nt
  s_mul_i32 s77, s84, 128
  s_add_u32 s77, s77, s78
  v_or_b32 v44, s90, v44
  buffer_load_dwordx4 v[80:83], v44, s[24:27], s77 offen nt
L_noffnw:
  s_mov_b32 s101, 0
  s_cmp_lg_u32 s76, 0
  s_cbranch_scc1 L_nowq
  s_sub_u32 s77, s2, 160
  s_cmp_lt_u32 s77, 64
  s_cbranch_scc1 L_nowq
  v_lshrrev_b32 v44, 3, v1
  v_mul_u32_u24 v44, 98304, v44
  v_and_b32 v45, 7, v1
  v_lshl_add_u32 v44, v45, 4, v44
  s_cmp_ge_u32 s2, 224
  s_cselect_b32 s78, 64, 0
  s_sub_u32 s78, s2, s78
  s_and_b32 s77, s78, 1
  s_lshl1_add_u32 s77, s3, s77
  s_mulk_i32 s77, 12288
  s_lshr_b32 s78, s78, 1
  s_lshl_b32 s78, s78, 7
  s_add_u32 s77, s77, s78
  v_mov_b32 v4, v44
  s_mov_b32 s100, s77
  s_mov_b32 s101, 1
  buffer_load_dwordx4 v[48:51], v4, s[12:15], s100 offen nt
  s_add_u32 s100, s100, 786432
  buffer_load_dwordx4 v[52:55], v4, s[12:15], s100 offen nt
  s_add_u32 s100, s100, 786432
  buffer_load_dwordx4 v[56:59], v4, s[12:15], s100 offen nt
  s_add_u32 s100, s100, 786432
  buffer_load_dwordx4 v[60:63], v4, s[12:15], s100 offen nt
  s_add_u32 s100, s100, 786432
  s_cmp_lt_u32 s2, 192
  s_cbranch_scc1 L_ffn
  buffer_load_dwordx4 v[64:67], v4, s[12:15], s100 offen nt
  s_add_u32 s100, s100, 786432
  buffer_load_dwordx4 v[68:71], v4, s[12:15], s100 offen nt
  s_add_u32 s100, s100, 786432
  buffer_load_dwordx4 v[12:15], v4, s[12:15], s100 offen nt
  s_add_u32 s100, s100, 786432
  buffer_load_dwordx4 v[80:83], v4, s[12:15], s100 offen nt
  s_add_u32 s100, s100, 786432
  buffer_load_dwordx4 v[32:35], v4, s[12:15], s100 offen nt
  s_add_u32 s100, s100, 786432
  buffer_load_dwordx4 v[36:39], v4, s[12:15], s100 offen nt
  s_add_u32 s100, s100, 786432
L_nowq:
  s_cmp_lt_u32 s2, 192
  s_cbranch_scc1 L_ffn
  s_cmp_ge_u32 s2, 224
  s_cbranch_scc1 L_red_done
  v_lshrrev_b32 v44, 3, v1
  v_and_b32 v45, 7, v1
  v_lshlrev_b32 v44, 12, v44
  v_lshl_add_u32 v84, v45, 4, v44
  v_lshlrev_b32 v44, 4, v1
  s_mov_b32 s101, 1
  s_branch L_rb_640
L_rp_639:
  s_mov_b32 s101, 0
  s_mul_i32 s77, s82, 32768
  s_mul_i32 s78, s3, 8192
  s_add_u32 s77, s77, s78
  s_add_u32 s78, s77, 4096
  s_mov_b32 s86, 200000
  buffer_load_dwordx4 v[32:35], v44, s[28:31], s77 offen offset:0 sc1
  buffer_load_dwordx4 v[36:39], v44, s[28:31], s77 offen offset:1024 sc1
  buffer_load_dwordx4 v[40:43], v44, s[28:31], s77 offen offset:2048 sc1
  buffer_load_dwordx4 v[72:75], v44, s[28:31], s77 offen offset:3072 sc1
  buffer_load_dwordx4 v[76:79], v44, s[28:31], s78 offen offset:0 sc1
  buffer_load_dwordx4 v[80:83], v44, s[28:31], s78 offen offset:1024 sc1
  buffer_load_dwordx4 v[20:23], v44, s[28:31], s78 offen offset:2048 sc1
  buffer_load_dwordx4 v[24:27], v44, s[28:31], s78 offen offset:3072 sc1
L_poll_641:
  s_waitcnt vmcnt(7)
  v_bitop3_b32 v45, v32, v33, s75 bitop3:0x7e
  v_bitop3_b32 v45, v45, v34, s75 bitop3:0xf6
  v_and_b32 v45, 1, v45
  v_cmp_ne_u32 s[60:61], 0, v45
  s_waitcnt vmcnt(6)
  v_bitop3_b32 v45, v36, v37, s75 bitop3:0x7e
  v_bitop3_b32 v45, v45, v38, s75 bitop3:0xf6
  v_and_b32 v45, 1, v45
  v_cmp_ne_u32 s[62:63], 0, v45
  s_waitcnt vmcnt(5)
  v_bitop3_b32 v45, v40, v41, s75 bitop3:0x7e
  v_bitop3_b32 v45, v45, v42, s75 bitop3:0xf6
  v_and_b32 v45, 1, v45
  v_cmp_ne_u32 s[64:65], 0, v45
  s_or_b64 vcc, s[60:61], s[62:63]
  s_waitcnt vmcnt(4)
  v_bitop3_b32 v45, v72, v73, s75 bitop3:0x7e
  v_bitop3_b32 v45, v45, v74, s75 bitop3:0xf6
  v_and_b32 v45, 1, v45
  v_cmp_ne_u32 s[66:67], 0, v45
  s_or_b64 vcc, vcc, s[64:65]
  s_waitcnt vmcnt(3)
  v_bitop3_b32 v45, v76, v77, s75 bitop3:0x7e
  v_bitop3_b32 v45, v45, v78, s75 bitop3:0xf6
  v_and_b32 v45, 1, v45
  v_cmp_ne_u32 s[68:69], 0, v45
  s_or_b64 vcc, vcc, s[66:67]
  s_waitcnt vmcnt(2)
  v_bitop3_b32 v45, v80, v81, s75 bitop3:0x7e
  v_bitop3_b32 v45, v45, v82, s75 bitop3:0xf6
  v_and_b32 v45, 1, v45
  v_cmp_ne_u32 s[70:71], 0, v45
  s_or_b64 vcc, vcc, s[68:69]
  s_waitcnt vmcnt(1)
  v_bitop3_b32 v45, v20, v21, s75 bitop3:0x7e
  v_bitop3_b32 v45, v45, v22, s75 bitop3:0xf6
  v_and_b32 v45, 1, v45
  v_cmp_ne_u32 s[54:55], 0, v45
  s_or_b64 vcc, vcc, s[70:71]
  s_waitcnt vmcnt(0)
  v_bitop3_b32 v45, v24, v25, s75 bitop3:0x7e
  v_bitop3_b32 v45, v45, v26, s75 bitop3:0xf6
  v_and_b32 v45, 1, v45
  v_cmp_ne_u32 s[52:53], 0, v45
  s_or_b64 vcc, vcc, s[54:55]
  s_nop 0
  s_or_b64 vcc, vcc, s[52:53]
  s_cbranch_scc0 L_pollx_642
  s_mov_b64 exec, s[60:61]
  buffer_load_dwordx4 v[32:35], v44, s[28:31], s77 offen offset:0 sc1
  s_mov_b64 exec, s[62:63]
  buffer_load_dwordx4 v[36:39], v44, s[28:31], s77 offen offset:1024 sc1
  s_mov_b64 exec, s[64:65]
  buffer_load_dwordx4 v[40:43], v44, s[28:31], s77 offen offset:2048 sc1
  s_mov_b64 exec, s[66:67]
  buffer_load_dwordx4 v[72:75], v44, s[28:31], s77 offen offset:3072 sc1
  s_mov_b64 exec, s[68:69]
  buffer_load_dwordx4 v[76:79], v44, s[28:31], s78 offen offset:0 sc1
  s_mov_b64 exec, s[70:71]
  buffer_load_dwordx4 v[80:83], v44, s[28:31], s78 offen offset:1024 sc1
  s_mov_b64 exec, s[54:55]
  buffer_load_dwordx4 v[20:23], v44, s[28:31], s78 offen offset:2048 sc1
  s_mov_b64 exec, s[52:53]
  buffer_load_dwordx4 v[24:27], v44, s[28:31], s78 offen offset:3072 sc1
  s_mov_b64 exec, -1
  s_sub_u32 s86, s86, 1
  s_cmp_lg_u32 s86, 0
  s_cbranch_scc1 L_poll_641
  s_waitcnt vmcnt(0)
L_pollx_642:
L_rb_640:
  v_pk_add_f32 v[32:33], v[32:33], v[36:37]
  v_add_f32 v34, v34, v38
  v_pk_add_f32 v[40:41], v[40:41], v[72:73]
  v_add_f32 v42, v42, v74
  v_pk_add_f32 v[76:77], v[76:77], v[80:81]
  v_add_f32 v78, v78, v82
  v_pk_add_f32 v[20:21], v[20:21], v[24:25]
  v_add_f32 v22, v22, v26
  v_pk_add_f32 v[32:33], v[32:33], v[40:41]
  v_add_f32 v34, v34, v42
  v_pk_add_f32 v[76:77], v[76:77], v[20:21]
  v_add_f32 v78, v78, v22
  v_pk_add_f32 v[32:33], v[32:33], v[76:77]
  v_add_f32 v34, v34, v78
  s_cmp_eq_u32 s3, 3
  s_cbranch_scc1 L_rw_643
  s_lshl_b32 s77, s3, 12
  s_add_u32 s77, s77, 147456
  v_add_u32 v45, s77, v44
  ds_write_b128 v45, v[32:35]
  s_cmp_eq_u32 s101, 1
  s_waitcnt lgkmcnt(0)
  s_barrier
  s_cbranch_scc1 L_rp_639
  s_branch L_h2_done
L_rw_643:
  v_add_u32 v45, 147456, v44
  s_cmp_eq_u32 s101, 1
  s_barrier
  ds_read_b128 v[20:23], v45 offset:0
  ds_read_b128 v[24:27], v45 offset:4096
  ds_read_b128 v[28:31], v45 offset:8192
  v_and_b32 v88, 0xffff0000, v88
  v_and_b32 v89, 0xffff0000, v89
  v_and_b32 v90, 0xffff0000, v90
  v_mov_b32 v91, s74
  s_waitcnt lgkmcnt(0)
  v_add_f32 v32, v32, v20
  v_add_f32 v24, v24, v28
  v_add_f32 v33, v33, v21
  v_add_f32 v25, v25, v29
  v_add_f32 v34, v34, v22
  v_add_f32 v26, v26, v30
  v_add_f32 v32, v32, v24
  v_add_f32 v33, v33, v25
  v_add_f32 v34, v34, v26
  s_nop 1
  v_add_f32_dpp v32, v32, v32 row_ror:8 row_mask:0xf bank_mask:0xf
  v_add_f32_dpp v33, v33, v33 row_ror:8 row_mask:0xf bank_mask:0xf
  v_add_f32_dpp v34, v34, v34 row_ror:8 row_mask:0xf bank_mask:0xf
  v_mov_b32 v45, v32
  v_mov_b32 v46, v33
  v_mov_b32 v47, v34
  s_nop 1
  v_permlane16_swap_b32 v32, v45
  v_permlane16_swap_b32 v33, v46
  v_permlane16_swap_b32 v34, v47
  v_add_f32 v32, v32, v45
  v_add_f32 v33, v33, v46
  v_add_f32 v34, v34, v47
  v_mov_b32 v45, v32
  v_mov_b32 v46, v33
  v_mov_b32 v47, v34
  s_nop 1
  v_permlane32_swap_b32 v32, v45
  v_permlane32_swap_b32 v33, v46
  v_permlane32_swap_b32 v34, v47
  v_add_f32 v32, v32, v45
  v_add_f32 v33, v33, v46
  v_add_f32 v34, v34, v47
  v_cvt_pk_bf16_f32 v32, 0, v32
  v_cvt_pk_bf16_f32 v33, 0, v33
  v_cvt_pk_bf16_f32 v34, 0, v34
  v_add_f32 v32, v88, v32
  v_add_f32 v33, v89, v33
  v_add_f32 v34, v90, v34
  v_cvt_pk_bf16_f32 v32, 0, v32
  v_cvt_pk_bf16_f32 v33, 0, v33
  v_cvt_pk_bf16_f32 v34, 0, v34
  s_cbranch_scc1 L_rp_639
  v_or_b32 v88, s74, v32
  v_or_b32 v89, s74, v33
  v_or_b32 v90, s74, v34
  s_lshl_b32 s77, s82, 7
  s_add_u32 s77, s77, 2654208
  s_mov_b64 exec, 0xffffffff
  buffer_store_dwordx4 v[88:91], v84, s[28:31], s77 offen sc1
  s_mov_b64 exec, -1
L_h2_done:
  v_lshlrev_b32 v44, 4, v1
  s_mov_b32 s101, 1
  s_branch L_rb_645
L_rp_644:
  s_mov_b32 s101, 0
  s_mul_i32 s77, s82, 24576
  s_mul_i32 s78, s3, 6144
  s_add_u32 s77, s77, s78
  s_add_u32 s77, s77, 1048576
  s_add_u32 s78, s77, 4096
  s_mov_b32 s86, 200000
  buffer_load_dwordx4 v[32:35], v44, s[28:31], s77 offen offset:0 sc1
  buffer_load_dwordx4 v[36:39], v44, s[28:31], s77 offen offset:1024 sc1
  buffer_load_dwordx4 v[40:43], v44, s[28:31], s77 offen offset:2048 sc1
  buffer_load_dwordx4 v[72:75], v44, s[28:31], s77 offen offset:3072 sc1
  buffer_load_dwordx4 v[76:79], v44, s[28:31], s78 offen offset:0 sc1
  buffer_load_dwordx4 v[80:83], v44, s[28:31], s78 offen offset:1024 sc1
L_poll_646:
  s_waitcnt vmcnt(5)
  v_bitop3_b32 v45, v32, v33, s75 bitop3:0x7e
  v_bitop3_b32 v45, v45, v34, s75 bitop3:0xf6
  v_and_b32 v45, 1, v45
  v_cmp_ne_u32 s[60:61], 0, v45
  s_waitcnt vmcnt(4)
  v_bitop3_b32 v45, v36, v37, s75 bitop3:0x7e
  v_bitop3_b32 v45, v45, v38, s75 bitop3:0xf6
  v_and_b32 v45, 1, v45
  v_cmp_ne_u32 s[62:63], 0, v45
  s_waitcnt vmcnt(3)
  v_bitop3_b32 v45, v40, v41, s75 bitop3:0x7e
  v_bitop3_b32 v45, v45, v42, s75 bitop3:0xf6
  v_and_b32 v45, 1, v45
  v_cmp_ne_u32 s[64:65], 0, v45
  s_or_b64 vcc, s[60:61], s[62:63]
  s_waitcnt vmcnt(2)
  v_bitop3_b32 v45, v72, v73, s75 bitop3:0x7e
  v_bitop3_b32 v45, v45, v74, s75 bitop3:0xf6
  v_and_b32 v45, 1, v45
  v_cmp_ne_u32 s[66:67], 0, v45
  s_or_b64 vcc, vcc, s[64:65]
  s_waitcnt vmcnt(1)
  v_bitop3_b32 v45, v76, v77, s75 bitop3:0x7e
  v_bitop3_b32 v45, v45, v78, s75 bitop3:0xf6
  v_and_b32 v45, 1, v45
  v_cmp_ne_u32 s[68:69], 0, v45
  s_or_b64 vcc, vcc, s[66:67]
  s_waitcnt vmcnt(0)
  v_bitop3_b32 v45, v80, v81, s75 bitop3:0x7e
  v_bitop3_b32 v45, v45, v82, s75 bitop3:0xf6
  v_and_b32 v45, 1, v45
  v_cmp_ne_u32 s[70:71], 0, v45
  s_or_b64 vcc, vcc, s[68:69]
  s_nop 0
  s_or_b64 vcc, vcc, s[70:71]
  s_cbranch_scc0 L_pollx_647
  s_mov_b64 exec, s[60:61]
  buffer_load_dwordx4 v[32:35], v44, s[28:31], s77 offen offset:0 sc1
  s_mov_b64 exec, s[62:63]
  buffer_load_dwordx4 v[36:39], v44, s[28:31], s77 offen offset:1024 sc1
  s_mov_b64 exec, s[64:65]
  buffer_load_dwordx4 v[40:43], v44, s[28:31], s77 offen offset:2048 sc1
  s_mov_b64 exec, s[66:67]
  buffer_load_dwordx4 v[72:75], v44, s[28:31], s77 offen offset:3072 sc1
  s_mov_b64 exec, s[68:69]
  buffer_load_dwordx4 v[76:79], v44, s[28:31], s78 offen offset:0 sc1
  s_mov_b64 exec, s[70:71]
  buffer_load_dwordx4 v[80:83], v44, s[28:31], s78 offen offset:1024 sc1
  s_mov_b64 exec, -1
  s_sub_u32 s86, s86, 1
  s_cmp_lg_u32 s86, 0
  s_cbranch_scc1 L_poll_646
  s_waitcnt vmcnt(0)
L_pollx_647:
L_rb_645:
  v_pk_add_f32 v[32:33], v[32:33], v[36:37]
  v_add_f32 v34, v34, v38
  v_pk_add_f32 v[40:41], v[40:41], v[72:73]
  v_add_f32 v42, v42, v74
  v_pk_add_f32 v[76:77], v[76:77], v[80:81]
  v_add_f32 v78, v78, v82
  v_pk_add_f32 v[32:33], v[32:33], v[40:41]
  v_add_f32 v34, v34, v42
  v_pk_add_f32 v[32:33], v[32:33], v[76:77]
  v_add_f32 v34, v34, v78
  s_cmp_eq_u32 s3, 3
  s_cbranch_scc1 L_rw_648
  s_lshl_b32 s77, s3, 12
  s_add_u32 s77, s77, 148480
  v_add_u32 v45, s77, v44
  ds_write_b128 v45, v[32:35]
  s_cmp_eq_u32 s101, 1
  s_waitcnt lgkmcnt(0)
  s_barrier
  s_cbranch_scc1 L_rp_644
  s_branch L_red_done
L_rw_648:
  v_add_u32 v45, 148480, v44
  s_cmp_eq_u32 s101, 1
  s_barrier
  ds_read_b128 v[20:23], v45 offset:0
  ds_read_b128 v[24:27], v45 offset:4096
  ds_read_b128 v[28:31], v45 offset:8192
  v_and_b32 v88, 0xffff0000, v88
  v_and_b32 v89, 0xffff0000, v89
  v_and_b32 v90, 0xffff0000, v90
  v_mov_b32 v91, s74
  s_waitcnt lgkmcnt(0)
  v_add_f32 v32, v32, v20
  v_add_f32 v24, v24, v28
  v_add_f32 v33, v33, v21
  v_add_f32 v25, v25, v29
  v_add_f32 v34, v34, v22
  v_add_f32 v26, v26, v30
  v_add_f32 v32, v32, v24
  v_add_f32 v33, v33, v25
  v_add_f32 v34, v34, v26
  s_nop 1
  v_add_f32_dpp v32, v32, v32 row_ror:8 row_mask:0xf bank_mask:0xf
  v_add_f32_dpp v33, v33, v33 row_ror:8 row_mask:0xf bank_mask:0xf
  v_add_f32_dpp v34, v34, v34 row_ror:8 row_mask:0xf bank_mask:0xf
  v_mov_b32 v45, v32
  v_mov_b32 v46, v33
  v_mov_b32 v47, v34
  s_nop 1
  v_permlane16_swap_b32 v32, v45
  v_permlane16_swap_b32 v33, v46
  v_permlane16_swap_b32 v34, v47
  v_add_f32 v32, v32, v45
  v_add_f32 v33, v33, v46
  v_add_f32 v34, v34, v47
  v_mov_b32 v45, v32
  v_mov_b32 v46, v33
  v_mov_b32 v47, v34
  s_nop 1
  v_permlane32_swap_b32 v32, v45
  v_permlane32_swap_b32 v33, v46
  v_permlane32_swap_b32 v34, v47
  v_add_f32 v32, v32, v45
  v_add_f32 v33, v33, v46
  v_add_f32 v34, v34, v47
  v_cvt_pk_bf16_f32 v32, 0, v32
  v_cvt_pk_bf16_f32 v33, 0, v33
  v_cvt_pk_bf16_f32 v34, 0, v34
  v_add_f32 v32, v88, v32
  v_add_f32 v33, v89, v33
  v_add_f32 v34, v90, v34
  v_cvt_pk_bf16_f32 v32, 0, v32
  v_cvt_pk_bf16_f32 v33, 0, v33
  v_cvt_pk_bf16_f32 v34, 0, v34
  s_cbranch_scc1 L_rp_644
  s_cmp_lg_u32 s76, 0
  s_cbranch_scc1 L_final
  v_or_b32 v88, s74, v32
  v_or_b32 v89, s74, v33
  v_or_b32 v90, s74, v34
  s_lshl_b32 s77, s82, 7
  s_add_u32 s77, s77, 2686976
  s_mov_b64 exec, 0xffffffff
  buffer_store_dwordx4 v[88:91], v84, s[28:31], s77 offen sc1
  s_mov_b64 exec, -1
  s_branch L_red_done
L_final:
  s_lshr_b32 s77, s82, 3
  s_lshl_b32 s77, s77, 7
  s_and_b32 s78, s82, 3
  s_lshl_b32 s78, s78, 2
  s_add_u32 s77, s77, s78
  s_bfe_u32 s78, s82, 0x10002
  s_lshl_b32 s78, s78, 1
  s_add_u32 s77, s77, s78
  s_mov_b64 exec, 0xff
  buffer_store_short_d16_hi v32, v44, s[36:39], s77 offen
  buffer_store_short_d16_hi v33, v44, s[36:39], s77 offen offset:512
  s_cmp_ge_u32 s82, 16
  s_cbranch_scc1 L_final2
  buffer_store_short_d16_hi v34, v44, s[36:39], s77 offen offset:1024
L_final2:
  s_mov_b64 exec, -1
  s_branch L_red_done
L_ffn:
  s_lshl_b32 s78, s3, 10
  s_add_u32 s78, s78, 151552
  v_lshl_add_u32 v46, v1, 4, s78
  s_or_b32 s101, s101, 2
  s_branch L_ffn_body
L_ffn_poll:
  s_and_b32 s101, s101, 1
  v_lshlrev_b32 v44, 4, v1
  s_and_b32 s77, s2, 3
  s_lshl2_add_u32 s77, s77, s3
  s_lshl_b32 s77, s77, 10
  s_add_u32 s77, s77, 2654208
  s_lshl_b32 s78, s3, 10
  s_add_u32 s78, s78, 151552
  v_lshl_add_u32 v46, v1, 4, s78
  s_mov_b32 s86, 200000
L_poll_649:
  buffer_load_dwordx4 v[84:87], v44, s[28:31], s77 offen sc1
  s_waitcnt vmcnt(0)
  v_bitop3_b32 v45, v84, v85, s75 bitop3:0x7e
  v_bitop3_b32 v45, v45, v86, s75 bitop3:0xf6
  v_and_b32 v45, 1, v45
  v_cmp_ne_u32 vcc, 0, v45
  s_cbranch_vccz L_pollx_650
  s_mov_b64 exec, vcc
  s_sub_u32 s86, s86, 1
  s_cmp_lg_u32 s86, 0
  s_cbranch_scc1 L_poll_649
L_pollx_650:
  s_mov_b64 exec, -1
  v_and_b32 v84, 0xffff0000, v84
  v_and_b32 v85, 0xffff0000, v85
  v_and_b32 v86, 0xffff0000, v86
L_ffn_body:
  ds_write_b128 v46, v[84:87]
  v_lshlrev_b32 v44, 4, v1
  v_add_u32 v44, 151552, v44
  s_waitcnt lgkmcnt(0)
  s_barrier
  ds_read_b128 v[20:23], v44
  ds_read_b128 v[24:27], v44 offset:1024
  ds_read_b64 v[28:29], v44 offset:2048
  ds_read_b64 v[30:31], v44 offset:3072
  s_cmp_lg_u32 s101, 1
  s_cbranch_scc1 L_wq_651
  buffer_load_dwordx4 v[64:67], v4, s[12:15], s100 offen nt
  s_add_u32 s100, s100, 786432
  buffer_load_dwordx4 v[68:71], v4, s[12:15], s100 offen nt
  s_add_u32 s100, s100, 786432
  buffer_load_dwordx4 v[12:15], v4, s[12:15], s100 offen nt
  s_add_u32 s100, s100, 786432
L_wq_651:
  s_waitcnt lgkmcnt(0)
  v_readfirstlane_b32 s54, v20
  s_nop 1
  v_pk_add_f32 v[20:21], v[20:21], s[54:55] op_sel_hi:[1,0] neg_lo:[0,1] neg_hi:[0,1]
  v_pk_add_f32 v[24:25], v[24:25], s[54:55] op_sel_hi:[1,0] neg_lo:[0,1] neg_hi:[0,1]
  v_pk_add_f32 v[28:29], v[28:29], s[54:55] op_sel_hi:[1,0] neg_lo:[0,1] neg_hi:[0,1]
  v_pk_add_f32 v[30:31], v[30:31], s[54:55] op_sel_hi:[1,0] neg_lo:[0,1] neg_hi:[0,1]
  v_subrev_f32 v22, s54, v22
  v_subrev_f32 v23, s54, v26
  v_pk_mul_f32 v[46:47], v[20:21], v[20:21]
  v_pk_add_f32 v[44:45], v[20:21], v[24:25]
  v_pk_fma_f32 v[46:47], v[24:25], v[24:25], v[46:47]
  v_pk_add_f32 v[44:45], v[44:45], v[28:29]
  v_pk_fma_f32 v[46:47], v[28:29], v[28:29], v[46:47]
  v_pk_add_f32 v[44:45], v[44:45], v[30:31]
  v_pk_fma_f32 v[46:47], v[30:31], v[30:31], v[46:47]
  v_pk_add_f32 v[44:45], v[44:45], v[22:23]
  v_pk_fma_f32 v[46:47], v[22:23], v[22:23], v[46:47]
  v_add_f32 v44, v44, v45
  v_add_f32 v45, v46, v47
  s_nop 1
  v_add_f32_dpp v44, v44, v44 quad_perm:[1,0,3,2] row_mask:0xf bank_mask:0xf
  v_add_f32_dpp v45, v45, v45 quad_perm:[1,0,3,2] row_mask:0xf bank_mask:0xf
  s_nop 0
  v_add_f32_dpp v44, v44, v44 quad_perm:[2,3,0,1] row_mask:0xf bank_mask:0xf
  v_add_f32_dpp v45, v45, v45 quad_perm:[2,3,0,1] row_mask:0xf bank_mask:0xf
  s_nop 0
  v_add_f32_dpp v44, v44, v44 row_half_mirror row_mask:0xf bank_mask:0xf
  v_add_f32_dpp v45, v45, v45 row_half_mirror row_mask:0xf bank_mask:0xf
  s_nop 0
  v_add_f32_dpp v44, v44, v44 row_mirror row_mask:0xf bank_mask:0xf
  v_add_f32_dpp v45, v45, v45 row_mirror row_mask:0xf bank_mask:0xf
  s_nop 0
  v_mov_b32 v46, v44
  v_mov_b32 v47, v45
  s_nop 1
  v_permlane16_swap_b32 v44, v46
  v_permlane16_swap_b32 v45, v47
  v_add_f32 v44, v44, v46
  v_add_f32 v45, v45, v47
  v_mov_b32 v46, v44
  v_mov_b32 v47, v45
  s_nop 1
  v_permlane32_swap_b32 v44, v46
  v_permlane32_swap_b32 v45, v47
  v_add_f32 v44, v44, v46
  v_add_f32 v45, v45, v47
  v_mul_f32 v44, 0x3acccccd, v44
  v_mul_f32 v45, 0x3acccccd, v45
  v_fma_f32 v45, -v44, v44, v45
  v_add_f32 v44, s54, v44
  v_max_f32 v45, 0, v45
  v_cvt_pk_bf16_f32 v45, 0, v45
  v_cvt_pk_bf16_f32 v44, 0, v44
  v_add_f32 v45, 0x3727c5ac, v45
  v_cvt_pk_bf16_f32 v45, 0, v45
  v_sqrt_f32 v45, v45
  s_waitcnt lgkmcnt(0)
  v_sub_f32 v88, v84, v44
  v_sub_f32 v89, v85, v44
  v_sub_f32 v90, v86, v44
  v_cvt_pk_bf16_f32 v45, 0, v45
  v_rcp_f32 v46, v45
  v_cvt_pk_bf16_f32 v88, 0, v88
  v_cvt_pk_bf16_f32 v89, 0, v89
  v_cvt_pk_bf16_f32 v90, 0, v90
  v_mul_f32 v20, v88, v46
  v_mul_f32 v21, v89, v46
  v_mul_f32 v22, v90, v46
  v_fma_f32 v24, -v20, v45, v88
  v_fma_f32 v25, -v21, v45, v89
  v_fma_f32 v26, -v22, v45, v90
  v_fma_f32 v20, v24, v46, v20
  v_fma_f32 v21, v25, v46, v21
  v_fma_f32 v22, v26, v46, v22
  v_and_b32 v22, s83, v22
  v_cvt_pk_bf16_f32 v88, v20, 0
  v_cvt_pk_bf16_f32 v84, 0, v20
  v_cvt_pk_bf16_f32 v89, v21, 0
  v_cvt_pk_bf16_f32 v85, 0, v21
  v_cvt_pk_bf16_f32 v90, v22, 0
  v_cvt_pk_bf16_f32 v86, 0, v22
  v_dot2_f32_bf16 v20, v32, v88, 0
  v_dot2_f32_bf16 v21, v32, v84, 0
  v_dot2_f32_bf16 v22, v33, v88, 0
  v_dot2_f32_bf16 v23, v33, v84, 0
  v_dot2_f32_bf16 v24, v34, v88, 0
  v_dot2_f32_bf16 v25, v34, v84, 0
  v_dot2_f32_bf16 v26, v35, v88, 0
  v_dot2_f32_bf16 v27, v35, v84, 0
  v_dot2_f32_bf16 v20, v36, v89, v20
  v_dot2_f32_bf16 v21, v36, v85, v21
  v_dot2_f32_bf16 v22, v37, v89, v22
  v_dot2_f32_bf16 v23, v37, v85, v23
  v_dot2_f32_bf16 v24, v38, v89, v24
  v_dot2_f32_bf16 v25, v38, v85, v25
  v_dot2_f32_bf16 v26, v39, v89, v26
  v_dot2_f32_bf16 v27, v39, v85, v27
  v_dot2_f32_bf16 v20, v40, v90, v20
  v_dot2_f32_bf16 v21, v40, v86, v21
  v_dot2_f32_bf16 v22, v41, v90, v22
  v_dot2_f32_bf16 v23, v41, v86, v23
  v_dot2_f32_bf16 v24, v42, v90, v24
  v_dot2_f32_bf16 v25, v42, v86, v25
  v_dot2_f32_bf16 v26, v43, v90, v26
  v_dot2_f32_bf16 v27, v43, v86, v27
  v_add_f32_dpp v84, v20, v20 row_ror:8 row_mask:0xf bank_mask:0x3
  v_add_f32_dpp v84, v24, v24 row_ror:8 row_mask:0xf bank_mask:0xc
  v_add_f32_dpp v85, v21, v21 row_ror:8 row_mask:0xf bank_mask:0x3
  v_add_f32_dpp v85, v25, v25 row_ror:8 row_mask:0xf bank_mask:0xc
  v_add_f32_dpp v86, v22, v22 row_ror:8 row_mask:0xf bank_mask:0x3
  v_add_f32_dpp v86, v26, v26 row_ror:8 row_mask:0xf bank_mask:0xc
  v_add_f32_dpp v87, v23, v23 row_ror:8 row_mask:0xf bank_mask:0x3
  v_add_f32_dpp v87, v27, v27 row_ror:8 row_mask:0xf bank_mask:0xc
  v_add_f32_dpp v88, v84, v84 row_half_mirror row_mask:0xf bank_mask:0x5
  v_add_f32_dpp v88, v86, v86 row_half_mirror row_mask:0xf bank_mask:0xa
  v_add_f32_dpp v89, v85, v85 row_half_mirror row_mask:0xf bank_mask:0x5
  v_add_f32_dpp v89, v87, v87 row_half_mirror row_mask:0xf bank_mask:0xa
  v_bfe_u32 v44, v1, 4, 1
  v_bfe_u32 v45, v1, 2, 2
  v_permlane16_swap_b32 v88, v89
  v_add_f32 v88, v88, v89
  v_lshl_add_u32 v44, v45, 1, v44
  s_lshl2_add_u32 s77, s3, 159872
  v_add_f32_dpp v88, v88, v88 quad_perm:[1,0,3,2] row_mask:0xf bank_mask:0xf
  v_lshl_add_u32 v44, v44, 4, s77
  v_lshrrev_b32 v45, 3, v1
  v_add_f32_dpp v88, v88, v88 quad_perm:[2,3,0,1] row_mask:0xf bank_mask:0xf
  v_mov_b32 v89, v88
  v_lshlrev_b32 v45, 4, v45
  v_add_u32 v45, 159872, v45
  v_permlane32_swap_b32 v88, v89
  v_add_f32 v88, v88, v89
  ds_write_b32 v44, v88
  s_waitcnt lgkmcnt(0)
  s_barrier
  ds_read_b128 v[84:87], v45
  s_waitcnt lgkmcnt(0)
  v_add_f32 v84, v84, v85
  v_add_f32 v86, v86, v87
  v_add_f32 v84, v84, v86
  v_cvt_pk_bf16_f32 v84, 0, v84
  v_mul_f32 v44, s85, v84
  v_exp_f32 v44, -v44
  s_nop 0
  v_add_f32 v44, 1.0, v44
  v_rcp_f32 v44, v44
  s_nop 0
  v_mul_f32 v44, v84, v44
  v_cvt_pk_bf16_f32 v44, v44, v44
  v_and_b32 v16, v8, v44
  v_and_b32 v17, v9, v44
  v_and_b32 v18, v10, v44
  v_and_b32 v19, v11, v44
  s_nop 1
  v_mfma_f32_16x16x32_bf16 v[20:23], v[16:19], v[72:75], 0
  v_mfma_f32_16x16x32_bf16 v[24:27], v[16:19], v[76:79], 0
  v_mfma_f32_16x16x32_bf16 v[28:31], v[16:19], v[80:83], 0
  v_lshrrev_b32 v46, 3, v1
  v_mul_u32_u24 v46, 24576, v46
  v_and_b32 v47, 7, v1
  v_lshl_add_u32 v46, v47, 4, v46
  s_mul_i32 s77, s3, 196608
  s_lshl_b32 s78, s2, 7
  s_add_u32 s77, s77, s78
  s_add_u32 s77, s77, 1048576
  s_cmp_ge_u32 s101, 2
  s_nop 1
  v_permlane32_swap_b32 v20, v21
  v_permlane32_swap_b32 v22, v23
  v_permlane32_swap_b32 v24, v25
  v_permlane32_swap_b32 v26, v27
  v_permlane32_swap_b32 v28, v29
  v_permlane32_swap_b32 v30, v31
  s_nop 0
  v_add_f32_dpp v16, v21, v20 row_ror:8 row_mask:0xf bank_mask:0x3
  v_add_f32_dpp v16, v22, v23 row_ror:8 row_mask:0xf bank_mask:0xc
  v_add_f32_dpp v17, v25, v24 row_ror:8 row_mask:0xf bank_mask:0x3
  v_add_f32_dpp v17, v26, v27 row_ror:8 row_mask:0xf bank_mask:0xc
  v_add_f32_dpp v18, v29, v28 row_ror:8 row_mask:0xf bank_mask:0x3
  v_add_f32_dpp v18, v30, v31 row_ror:8 row_mask:0xf bank_mask:0xc
  v_and_or_b32 v16, v16, -2, s74
  v_and_or_b32 v17, v17, -2, s74
  v_and_or_b32 v18, v18, -2, s74
  v_and_or_b32 v19, v19, -2, s74
  s_cbranch_scc1 L_ffn_poll
  buffer_store_dwordx4 v[16:19], v46, s[28:31], s77 offen sc1
  s_cmp_lg_u32 s76, 0
  s_cbranch_scc1 L_end
  s_sub_u32 s77, s2, 160
  s_cmp_lt_u32 s77, 64
  s_cbranch_scc1 L_next
  s_barrier
  buffer_load_dwordx4 v[80:83], v4, s[12:15], s100 offen nt
  s_add_u32 s100, s100, 786432
  buffer_load_dwordx4 v[32:35], v4, s[12:15], s100 offen nt
  s_add_u32 s100, s100, 786432
  buffer_load_dwordx4 v[36:39], v4, s[12:15], s100 offen nt
  s_add_u32 s100, s100, 786432
  s_branch L_next
L_red_done:
  s_cmp_lg_u32 s76, 0
  s_cbranch_scc1 L_end
L_next:
  s_mov_b32 s76, 1
  s_mov_b32 s58, s91
  s_mov_b32 s59, 0
  s_mov_b32 s101, 0
  v_readlane_b32 s64, v0, s59
  s_lshr_b32 s64, s64, s101
  s_and_b32 s65, s64, 7
  s_mulk_i32 s65, 12288
  v_add_u32 v44, s65, v2
  v_add_u32 v45, 4294868992, v44
  v_min_u32 v4, v44, v45
  s_sub_u32 s77, s2, 160
  s_cmp_lt_u32 s77, 64
  s_cbranch_scc1 L_ek
  s_lshl_b32 s78, s3, 10
  s_add_u32 s78, s78, 151552
  v_lshl_add_u32 v46, v1, 4, s78
  s_mov_b32 s76, 2
  s_branch L_pass
L_ek:
  s_barrier
  buffer_load_dwordx4 v[72:75], v4, s[4:7], s58 offen offset:0 nt
  buffer_load_dwordx4 v[76:79], v4, s[4:7], s58 offen offset:128 nt
  buffer_load_dwordx4 v[40:43], v4, s[4:7], s58 offen offset:256 nt
  s_branch L_q_pass1b
  s_sub_u32 s77, s2, 160
  s_cmp_lt_u32 s77, 64
  s_cbranch_scc1 L_q_pass1
  s_mov_b32 s76, 2
  s_branch L_pass
L_end:
  s_endpgm
L_rescale:
  v_mov_b32 v44, v14
  s_nop 1
  v_max_f32_dpp v44, v44, v44 quad_perm:[1,0,3,2] row_mask:0xf bank_mask:0xf
  s_nop 1
  v_max_f32_dpp v44, v44, v44 quad_perm:[2,3,0,1] row_mask:0xf bank_mask:0xf
  s_nop 1
  v_max_f32_dpp v44, v44, v44 row_half_mirror row_mask:0xf bank_mask:0xf
  s_nop 1
  v_max_f32_dpp v44, v44, v44 row_mirror row_mask:0xf bank_mask:0xf
  s_nop 1
  v_mov_b32 v45, v44
  s_nop 1
  v_permlane16_swap_b32 v44, v45
  v_max_f32 v44, v44, v45
  v_mov_b32 v45, v44
  s_nop 1
  v_permlane32_swap_b32 v44, v45
  v_max_f32 v44, v44, v45
  v_sub_f32 v45, s60, v44
  v_mul_f32 v45, s85, v45
  v_exp_f32 v45, v45
  v_readfirstlane_b32 s60, v44
  v_mul_f32 v20, v45, v20
  v_mul_f32 v21, v45, v21
  v_mul_f32 v22, v45, v22
  v_mul_f32 v23, v45, v23
  v_mul_f32 v24, v45, v24
  v_mul_f32 v25, v45, v25
  v_mul_f32 v26, v45, v26
  v_mul_f32 v27, v45, v27
  v_mul_f32 v28, v45, v28
  v_mul_f32 v29, v45, v29
  v_mul_f32 v30, v45, v30
  v_mul_f32 v31, v45, v31
  v_mul_f32 v15, v45, v15
  s_setpc_b64 s[52:53]
L_flush:
  s_nop 1
  v_add_f32_dpp v15, v15, v15 quad_perm:[1,0,3,2] row_mask:0xf bank_mask:0xf
  s_nop 1
  v_add_f32_dpp v15, v15, v15 quad_perm:[2,3,0,1] row_mask:0xf bank_mask:0xf
  s_nop 1
  v_add_f32_dpp v15, v15, v15 row_half_mirror row_mask:0xf bank_mask:0xf
  s_nop 1
  v_add_f32_dpp v15, v15, v15 row_mirror row_mask:0xf bank_mask:0xf
  s_nop 1
  v_mov_b32 v44, v15
  s_nop 1
  v_permlane16_swap_b32 v15, v44
  v_add_f32 v15, v15, v44
  v_mov_b32 v44, v15
  s_nop 1
  v_permlane32_swap_b32 v15, v44
  v_add_f32 v15, v15, v44
  v_permlane32_swap_b32 v20, v21
  v_permlane32_swap_b32 v22, v23
  v_permlane32_swap_b32 v24, v25
  v_permlane32_swap_b32 v26, v27
  v_permlane32_swap_b32 v28, v29
  v_permlane32_swap_b32 v30, v31
  s_nop 0
  v_add_f32_dpp v16, v21, v20 row_ror:8 row_mask:0xf bank_mask:0x3
  v_add_f32_dpp v16, v22, v23 row_ror:8 row_mask:0xf bank_mask:0xc
  v_add_f32_dpp v17, v25, v24 row_ror:8 row_mask:0xf bank_mask:0x3
  v_add_f32_dpp v17, v26, v27 row_ror:8 row_mask:0xf bank_mask:0xc
  v_add_f32_dpp v18, v29, v28 row_ror:8 row_mask:0xf bank_mask:0x3
  v_add_f32_dpp v18, v30, v31 row_ror:8 row_mask:0xf bank_mask:0xc
  s_lshl_b32 s78, s78, 2
  s_add_u32 s78, s78, s3
  s_lshl_b32 s77, s78, 10
  s_add_u32 s77, s77, 147456
  v_lshl_add_u32 v45, v1, 4, s77
  ds_write_b128 v45, v[16:19]
  s_lshl_b32 s77, s78, 3
  s_add_u32 s77, s77, 159744
  v_mov_b32 v44, s77
  v_mov_b32 v14, s60
  ds_write_b64 v44, v[14:15]
  s_nop 0
  v_mov_b32 v20, 0
  v_mov_b32 v21, 0
  v_mov_b32 v22, 0
  v_mov_b32 v23, 0
  v_mov_b32 v24, 0
  v_mov_b32 v25, 0
  v_mov_b32 v26, 0
  v_mov_b32 v27, 0
  v_mov_b32 v28, 0
  v_mov_b32 v29, 0
  v_mov_b32 v30, 0
  v_mov_b32 v31, 0
  v_mov_b32 v15, 0
  s_mov_b32 s60, 0xff800000
L_setret:
  s_setpc_b64 s[52:53]
L_go_spin:
  s_mov_b32 s86, 200000
L_go_spin1:
  buffer_load_dword v40, v41, s[40:43], 0 offen offset:128 sc1
  s_waitcnt vmcnt(0)
  v_cmp_eq_u32 vcc, 0, v40
  s_nop 1
  s_cmp_eq_u64 vcc, 0
  s_cbranch_scc1 L_go_ok
  s_sub_u32 s86, s86, 1
  s_cmp_lg_u32 s86, 0
  s_cbranch_scc1 L_go_spin1
  s_branch L_go_ok
L_pw_spin:
  s_mov_b32 s86, 200000
L_pw_spin1:
  buffer_load_dword v14, v46, s[28:31], s71 offen sc1
  s_waitcnt vmcnt(0)
  v_cmp_eq_u32 vcc, 0, v14
  s_nop 1
  s_cmp_eq_u64 vcc, 0
  s_cbranch_scc1 L_pw_ok
  s_sub_u32 s86, s86, 1
  s_cmp_lg_u32 s86, 0
  s_cbranch_scc1 L_pw_spin1
  s_branch L_pw_ok
L_all_spin:
  s_mov_b32 s86, 200000
L_all_spin1:
  buffer_load_dword v14, off, s[40:43], 0 sc1
  s_waitcnt vmcnt(0)
  v_readfirstlane_b32 s77, v14
  s_cmp_ge_u32 s77, 64
  s_cbranch_scc1 L_all_ok
  s_sub_u32 s86, s86, 1
  s_cmp_lg_u32 s86, 0
  s_cbranch_scc1 L_all_spin1
  s_branch L_all_ok
L_ma_3:
  buffer_load_dwordx4 v[48:51], v4, s[4:7], s58 offen offset:0
  s_branch L_mb_4
L_ma_5:
  buffer_load_dwordx4 v[52:55], v4, s[4:7], s58 offen offset:128
  s_branch L_mb_6
L_ma_7:
  buffer_load_dwordx4 v[56:59], v4, s[4:7], s58 offen offset:256
  s_branch L_mb_8
L_ma_9:
  buffer_load_dwordx4 v[60:63], v4, s[4:7], s58 offen offset:0
  s_branch L_mb_10
L_ma_11:
  buffer_load_dwordx4 v[64:67], v4, s[4:7], s58 offen offset:128
  s_branch L_mb_12
L_ma_13:
  buffer_load_dwordx4 v[68:71], v4, s[4:7], s58 offen offset:256
  s_branch L_mb_14
L_ma_15:
  buffer_load_dwordx4 v[72:75], v4, s[4:7], s58 offen offset:0
  s_branch L_mb_16
L_ma_17:
  buffer_load_dwordx4 v[76:79], v4, s[4:7], s58 offen offset:128
  s_branch L_mb_18
L_ma_19:
  buffer_load_dwordx4 v[48:51], v4, s[4:7], s58 offen offset:256
  s_branch L_mb_20
L_ma_21:
  buffer_load_dwordx4 v[52:55], v4, s[4:7], s58 offen offset:0
  s_branch L_mb_22
L_ma_23:
  buffer_load_dwordx4 v[56:59], v4, s[4:7], s58 offen offset:128
  s_branch L_mb_24
L_ma_25:
  buffer_load_dwordx4 v[60:63], v4, s[4:7], s58 offen offset:256
  s_branch L_mb_26
L_ma_27:
  buffer_load_dwordx4 v[64:67], v4, s[4:7], s58 offen offset:0
  s_branch L_mb_28
L_ma_29:
  buffer_load_dwordx4 v[68:71], v4, s[4:7], s58 offen offset:128
  s_branch L_mb_30
L_ma_31:
  buffer_load_dwordx4 v[72:75], v4, s[4:7], s58 offen offset:256
  s_branch L_mb_32
L_ma_33:
  buffer_load_dwordx4 v[76:79], v4, s[4:7], s58 offen offset:0
  s_branch L_mb_34
L_ma_35:
  buffer_load_dwordx4 v[48:51], v4, s[4:7], s58 offen offset:128
  s_branch L_mb_36
L_ma_37:
  buffer_load_dwordx4 v[52:55], v4, s[4:7], s58 offen offset:256
  s_branch L_mb_38
L_ma_39:
  buffer_load_dwordx4 v[56:59], v4, s[4:7], s58 offen offset:0
  s_branch L_mb_40
L_ma_41:
  buffer_load_dwordx4 v[60:63], v4, s[4:7], s58 offen offset:128
  s_branch L_mb_42
L_ma_43:
  buffer_load_dwordx4 v[64:67], v4, s[4:7], s58 offen offset:256
  s_branch L_mb_44
L_ma_45:
  buffer_load_dwordx4 v[68:71], v4, s[4:7], s58 offen offset:0
  s_branch L_mb_46
L_ma_47:
  buffer_load_dwordx4 v[72:75], v4, s[4:7], s58 offen offset:128
  s_branch L_mb_48
L_ma_49:
  buffer_load_dwordx4 v[76:79], v4, s[4:7], s58 offen offset:256
  s_branch L_mb_50
L_ma_51:
  buffer_load_dwordx4 v[48:51], v4, s[4:7], s58 offen offset:0
  s_branch L_mb_52
L_ma_53:
  buffer_load_dwordx4 v[52:55], v4, s[4:7], s58 offen offset:128
  s_branch L_mb_54
L_ma_55:
  buffer_load_dwordx4 v[56:59], v4, s[4:7], s58 offen offset:256
  s_branch L_mb_56
L_ma_57:
  buffer_load_dwordx4 v[60:63], v4, s[4:7], s58 offen offset:0
  s_branch L_mb_58
L_ma_59:
  buffer_load_dwordx4 v[64:67], v4, s[4:7], s58 offen offset:128
  s_branch L_mb_60
L_ma_61:
  buffer_load_dwordx4 v[68:71], v4, s[4:7], s58 offen offset:256
  s_branch L_mb_62
L_ma_63:
  buffer_load_dwordx4 v[72:75], v4, s[4:7], s58 offen offset:0
  s_branch L_mb_64
L_q10:
  v_bfe_u32 v45, v1, 3, 1
  v_lshlrev_b32 v45, 6, v45
  v_lshrrev_b32 v46, 4, v1
  v_lshl_add_u32 v45, v46, 4, v45
  v_add_u32 v45, 160384, v45
  ds_read_b128 v[80:83], v45 offset:0
  ds_read_b128 v[84:87], v45 offset:128
  ds_read_b128 v[88:91], v45 offset:256
  s_waitcnt lgkmcnt(0)
  s_branch L_flagA0_r
L_q20:
  v_bfe_u32 v45, v1, 3, 1
  v_lshlrev_b32 v45, 6, v45
  v_lshrrev_b32 v46, 4, v1
  v_lshl_add_u32 v45, v46, 4, v45
  v_add_u32 v45, 160768, v45
  ds_read_b128 v[80:83], v45 offset:0
  ds_read_b128 v[84:87], v45 offset:128
  ds_read_b128 v[88:91], v45 offset:256
  s_waitcnt lgkmcnt(0)
  s_branch L_flagA0_r
L_stA0:
  v_mov_b32 v32, v36
  v_mov_b32 v33, v37
  v_mov_b32 v34, v38
  v_mov_b32 v35, v39
  v_lshl_or_b32 v44, v1, 4, s98
  buffer_store_dwordx4 v[32:35], v44, s[28:31], s87 offen offset:0 sc1 nt
  s_branch L_flagA0_r
L_flagA0:
  s_add_u32 s88, s88, 1
  v_mov_b32 v44, s88
  s_cmp_eq_u32 s3, 0
  s_cselect_b32 s77, s98, 0x80000000
  v_lshl_or_b32 v45, v1, 2, s77
  s_lshl_b32 s77, s2, 7
  s_add_u32 s77, s77, 2621440
  s_mov_b32 exec_hi, 0
  buffer_store_dword v44, v45, s[28:31], s77 offen sc1 nt
  s_mov_b64 exec, -1
  s_branch L_flagA0_r
L_ma_65:
  buffer_load_dwordx4 v[76:79], v4, s[4:7], s58 offen offset:128
  s_branch L_mb_66
L_ma_67:
  buffer_load_dwordx4 v[48:51], v4, s[4:7], s58 offen offset:256
  s_branch L_mb_68
L_ma_69:
  buffer_load_dwordx4 v[52:55], v4, s[4:7], s58 offen offset:0
  s_branch L_mb_70
L_ma_71:
  buffer_load_dwordx4 v[56:59], v4, s[4:7], s58 offen offset:128
  s_branch L_mb_72
L_ma_73:
  buffer_load_dwordx4 v[60:63], v4, s[4:7], s58 offen offset:256
  s_branch L_mb_74
L_ma_75:
  buffer_load_dwordx4 v[64:67], v4, s[4:7], s58 offen offset:0
  s_branch L_mb_76
L_ma_77:
  buffer_load_dwordx4 v[68:71], v4, s[4:7], s58 offen offset:128
  s_branch L_mb_78
L_ma_79:
  buffer_load_dwordx4 v[72:75], v4, s[4:7], s58 offen offset:256
  s_branch L_mb_80
L_ma_81:
  buffer_load_dwordx4 v[76:79], v4, s[4:7], s58 offen offset:0
  s_branch L_mb_82
L_fs_83:
  s_mov_b32 s86, 200000
L_fs_83a:
  buffer_load_dword v47, off, s[28:31], s71 sc1
  s_waitcnt vmcnt(0)
  v_readfirstlane_b32 s77, v47
  s_cmp_ge_i32 s77, s88
  s_cbranch_scc1 L_fk_84
  s_sub_u32 s86, s86, 1
  s_cmp_lg_u32 s86, 0
  s_cbranch_scc1 L_fs_83a
  s_branch L_fk_84
L_ma_85:
  buffer_load_dwordx4 v[48:51], v4, s[4:7], s58 offen offset:128
  s_branch L_mb_86
L_ma_87:
  buffer_load_dwordx4 v[52:55], v4, s[4:7], s58 offen offset:256
  s_branch L_mb_88
L_ma_89:
  buffer_load_dwordx4 v[56:59], v4, s[4:7], s58 offen offset:0
  s_branch L_mb_90
L_ma_91:
  buffer_load_dwordx4 v[60:63], v4, s[4:7], s58 offen offset:128
  s_branch L_mb_92
L_ma_93:
  buffer_load_dwordx4 v[64:67], v4, s[4:7], s58 offen offset:256
  s_branch L_mb_94
L_ma_95:
  buffer_load_dwordx4 v[68:71], v4, s[4:7], s58 offen offset:0
  s_branch L_mb_96
L_ma_97:
  buffer_load_dwordx4 v[72:75], v4, s[4:7], s58 offen offset:128
  s_branch L_mb_98
L_ma_99:
  buffer_load_dwordx4 v[76:79], v4, s[4:7], s58 offen offset:256
  s_branch L_mb_100
L_fs_334:
  s_mov_b32 s86, 200000
L_fs_334a:
  buffer_load_dword v47, off, s[28:31], s71 sc1
  s_waitcnt vmcnt(0)
  v_readfirstlane_b32 s77, v47
  s_cmp_ge_i32 s77, s88
  s_cbranch_scc1 L_fk_335
  s_sub_u32 s86, s86, 1
  s_cmp_lg_u32 s86, 0
  s_cbranch_scc1 L_fs_334a
  s_branch L_fk_335
L_q11:
  v_bfe_u32 v45, v1, 3, 1
  v_lshlrev_b32 v45, 6, v45
  v_lshrrev_b32 v46, 4, v1
  v_lshl_add_u32 v45, v46, 4, v45
  v_add_u32 v45, 160384, v45
  ds_read_b128 v[80:83], v45 offset:0
  ds_read_b128 v[84:87], v45 offset:128
  ds_read_b128 v[88:91], v45 offset:256
  s_waitcnt lgkmcnt(0)
  s_branch L_flagA1_r
L_q21:
  v_bfe_u32 v45, v1, 3, 1
  v_lshlrev_b32 v45, 6, v45
  v_lshrrev_b32 v46, 4, v1
  v_lshl_add_u32 v45, v46, 4, v45
  v_add_u32 v45, 160768, v45
  ds_read_b128 v[80:83], v45 offset:0
  ds_read_b128 v[84:87], v45 offset:128
  ds_read_b128 v[88:91], v45 offset:256
  s_waitcnt lgkmcnt(0)
  s_branch L_flagA1_r
L_stA1:
  v_mov_b32 v32, v36
  v_mov_b32 v33, v37
  v_mov_b32 v34, v38
  v_mov_b32 v35, v39
  v_lshl_or_b32 v44, v1, 4, s98
  buffer_store_dwordx4 v[32:35], v44, s[28:31], s87 offen offset:0 sc1 nt
  s_branch L_flagA1_r
L_flagA1:
  s_add_u32 s88, s88, 1
  v_mov_b32 v44, s88
  s_cmp_eq_u32 s3, 0
  s_cselect_b32 s77, s98, 0x80000000
  v_lshl_or_b32 v45, v1, 2, s77
  s_lshl_b32 s77, s2, 7
  s_add_u32 s77, s77, 2621440
  s_mov_b32 exec_hi, 0
  buffer_store_dword v44, v45, s[28:31], s77 offen sc1 nt
  s_mov_b64 exec, -1
  s_branch L_flagA1_r
L_fs_613:
  s_mov_b32 s86, 200000
L_fs_613a:
  buffer_load_dword v47, off, s[28:31], s71 sc1
  s_waitcnt vmcnt(0)
  v_readfirstlane_b32 s77, v47
  s_cmp_ge_i32 s77, s88
  s_cbranch_scc1 L_fk_614
  s_sub_u32 s86, s86, 1
  s_cmp_lg_u32 s86, 0
  s_cbranch_scc1 L_fs_613a
  s_branch L_fk_614
L_fs_624:
  s_mov_b32 s86, 200000
L_fs_624a:
  buffer_load_dword v47, off, s[28:31], s71 sc1
  s_waitcnt vmcnt(0)
  v_readfirstlane_b32 s77, v47
  s_cmp_ge_i32 s77, s88
  s_cbranch_scc1 L_fk_625
  s_sub_u32 s86, s86, 1
  s_cmp_lg_u32 s86, 0
  s_cbranch_scc1 L_fs_624a
  s_branch L_fk_625
.section .rodata,"a"
.p2align 6
.amdhsa_kernel interleave_layers__mha_block_cached__dense_activation_silu__decode_kernel
  .amdhsa_next_free_vgpr 512
  .amdhsa_next_free_sgpr 102
  .amdhsa_accum_offset 256
  .amdhsa_group_segment_fixed_size 0
  .amdhsa_kernarg_size 88
  .amdhsa_user_sgpr_count 2
  .amdhsa_user_sgpr_kernarg_segment_ptr 1
  .amdhsa_system_sgpr_workgroup_id_x 1
.end_amdhsa_kernel
```
